```python
import torch

def _softmax(x, axis=-1):
    return torch.softmax(x, dim=axis)
def _gelu(x):
    return torch.nn.functional.gelu(x, approximate="tanh")
def _silu(x):
    return torch.nn.functional.silu(x)
def _sigmoid(x):
    return torch.sigmoid(x)
def _layernorm(x, axis=-1, eps=1e-5):
    m = x.mean(dim=axis, keepdim=True)
    v = x.var(dim=axis, keepdim=True, unbiased=False)
    return (x - m) / torch.sqrt(v + eps)
def _scatter_add(tgt, idx, src, axis=0):
    return tgt.clone().index_add_(axis, idx, src)
def _segment_sum(src, seg, n):
    out = torch.zeros((n,) + src.shape[1:], dtype=src.dtype)
    return out.index_add_(0, seg, src)
def _pad(x, pw):
    flat = tuple(v for pair in reversed(pw) for v in pair)
    return torch.nn.functional.pad(x, flat)

kernel_name = 'gated_mix__sliding_local_dilated__dense_activation_relu__prompt'

def setup_inputs():

    _w = (lambda a: (lambda t: t.to(torch.bfloat16) if t.is_floating_point() else t)(torch.as_tensor(a)))
    def _A_setup():
        B, S, D = 1, 2048, 640
        return {
            "x": _w((lambda *s: torch.randn(*s, dtype=torch.bfloat16) * 0.05)(B, S, D)),
            "wqkv": _w((lambda *s: torch.randn(*s, dtype=torch.bfloat16) * 0.8)(D, 3 * D)),
            "wo": _w((lambda *s: torch.randn(*s, dtype=torch.bfloat16) * 0.05)(D, D)),
        }
    _A_in = _A_setup()

    def _B_setup():
        B, S, D, Dff = 1, 2048, 640, 1728
        return {
            "x": _w((lambda *s: torch.randn(*s, dtype=torch.bfloat16) * 0.05)(B, S, D)),
            "w1": _w((lambda *s: torch.randn(*s, dtype=torch.bfloat16) * 0.1)(D, Dff)),
            "w2": _w((lambda *s: torch.randn(*s, dtype=torch.bfloat16) * 0.1)(Dff, D)),
        }
    _B_in = _B_setup()

    return {
        "A_x": _A_in["x"],
        "A_wqkv": _A_in["wqkv"],
        "A_wo": _A_in["wo"],
        "B_x": _B_in["x"],
        "B_w1": _B_in["w1"],
        "B_w2": _B_in["w2"],
        "gate_w": _w((lambda *s: torch.randn(*s, dtype=torch.bfloat16) * 0.05)(640) * 16.0),
    }

def reference(A_x, A_wqkv, A_wo, B_x, B_w1, B_w2, gate_w):
    def _A_ref(x, wqkv, wo):
        B, S, D = x.shape
        H = 32; Dh = D // H
        W, dil = 8, 2
        qkv = (lambda x, *d: x.permute(*d))((x @ wqkv).reshape(B, S, 3, H, Dh), 2, 0, 3, 1, 4)
        q, k, v = qkv[0], qkv[1], qkv[2]
        scale = Dh ** -0.5
        pos = torch.arange(S)
        off = torch.arange(W) * dil
        idx = pos[:, None] - off[None, :]
        mask = idx >= 0
        idx_c = torch.where(mask, idx, 0).reshape(-1)
        kg = k[:, :, idx_c, :].reshape(B, H, S, W, Dh)
        vg = v[:, :, idx_c, :].reshape(B, H, S, W, Dh)
        logits = torch.einsum("bhsd,bhswd->bhsw", q, kg) * scale
        logits = torch.where(mask[None, None, :, :], logits, -1e9)
        attn = _softmax(logits, axis=-1)
        o = torch.einsum("bhsw,bhswd->bhsd", attn, vg)
        return (lambda x, *d: x.permute(*d))(o, 0, 2, 1, 3).reshape(B, S, D) @ wo

    def _B_ref(x, w1, w2):
        h = torch.einsum("bsd,df->bsf", x, w1)
        zero = torch.zeros_like(h)
        h = torch.maximum(h, zero)
        return torch.einsum("bsf,fd->bsd", h, w2)

    x = A_x
    g = _sigmoid((x * gate_w).sum(-1, keepdims=True))
    a = _A_ref(x, A_wqkv, A_wo)
    b = _B_ref(x, B_w1, B_w2)
    return g * a + (1 - g) * b
```

```asm
; @launch grid=(256,1,1) block=(256,1,1) lds=163840
.amdgcn_target "amdgcn-amd-amdhsa--gfx950"
.text
.globl gated_mix__sliding_local_dilated__dense_activation_relu__prompt_kernel
.p2align 8
.type gated_mix__sliding_local_dilated__dense_activation_relu__prompt_kernel,@function
gated_mix__sliding_local_dilated__dense_activation_relu__prompt_kernel:
  s_lshr_b32 s3, s2, 8
  s_cbranch_scc1 Lend
  s_load_dwordx8 s[36:43], s[0:1], 0
  s_load_dwordx8 s[44:51], s[0:1], 32
  s_getpc_b64 s[16:17]
Lpc:
  v_lshlrev_b32 v26, 7, v0
  v_min_u32 v26, LvA5-Lpc, v26
  global_load_dword a254, v26, s[16:17]
  s_load_dwordx4 s[52:55], s[0:1], 64
  s_lshl_b32 s57, s2, 2
  s_add_u32 s57, s57, Ltab-Lpc
  s_load_dword s56, s[16:17], s57
  v_lshl_add_u32 v40, s2, 8, v0
  v_lshrrev_b32 v40, 5, v40
  v_and_b32 v41, 31, v0
  v_mul_u32_u24 v42, 1280, v40
  v_lshl_add_u32 v42, v41, 7, v42
  v_mul_u32_u24 v40, 512, v40
  v_lshl_add_u32 v40, v41, 7, v40
  v_lshrrev_b32 v3, 6, v0
  v_and_b32 v1, 63, v0
  v_readfirstlane_b32 s20, v3
  v_lshrrev_b32 v2, 4, v1
  v_and_b32 v3, 15, v0
  s_and_b32 s60, s2, 7
  s_lshr_b32 s61, s2, 3
  s_lshr_b32 s62, s60, 2
  s_and_b32 s63, s60, 3
  s_lshr_b32 s64, s20, 1
  s_and_b32 s65, s20, 1
  s_movk_i32 s59, 1280
  v_lshrrev_b32 v32, 2, v1
  v_and_b32 v32, 14, v32
  v_and_b32 v33, 7, v1
  v_xor_b32 v33, v33, v2
  v_lshlrev_b32 v33, 4, v33
  v_xor_b32 v34, 64, v33
  s_mov_b32 s7, 0x20000
  s_mov_b32 s11, 0x20000
  s_mov_b32 exec_lo, 15
  s_mov_b32 exec_hi, 15
  s_waitcnt lgkmcnt(0)
  global_load_dword a247, v42, s[36:37]
  global_load_dword a246, v40, s[38:39]
  global_load_dword a245, v40, s[44:45]
  s_mov_b64 exec, -1
  s_cmp_ge_u32 s61, 18
  s_cbranch_scc1 LdecF
  s_mov_b32 s21, 1
  s_mul_i32 s22, s62, 9
  s_lshr_b32 s57, s61, 1
  s_add_u32 s22, s22, s57
  s_lshl_b32 s23, s63, 1
  s_and_b32 s57, s61, 1
  s_add_u32 s23, s23, s57
  s_mul_i32 s71, s22, 114
  s_sub_u32 s71, s71, 14
  s_movk_i32 s18, 3840
  s_lshl_b32 s70, s22, 3
  s_add_u32 s70, s70, s23
  s_add_u32 s70, s70, 112
  s_mul_i32 s19, s23, 160
  s_mov_b32 s66, 29
  s_movk_i32 s67, 70
  s_branch Ldec2
LdecF:
  s_mov_b32 s21, 0
  s_mul_i32 s57, s63, 12
  s_add_u32 s57, s57, s61
  s_sub_u32 s57, s57, 18
  s_lshl_b32 s58, s63, 1
  s_add_u32 s58, s58, s61
  s_add_u32 s58, s58, 18
  s_cmp_ge_u32 s61, 30
  s_cselect_b32 s57, s58, s57
  s_lshr_b32 s23, s57, 3
  s_and_b32 s57, s57, 7
  s_lshl_b32 s22, s62, 3
  s_add_u32 s22, s22, s57
  s_lshl_b32 s71, s22, 7
  s_movk_i32 s18, 3456
  s_mul_i32 s70, s22, 7
  s_add_u32 s70, s70, s23
  s_lshl_b32 s19, s23, 9
  s_cmp_eq_u32 s23, 6
  s_cselect_b32 s66, 23, 31
  s_mov_b32 s67, 0
Ldec2:
  s_lshl_b32 s57, s65, 6
  s_add_u32 s57, s57, s64
  s_add_u32 s57, s57, s71
  s_movk_i32 s58, 2047
  v_add_u32 v32, s57, v32
  v_add_u32 v35, 0, v32
  v_med3_i32 v35, v35, 0, s58
  v_mad_u32_u24 v35, v35, s59, v33
  v_add_u32 v14, 4096, v35
  v_add_u32 v35, 16, v32
  v_med3_i32 v35, v35, 0, s58
  v_mad_u32_u24 v35, v35, s59, v34
  v_add_u32 v15, 3072, v35
  v_add_u32 v35, 32, v32
  v_med3_i32 v35, v35, 0, s58
  v_mad_u32_u24 v35, v35, s59, v33
  v_add_u32 v16, 2048, v35
  v_add_u32 v35, 48, v32
  v_med3_i32 v35, v35, 0, s58
  v_mad_u32_u24 v35, v35, s59, v34
  v_add_u32 v17, 1024, v35
  s_lshl_b32 s31, s18, 6
  s_cmp_eq_u32 s21, 0
  s_cselect_b32 s25, 1, 1
  s_mul_i32 s25, s25, s23
  s_add_u32 s24, s22, s25
  s_mul_i32 s25, s24, 32768
  s_lshr_b32 s25, s25, 16
  s_mul_i32 s25, s25, 2
  s_sub_u32 s24, s24, s25
  s_lshl_b32 s24, s24, 2
  s_mov_b32 s26, 16
  s_mov_b32 s27, 0
  s_lshr_b64 s[24:25], s[26:27], s24
  s_and_b32 s24, s24, 15
  s_mul_i32 s25, s24, s31
  s_lshl_b32 s24, s24, 7
  s_mov_b32 s30, s24
  s_movk_i32 s80, 1280
  s_movk_i32 s81, 1280
  s_mul_i32 s82, s31, 10
  s_mov_b32 s83, s82
  s_movk_i32 s26, 128
  s_mul_i32 s33, s20, 40960
  s_mov_b32 s27, s33
  s_add_u32 s32, s33, 36864
  s_mov_b32 s6, 2625536
  s_mul_i32 s10, s18, 640
  s_add_u32 s10, s10, 4096
  s_cmp_eq_u32 s21, 0
  s_waitcnt lgkmcnt(0)
  s_cselect_b32 s8, s44, s38
  s_cselect_b32 s9, s45, s39
  s_sub_u32 s4, s36, 4096
  s_subb_u32 s5, s37, 0
  s_sub_u32 s8, s8, 4096
  s_subb_u32 s9, s9, 0
  s_cmp_lg_u32 s66, 23
  s_cbranch_scc1 Lng
  s_mov_b32 s76, s48
  s_mov_b32 s77, s49
  s_mov_b32 s78, 1280
  s_mov_b32 s79, 0x20000
  s_add_u32 m0, s33, 36864
  v_lshlrev_b32 v32, 4, v1
  buffer_load_dwordx4 v32, s[76:79], 0 offen lds
  s_mov_b64 exec, 0xffff
  buffer_load_dwordx4 v32, s[76:79], 0 offen offset:1024 lds
  s_add_u32 m0, m0, 1280
  s_nop 0
  buffer_load_dwordx4 v32, s[76:79], 0 offen offset:1024 lds
  s_mov_b64 exec, -1
  buffer_load_dwordx4 v32, s[76:79], 0 offen lds
  s_mov_b32 s12, s54
  s_mov_b32 s13, s55
  s_mov_b32 s14, 11567104
  s_mov_b32 s15, 0x20000
  s_cmp_lg_u32 s70, 6
  s_cbranch_scc1 Lsn1
  s_cmp_lg_u32 s20, 1
  s_cbranch_scc1 Lsn1
  v_lshlrev_b32 v52, 9, v1
  v_add_u32 v52, 11534336, v52
  buffer_load_dword v48, v52, s[12:15], 0 offen offset:0 sc1
  buffer_load_dword v49, v52, s[12:15], 0 offen offset:128 sc1
  buffer_load_dword v50, v52, s[12:15], 0 offen offset:256 sc1
  buffer_load_dword v51, v52, s[12:15], 0 offen offset:384 sc1
Lsn1:
Lng:
  s_mov_b32 m0, s27
  s_nop 0
  buffer_load_dwordx4 v14, s[4:7], s24 offen offset:0 lds
  buffer_load_dwordx4 v15, s[4:7], s24 offen offset:1024 lds
  buffer_load_dwordx4 v16, s[4:7], s24 offen offset:2048 lds
  buffer_load_dwordx4 v17, s[4:7], s24 offen offset:3072 lds
  v_lshrrev_b32 v32, 5, v1
  v_and_b32 v33, 31, v1
  v_lshlrev_b32 v34, 1, v32
  v_xor_b32 v33, v33, v34
  s_lshl_b32 s57, s65, 3
  v_xor_b32 v33, s57, v33
  s_lshl_b32 s57, s20, 3
  s_mul_i32 s57, s57, s18
  s_add_u32 s57, s57, s19
  s_add_u32 s57, s57, 4096
  v_mul_u32_u24 v32, s18, v32
  v_add_u32 v32, s57, v32
  s_lshl_b32 s58, s18, 1
  s_sub_u32 s58, s58, 1024
  s_lshl_b32 s59, s58, 1
  s_lshl_b32 s57, s18, 5
  v_xor_b32 v34, 0, v33
  v_min_u32 v34, s66, v34
  v_mul_u32_u24 v35, 26, v34
  v_lshrrev_b32 v35, 8, v35
  v_mad_u32_u24 v34, v35, s67, v34
  v_lshl_add_u32 v18, v34, 4, v32
  v_xor_b32 v34, 4, v33
  v_min_u32 v34, s66, v34
  v_mul_u32_u24 v35, 26, v34
  v_lshrrev_b32 v35, 8, v35
  v_mad_u32_u24 v34, v35, s67, v34
  v_lshl_add_u32 v19, v34, 4, v32
  v_add_u32 v19, s58, v19
  v_add_u32 v20, s59, v18
  v_add_u32 v21, s59, v19
  v_add_u32 v22, s57, v18
  v_add_u32 v23, s57, v19
  v_add_u32 v24, s57, v20
  v_add_u32 v25, s57, v21
  s_add_u32 m0, m0, 4096
  s_nop 0
  buffer_load_dwordx4 v18, s[8:11], s25 offen offset:0 lds
  buffer_load_dwordx4 v19, s[8:11], s25 offen offset:1024 lds
  buffer_load_dwordx4 v20, s[8:11], s25 offen offset:2048 lds
  s_mov_b32 s12, s54
  s_mov_b32 s13, s55
  s_mov_b32 s14, 11567104
  s_mov_b32 s15, 0x20000
  s_mov_b64 s[18:19], s[44:45]
  s_mov_b32 s44, s46
  s_mov_b32 s45, s47
  s_mov_b32 s46, 2211840
  s_mov_b32 s47, 0x20000
  buffer_load_dwordx4 v21, s[8:11], s25 offen offset:3072 lds
  s_mov_b32 s72, s52
  s_mov_b32 s73, s53
  s_mov_b32 s74, 256
  s_mov_b32 s75, 0x20000
  s_mul_i32 s57, s64, 81920
  v_lshl_add_u32 v32, v3, 7, s57
  v_lshrrev_b32 v33, 1, v3
  v_xor_b32 v33, v33, v2
  v_lshl_add_u32 v4, v33, 4, v32
  s_add_u32 m0, m0, 4096
  s_nop 0
  buffer_load_dwordx4 v22, s[8:11], s25 offen offset:0 lds
  v_xor_b32 v5, 64, v4
  v_bfe_u32 v35, v1, 2, 2
  v_mul_u32_u24 v44, 40960, v2
  v_lshl_add_u32 v44, v35, 9, v44
  v_add_u32 v44, 4096, v44
  v_and_b32 v45, 1, v2
  v_lshl_add_u32 v45, v45, 2, v35
  v_lshlrev_b32 v45, 5, v45
  v_lshrrev_b32 v32, 3, v1
  buffer_load_dwordx4 v23, s[8:11], s25 offen offset:1024 lds
  v_and_b32 v33, 7, v1
  v_lshlrev_b32 v34, 1, v2
  v_xor_b32 v33, v33, v34
  s_bfe_u32 s57, s56, 0x4000a
  s_lshl_b32 s57, s57, 7
  s_add_u32 s57, s57, 4096
  v_lshl_add_u32 v33, v33, 4, s57
  v_mul_u32_u24 v32, 1280, v32
  v_add_u32 v28, v32, v33
  buffer_load_dwordx4 v24, s[8:11], s25 offen offset:2048 lds
  v_lshrrev_b32 v32, 5, v1
  v_mul_u32_u24 v32, 46080, v32
  v_add_u32 v32, v32, v28
  v_add_u32 v29, 9216, v28
  v_add_u32 v30, 18432, v28
  v_add_u32 v31, 27648, v28
  v_add_u32 v100, 20480, v32
  v_add_u32 v101, 121856, v32
  v_add_u32 v102, 44032, v32
  buffer_load_dwordx4 v25, s[8:11], s25 offen offset:3072 lds
  v_add_u32 v103, 145408, v32
  v_lshrrev_b32 v32, 2, v1
  v_lshl_add_u32 v33, v32, 7, s33
  v_and_b32 v34, 3, v1
  v_lshl_add_u32 v33, v34, 3, v33
  v_bfe_u32 v34, v32, 1, 2
  v_lshl_add_u32 v96, v34, 5, v33
  v_xor_b32 v97, 32, v96
  v_xor_b32 v98, 64, v96
  s_add_u32 s24, s24, s26
  s_cmp_ge_u32 s24, s80
  s_cselect_b32 s34, s81, 0
  s_sub_u32 s24, s24, s34
  s_add_u32 s27, s27, 12288
  s_cmp_eq_u32 s27, s32
  s_cselect_b32 s27, s33, s27
  s_add_u32 s25, s25, s31
  s_cmp_ge_u32 s25, s82
  s_cselect_b32 s34, s83, 0
  s_sub_u32 s25, s25, s34
  s_mov_b32 m0, s27
  s_nop 0
  buffer_load_dwordx4 v14, s[4:7], s24 offen offset:0 lds
  v_xor_b32 v99, 96, v96
  s_mul_i32 s62, s20, 13
  s_min_u32 s57, s20, 1
  s_add_u32 s62, s62, s57
  s_lshr_b32 s57, s62, 3
  s_add_u32 s58, s62, 13
  s_lshr_b32 s58, s58, 3
  v_and_b32 v32, 7, v1
  v_add_u32 v32, s57, v32
  buffer_load_dwordx4 v15, s[4:7], s24 offen offset:1024 lds
  v_min_u32 v32, s58, v32
  v_cmp_gt_u32 vcc, 32, v1
  s_bfe_u32 s57, s56, 0x4000e
  s_bfe_u32 s58, s56, 0x40012
  v_cndmask_b32 v32, 6, v32, vcc
  v_bfe_u32 v33, v1, 3, 1
  v_add_u32 v33, s57, v33
  v_min_u32 v33, s58, v33
  v_mad_u32_u24 v32, v33, 7, v32
  buffer_load_dwordx4 v16, s[4:7], s24 offen offset:2048 lds
  s_bfe_u32 s57, s56, 0x50016
  s_lshr_b32 s58, s56, 27
  v_bfe_u32 v33, v1, 1, 3
  v_add_u32 v33, s57, v33
  v_min_u32 v33, s58, v33
  s_lshl_b32 s57, s20, 1
  s_add_u32 s57, s57, 112
  v_lshl_add_u32 v33, v33, 3, s57
  v_and_b32 v34, 1, v1
  buffer_load_dwordx4 v17, s[4:7], s24 offen offset:3072 lds
  v_add_u32 v33, v33, v34
  v_cmp_eq_u32 vcc, 1, v2
  v_mov_b32 v34, s70
  s_nop 0
  v_cndmask_b32 v32, v32, v33, vcc
  v_cmp_eq_u32 vcc, 3, v2
  s_bfe_u32 s57, s56, 0x30007
  s_nop 0
  v_cndmask_b32 v105, v32, v34, vcc
  v_lshlrev_b32 v104, 7, v105
  v_add_u32 v104, 11534336, v104
  s_add_u32 m0, m0, 4096
  s_nop 0
  buffer_load_dwordx4 v18, s[8:11], s25 offen offset:0 lds
  s_and_b32 s58, s56, 127
  s_mul_i32 s58, s58, 13
  s_lshr_b32 s58, s58, 6
  s_bfe_u32 s59, s56, 0x4000a
  s_add_u32 s58, s58, s59
  s_mul_i32 s59, s58, 32768
  s_lshr_b32 s59, s59, 16
  s_mul_i32 s59, s59, 2
  s_sub_u32 s58, s58, s59
  buffer_load_dwordx4 v19, s[8:11], s25 offen offset:1024 lds
  s_lshl_b32 s58, s58, 2
  s_lshr_b32 s71, 112, s58
  s_and_b32 s71, s71, 15
  s_mov_b32 s58, LvA5-Lpc
  s_cmp_eq_u32 s21, 0
  s_cselect_b32 s58, LvF5-Lpc, s58
  s_cmp_eq_u32 s57, 4
  s_cselect_b32 s58, LvA4-Lpc, s58
  s_cmp_eq_u32 s57, 6
  s_cselect_b32 s58, LvN6-Lpc, s58
  v_lshl_add_u32 v26, v0, 5, s58
  v_min_u32 v26, Ltab-Lpc, v26
  s_add_u32 s24, s24, s26
  s_cmp_ge_u32 s24, s80
  s_cselect_b32 s34, s81, 0
  s_sub_u32 s24, s24, s34
  s_add_u32 s27, s27, 12288
  s_cmp_eq_u32 s27, s32
  s_cselect_b32 s27, s33, s27
  s_cmp_eq_u32 s21, 0
  s_cbranch_scc1 LroleF
  s_mul_i32 s57, s65, 80
  v_add_u32 v32, s57, v44
  v_and_b32 v35, 3, v1
  v_lshl_add_u32 v33, v35, 3, v32
  v_and_b32 v34, 1, v1
  v_mad_u32_u24 v32, v34, 40, v32
  v_bfe_u32 v34, v1, 1, 1
  v_mul_u32_u24 v34, 160, v34
  v_add_u32 v34, v34, v32
  v_add_u32 v6, 0, v33
  v_xor_b32 v6, v6, v45
  v_add_u32 v7, 40, v33
  v_xor_b32 v7, v7, v45
  v_add_u32 v8, 160, v33
  v_xor_b32 v8, v8, v45
  v_add_u32 v9, 200, v33
  v_xor_b32 v9, v9, v45
  v_add_u32 v10, 32, v34
  v_xor_b32 v10, v10, v45
  v_add_u32 v11, 320, v33
  v_xor_b32 v11, v11, v45
  v_add_u32 v12, 360, v33
  v_xor_b32 v12, v12, v45
  v_add_u32 v13, 352, v32
  v_xor_b32 v13, v13, v45
  v_mov_b32 v32, 0xf149f2ca
  s_cmp_eq_u32 s22, 0
  s_cselect_b32 s57, 7, 0
  v_lshl_add_u32 v33, v2, 2, 0
  v_sub_u32 v34, v3, v33
  v_cmp_gt_u32 vcc, 8, v34
  v_cmp_gt_i32 s[66:67], -8, v34
  v_cmp_le_u32 s[58:59], s57, v33
  v_cndmask_b32 v106, v32, 0, vcc
  v_cmp_le_i32 vcc, 0, v34
  v_cndmask_b32 v110, v32, 0, s[66:67]
  v_cndmask_b32 v114, v32, v106, s[58:59]
  v_cndmask_b32 v35, 0, -1, vcc
  v_lshl_add_u32 v33, v2, 2, 1
  v_sub_u32 v34, v3, v33
  v_cmp_gt_u32 vcc, 8, v34
  v_cmp_gt_i32 s[66:67], -8, v34
  v_cmp_le_u32 s[58:59], s57, v33
  v_cndmask_b32 v107, v32, 0, vcc
  v_cmp_le_i32 vcc, 0, v34
  v_cndmask_b32 v111, v32, 0, s[66:67]
  v_cndmask_b32 v115, v32, v107, s[58:59]
  v_cndmask_b32 v36, 0, -1, vcc
  v_lshlrev_b32 v36, 16, v36
  v_and_b32 v35, 0xffff, v35
  v_or_b32 v118, v35, v36
  v_lshl_add_u32 v33, v2, 2, 2
  v_sub_u32 v34, v3, v33
  v_cmp_gt_u32 vcc, 8, v34
  v_cmp_gt_i32 s[66:67], -8, v34
  v_cmp_le_u32 s[58:59], s57, v33
  v_cndmask_b32 v108, v32, 0, vcc
  v_cmp_le_i32 vcc, 0, v34
  v_cndmask_b32 v112, v32, 0, s[66:67]
  v_cndmask_b32 v116, v32, v108, s[58:59]
  v_cndmask_b32 v35, 0, -1, vcc
  v_lshl_add_u32 v33, v2, 2, 3
  v_sub_u32 v34, v3, v33
  v_cmp_gt_u32 vcc, 8, v34
  v_cmp_gt_i32 s[66:67], -8, v34
  v_cmp_le_u32 s[58:59], s57, v33
  v_cndmask_b32 v109, v32, 0, vcc
  v_cmp_le_i32 vcc, 0, v34
  v_cndmask_b32 v113, v32, 0, s[66:67]
  v_cndmask_b32 v117, v32, v109, s[58:59]
  v_cndmask_b32 v36, 0, -1, vcc
  v_lshlrev_b32 v36, 16, v36
  v_and_b32 v35, 0xffff, v35
  v_or_b32 v119, v35, v36
  s_mov_b32 s28, 9
  s_mov_b32 s29, 12288
  s_add_u32 s35, s33, 24576
  s_mov_b32 s69, s29
  s_mov_b32 s68, 4294942720
  s_waitcnt vmcnt(6)
  s_barrier
  ds_read_b128 a[0:3], v4 offset:0
  ds_read_b128 a[4:7], v4 offset:2048
  ds_read_b128 a[8:11], v4 offset:40960
  ds_read_b128 a[12:15], v4 offset:43008
  ds_read_b64_tr_b16 a[16:17], v6 offset:0
  ds_read_b64_tr_b16 a[18:19], v6 offset:2048
  ds_read_b64_tr_b16 a[20:21], v7 offset:0
  ds_read_b64_tr_b16 a[22:23], v7 offset:2048
  ds_read_b64_tr_b16 a[24:25], v8 offset:0
  ds_read_b64_tr_b16 a[26:27], v8 offset:2048
  ds_read_b64_tr_b16 a[28:29], v9 offset:0
  ds_read_b64_tr_b16 a[30:31], v9 offset:2048
  ds_read_b64_tr_b16 a[32:33], v10 offset:0
  ds_read_b64_tr_b16 a[34:35], v10 offset:2048
  ds_read_b64_tr_b16 a[36:37], v11 offset:0
  ds_read_b64_tr_b16 a[38:39], v11 offset:2048
  ds_read_b64_tr_b16 a[40:41], v12 offset:0
  ds_read_b64_tr_b16 a[42:43], v12 offset:2048
  ds_read_b64_tr_b16 a[44:45], v13 offset:0
  ds_read_b64_tr_b16 a[46:47], v13 offset:2048
  s_waitcnt lgkmcnt(0)
  v_mfma_f32_16x16x32_bf16 v[128:131], a[16:19], a[0:3], 0
  ds_read_b128 a[48:51], v5 offset:0
  v_mfma_f32_16x16x32_bf16 v[132:135], a[20:23], a[0:3], 0
  ds_read_b128 a[52:55], v5 offset:2048
  buffer_load_dwordx4 v20, s[8:11], s25 offen offset:2048 lds
  v_add_u32 v4, s29, v4
  v_mfma_f32_16x16x32_bf16 v[136:139], a[24:27], a[0:3], 0
  ds_read_b128 a[56:59], v5 offset:40960
  v_mfma_f32_16x16x32_bf16 v[140:143], a[28:31], a[0:3], 0
  ds_read_b128 a[60:63], v5 offset:43008
  buffer_load_dwordx4 v21, s[8:11], s25 offen offset:3072 lds
  v_mfma_f32_16x16x32_bf16 v[144:147], a[32:35], a[0:3], 0
  ds_read_b64_tr_b16 a[64:65], v6 offset:4096
  v_add_u32 v5, s29, v5
  v_mfma_f32_16x16x32_bf16 v[148:151], a[0:3], a[36:39], 0
  ds_read_b64_tr_b16 a[66:67], v6 offset:6144
  s_add_u32 m0, m0, 4096
  s_nop 0
  buffer_load_dwordx4 v22, s[8:11], s25 offen offset:0 lds
  v_mfma_f32_16x16x32_bf16 v[152:155], a[0:3], a[40:43], 0
  ds_read_b64_tr_b16 a[68:69], v7 offset:4096
  v_add_u32 v6, s29, v6
  v_mfma_f32_16x16x32_bf16 v[156:159], a[0:3], a[44:47], 0
  ds_read_b64_tr_b16 a[70:71], v7 offset:6144
  buffer_load_dwordx4 v23, s[8:11], s25 offen offset:1024 lds
  v_mfma_f32_16x16x32_bf16 v[160:163], a[16:19], a[4:7], 0
  ds_read_b64_tr_b16 a[72:73], v8 offset:4096
  v_add_u32 v7, s29, v7
  v_mfma_f32_16x16x32_bf16 v[164:167], a[20:23], a[4:7], 0
  ds_read_b64_tr_b16 a[74:75], v8 offset:6144
  buffer_load_dwordx4 v24, s[8:11], s25 offen offset:2048 lds
  v_mfma_f32_16x16x32_bf16 v[168:171], a[24:27], a[4:7], 0
  ds_read_b64_tr_b16 a[76:77], v9 offset:4096
  v_add_u32 v8, s29, v8
  v_mfma_f32_16x16x32_bf16 v[172:175], a[28:31], a[4:7], 0
  ds_read_b64_tr_b16 a[78:79], v9 offset:6144
  v_mfma_f32_16x16x32_bf16 v[176:179], a[32:35], a[4:7], 0
  ds_read_b64_tr_b16 a[80:81], v10 offset:4096
  buffer_load_dwordx4 v25, s[8:11], s25 offen offset:3072 lds
  s_add_u32 s25, s25, s31
  s_cmp_ge_u32 s25, s82
  s_cselect_b32 s34, s83, 0
  s_sub_u32 s25, s25, s34
  v_add_u32 v9, s29, v9
  v_mfma_f32_16x16x32_bf16 v[180:183], a[4:7], a[36:39], 0
  ds_read_b64_tr_b16 a[82:83], v10 offset:6144
  v_mfma_f32_16x16x32_bf16 v[184:187], a[4:7], a[40:43], 0
  ds_read_b64_tr_b16 a[84:85], v11 offset:4096
  s_mov_b32 m0, s27
  s_nop 0
  buffer_load_dwordx4 v14, s[4:7], s24 offen offset:0 lds
  v_add_u32 v10, s29, v10
  v_mfma_f32_16x16x32_bf16 v[188:191], a[4:7], a[44:47], 0
  ds_read_b64_tr_b16 a[86:87], v11 offset:6144
  v_mfma_f32_16x16x32_bf16 v[192:195], a[16:19], a[8:11], 0
  ds_read_b64_tr_b16 a[88:89], v12 offset:4096
  buffer_load_dwordx4 v15, s[4:7], s24 offen offset:1024 lds
  v_add_u32 v11, s29, v11
  v_mfma_f32_16x16x32_bf16 v[196:199], a[20:23], a[8:11], 0
  ds_read_b64_tr_b16 a[90:91], v12 offset:6144
  v_mfma_f32_16x16x32_bf16 v[200:203], a[24:27], a[8:11], 0
  ds_read_b64_tr_b16 a[92:93], v13 offset:4096
  buffer_load_dwordx4 v16, s[4:7], s24 offen offset:2048 lds
  v_add_u32 v12, s29, v12
  v_mfma_f32_16x16x32_bf16 v[204:207], a[28:31], a[8:11], 0
  ds_read_b64_tr_b16 a[94:95], v13 offset:6144
  v_mfma_f32_16x16x32_bf16 v[208:211], a[32:35], a[8:11], 0
  v_add_u32 v13, s29, v13
  v_mfma_f32_16x16x32_bf16 v[212:215], a[8:11], a[36:39], 0
  buffer_load_dwordx4 v17, s[4:7], s24 offen offset:3072 lds
  v_mfma_f32_16x16x32_bf16 v[216:219], a[8:11], a[40:43], 0
  v_mfma_f32_16x16x32_bf16 v[220:223], a[8:11], a[44:47], 0
  s_add_u32 m0, m0, 4096
  s_nop 0
  buffer_load_dwordx4 v18, s[8:11], s25 offen offset:0 lds
  v_mfma_f32_16x16x32_bf16 v[224:227], a[16:19], a[12:15], 0
  v_mfma_f32_16x16x32_bf16 v[228:231], a[20:23], a[12:15], 0
  buffer_load_dwordx4 v19, s[8:11], s25 offen offset:1024 lds
  v_mfma_f32_16x16x32_bf16 v[232:235], a[24:27], a[12:15], 0
  v_mfma_f32_16x16x32_bf16 v[236:239], a[28:31], a[12:15], 0
  s_add_u32 s24, s24, s26
  s_cmp_ge_u32 s24, s80
  s_cselect_b32 s34, s81, 0
  s_sub_u32 s24, s24, s34
  s_add_u32 s27, s27, 12288
  s_cmp_eq_u32 s27, s32
  s_cselect_b32 s27, s33, s27
  v_mfma_f32_16x16x32_bf16 v[240:243], a[32:35], a[12:15], 0
  v_mfma_f32_16x16x32_bf16 v[244:247], a[12:15], a[36:39], 0
  v_mfma_f32_16x16x32_bf16 v[248:251], a[12:15], a[40:43], 0
  v_mfma_f32_16x16x32_bf16 v[252:255], a[12:15], a[44:47], 0
  s_waitcnt vmcnt(6) lgkmcnt(0)
  s_barrier
  v_mfma_f32_16x16x32_bf16 v[128:131], a[64:67], a[48:51], v[128:131]
  ds_read_b128 a[0:3], v4 offset:0
  v_mfma_f32_16x16x32_bf16 v[132:135], a[68:71], a[48:51], v[132:135]
  ds_read_b128 a[4:7], v4 offset:2048
  buffer_load_dwordx4 v20, s[8:11], s25 offen offset:2048 lds
  v_mfma_f32_16x16x32_bf16 v[136:139], a[72:75], a[48:51], v[136:139]
  ds_read_b128 a[8:11], v4 offset:40960
  v_mfma_f32_16x16x32_bf16 v[140:143], a[76:79], a[48:51], v[140:143]
  ds_read_b128 a[12:15], v4 offset:43008
  buffer_load_dwordx4 v21, s[8:11], s25 offen offset:3072 lds
  v_mfma_f32_16x16x32_bf16 v[144:147], a[80:83], a[48:51], v[144:147]
  ds_read_b64_tr_b16 a[16:17], v6 offset:0
  v_mfma_f32_16x16x32_bf16 v[148:151], a[48:51], a[84:87], v[148:151]
  ds_read_b64_tr_b16 a[18:19], v6 offset:2048
  s_add_u32 m0, m0, 4096
  s_nop 0
  buffer_load_dwordx4 v22, s[8:11], s25 offen offset:0 lds
  v_mfma_f32_16x16x32_bf16 v[152:155], a[48:51], a[88:91], v[152:155]
  ds_read_b64_tr_b16 a[20:21], v7 offset:0
  v_mfma_f32_16x16x32_bf16 v[156:159], a[48:51], a[92:95], v[156:159]
  ds_read_b64_tr_b16 a[22:23], v7 offset:2048
  buffer_load_dwordx4 v23, s[8:11], s25 offen offset:1024 lds
  v_mfma_f32_16x16x32_bf16 v[160:163], a[64:67], a[52:55], v[160:163]
  ds_read_b64_tr_b16 a[24:25], v8 offset:0
  v_mfma_f32_16x16x32_bf16 v[164:167], a[68:71], a[52:55], v[164:167]
  ds_read_b64_tr_b16 a[26:27], v8 offset:2048
  buffer_load_dwordx4 v24, s[8:11], s25 offen offset:2048 lds
  v_mfma_f32_16x16x32_bf16 v[168:171], a[72:75], a[52:55], v[168:171]
  ds_read_b64_tr_b16 a[28:29], v9 offset:0
  v_mfma_f32_16x16x32_bf16 v[172:175], a[76:79], a[52:55], v[172:175]
  ds_read_b64_tr_b16 a[30:31], v9 offset:2048
  buffer_load_dwordx4 v25, s[8:11], s25 offen offset:3072 lds
  s_add_u32 s25, s25, s31
  s_cmp_ge_u32 s25, s82
  s_cselect_b32 s34, s83, 0
  s_sub_u32 s25, s25, s34
  v_mfma_f32_16x16x32_bf16 v[176:179], a[80:83], a[52:55], v[176:179]
  ds_read_b64_tr_b16 a[32:33], v10 offset:0
  v_mfma_f32_16x16x32_bf16 v[180:183], a[52:55], a[84:87], v[180:183]
  ds_read_b64_tr_b16 a[34:35], v10 offset:2048
  s_mov_b32 m0, s27
  s_nop 0
  buffer_load_dwordx4 v14, s[4:7], s24 offen offset:0 lds
  v_mfma_f32_16x16x32_bf16 v[184:187], a[52:55], a[88:91], v[184:187]
  ds_read_b64_tr_b16 a[36:37], v11 offset:0
  v_mfma_f32_16x16x32_bf16 v[188:191], a[52:55], a[92:95], v[188:191]
  ds_read_b64_tr_b16 a[38:39], v11 offset:2048
  buffer_load_dwordx4 v15, s[4:7], s24 offen offset:1024 lds
  v_mfma_f32_16x16x32_bf16 v[192:195], a[64:67], a[56:59], v[192:195]
  ds_read_b64_tr_b16 a[40:41], v12 offset:0
  v_mfma_f32_16x16x32_bf16 v[196:199], a[68:71], a[56:59], v[196:199]
  ds_read_b64_tr_b16 a[42:43], v12 offset:2048
  buffer_load_dwordx4 v16, s[4:7], s24 offen offset:2048 lds
  v_mfma_f32_16x16x32_bf16 v[200:203], a[72:75], a[56:59], v[200:203]
  ds_read_b64_tr_b16 a[44:45], v13 offset:0
  v_mfma_f32_16x16x32_bf16 v[204:207], a[76:79], a[56:59], v[204:207]
  ds_read_b64_tr_b16 a[46:47], v13 offset:2048
  buffer_load_dwordx4 v17, s[4:7], s24 offen offset:3072 lds
  v_mfma_f32_16x16x32_bf16 v[208:211], a[80:83], a[56:59], v[208:211]
  v_mfma_f32_16x16x32_bf16 v[212:215], a[56:59], a[84:87], v[212:215]
  s_add_u32 m0, m0, 4096
  s_nop 0
  buffer_load_dwordx4 v18, s[8:11], s25 offen offset:0 lds
  v_mfma_f32_16x16x32_bf16 v[216:219], a[56:59], a[88:91], v[216:219]
  v_mfma_f32_16x16x32_bf16 v[220:223], a[56:59], a[92:95], v[220:223]
  buffer_load_dwordx4 v19, s[8:11], s25 offen offset:1024 lds
  v_mfma_f32_16x16x32_bf16 v[224:227], a[64:67], a[60:63], v[224:227]
  v_mfma_f32_16x16x32_bf16 v[228:231], a[68:71], a[60:63], v[228:231]
  v_lshrrev_b32 v41, 5, v0
  v_lshl_add_u32 v41, s2, 3, v41
  v_mul_u32_u24 v41, 768, v41
  v_and_b32 v40, 31, v0
  v_lshl_add_u32 v40, v40, 7, v41
  v_add_u32 v40, 1048576, v40
  v_min_u32 v41, 2211712, v40
  v_min_u32 v40, 2457472, v40
  s_mov_b32 exec_lo, 63
  s_mov_b32 exec_hi, 63
  global_load_dword a247, v42, s[36:37] offset:512
  global_load_dword a246, v40, s[38:39]
  global_load_dword a245, v41, s[18:19]
  s_mov_b64 exec, -1
  v_mfma_f32_16x16x32_bf16 v[232:235], a[72:75], a[60:63], v[232:235]
  v_mfma_f32_16x16x32_bf16 v[236:239], a[76:79], a[60:63], v[236:239]
  s_add_u32 s24, s24, s26
  s_cmp_ge_u32 s24, s80
  s_cselect_b32 s34, s81, 0
  s_sub_u32 s24, s24, s34
  s_add_u32 s27, s27, 12288
  s_cmp_eq_u32 s27, s32
  s_cselect_b32 s27, s33, s27
  s_cmp_eq_u32 s27, s35
  s_cselect_b32 s29, s68, s69
  v_mfma_f32_16x16x32_bf16 v[240:243], a[80:83], a[60:63], v[240:243]
  v_mfma_f32_16x16x32_bf16 v[244:247], a[60:63], a[84:87], v[244:247]
  v_mfma_f32_16x16x32_bf16 v[248:251], a[60:63], a[88:91], v[248:251]
  v_mfma_f32_16x16x32_bf16 v[252:255], a[60:63], a[92:95], v[252:255]
  s_waitcnt lgkmcnt(0)
Lp1loopA:
  v_mfma_f32_16x16x32_bf16 v[128:131], a[16:19], a[0:3], v[128:131]
  ds_read_b128 a[48:51], v5 offset:0
  v_add_u32 v4, s29, v4
  v_mfma_f32_16x16x32_bf16 v[132:135], a[20:23], a[0:3], v[132:135]
  ds_read_b128 a[52:55], v5 offset:2048
  v_mfma_f32_16x16x32_bf16 v[136:139], a[24:27], a[0:3], v[136:139]
  ds_read_b128 a[56:59], v5 offset:40960
  v_mfma_f32_16x16x32_bf16 v[140:143], a[28:31], a[0:3], v[140:143]
  ds_read_b128 a[60:63], v5 offset:43008
  v_mfma_f32_16x16x32_bf16 v[144:147], a[32:35], a[0:3], v[144:147]
  buffer_load_dwordx4 v20, s[8:11], s25 offen offset:2048 lds
  v_mfma_f32_16x16x32_bf16 v[148:151], a[0:3], a[36:39], v[148:151]
  ds_read_b64_tr_b16 a[64:65], v6 offset:4096
  v_add_u32 v5, s29, v5
  v_mfma_f32_16x16x32_bf16 v[152:155], a[0:3], a[40:43], v[152:155]
  ds_read_b64_tr_b16 a[66:67], v6 offset:6144
  v_mfma_f32_16x16x32_bf16 v[156:159], a[0:3], a[44:47], v[156:159]
  ds_read_b64_tr_b16 a[68:69], v7 offset:4096
  v_add_u32 v6, s29, v6
  v_mfma_f32_16x16x32_bf16 v[160:163], a[16:19], a[4:7], v[160:163]
  ds_read_b64_tr_b16 a[70:71], v7 offset:6144
  v_mfma_f32_16x16x32_bf16 v[164:167], a[20:23], a[4:7], v[164:167]
  buffer_load_dwordx4 v21, s[8:11], s25 offen offset:3072 lds
  v_mfma_f32_16x16x32_bf16 v[168:171], a[24:27], a[4:7], v[168:171]
  ds_read_b64_tr_b16 a[72:73], v8 offset:4096
  v_add_u32 v7, s29, v7
  v_mfma_f32_16x16x32_bf16 v[172:175], a[28:31], a[4:7], v[172:175]
  ds_read_b64_tr_b16 a[74:75], v8 offset:6144
  v_mfma_f32_16x16x32_bf16 v[176:179], a[32:35], a[4:7], v[176:179]
  ds_read_b64_tr_b16 a[76:77], v9 offset:4096
  v_add_u32 v8, s29, v8
  v_mfma_f32_16x16x32_bf16 v[180:183], a[4:7], a[36:39], v[180:183]
  s_add_u32 m0, m0, 4096
  ds_read_b64_tr_b16 a[78:79], v9 offset:6144
  v_mfma_f32_16x16x32_bf16 v[184:187], a[4:7], a[40:43], v[184:187]
  buffer_load_dwordx4 v22, s[8:11], s25 offen offset:0 lds
  v_mfma_f32_16x16x32_bf16 v[188:191], a[4:7], a[44:47], v[188:191]
  ds_read_b64_tr_b16 a[80:81], v10 offset:4096
  v_add_u32 v9, s29, v9
  v_mfma_f32_16x16x32_bf16 v[192:195], a[16:19], a[8:11], v[192:195]
  ds_read_b64_tr_b16 a[82:83], v10 offset:6144
  v_mfma_f32_16x16x32_bf16 v[196:199], a[20:23], a[8:11], v[196:199]
  ds_read_b64_tr_b16 a[84:85], v11 offset:4096
  v_add_u32 v10, s29, v10
  v_mfma_f32_16x16x32_bf16 v[200:203], a[24:27], a[8:11], v[200:203]
  ds_read_b64_tr_b16 a[86:87], v11 offset:6144
  v_mfma_f32_16x16x32_bf16 v[204:207], a[28:31], a[8:11], v[204:207]
  buffer_load_dwordx4 v23, s[8:11], s25 offen offset:1024 lds
  v_mfma_f32_16x16x32_bf16 v[208:211], a[32:35], a[8:11], v[208:211]
  ds_read_b64_tr_b16 a[88:89], v12 offset:4096
  v_add_u32 v11, s29, v11
  v_mfma_f32_16x16x32_bf16 v[212:215], a[8:11], a[36:39], v[212:215]
  ds_read_b64_tr_b16 a[90:91], v12 offset:6144
  v_mfma_f32_16x16x32_bf16 v[216:219], a[8:11], a[40:43], v[216:219]
  ds_read_b64_tr_b16 a[92:93], v13 offset:4096
  v_add_u32 v12, s29, v12
  v_mfma_f32_16x16x32_bf16 v[220:223], a[8:11], a[44:47], v[220:223]
  buffer_load_dwordx4 v24, s[8:11], s25 offen offset:2048 lds
  v_mfma_f32_16x16x32_bf16 v[224:227], a[16:19], a[12:15], v[224:227]
  ds_read_b64_tr_b16 a[94:95], v13 offset:6144
  v_mfma_f32_16x16x32_bf16 v[228:231], a[20:23], a[12:15], v[228:231]
  v_add_u32 v13, s29, v13
  v_mfma_f32_16x16x32_bf16 v[232:235], a[24:27], a[12:15], v[232:235]
  buffer_load_dwordx4 v25, s[8:11], s25 offen offset:3072 lds
  v_mfma_f32_16x16x32_bf16 v[236:239], a[28:31], a[12:15], v[236:239]
  s_add_u32 s25, s25, s31
  s_cmp_ge_u32 s25, s82
  v_mfma_f32_16x16x32_bf16 v[240:243], a[32:35], a[12:15], v[240:243]
  s_cselect_b32 s34, s83, 0
  s_sub_u32 s25, s25, s34
  v_mfma_f32_16x16x32_bf16 v[244:247], a[12:15], a[36:39], v[244:247]
  s_cmp_eq_u32 s28, 3
  s_cbranch_scc1 LswA
LswbA:
  v_mfma_f32_16x16x32_bf16 v[248:251], a[12:15], a[40:43], v[248:251]
  v_mfma_f32_16x16x32_bf16 v[252:255], a[12:15], a[44:47], v[252:255]
  s_waitcnt vmcnt(12) lgkmcnt(0)
  s_barrier
  v_mfma_f32_16x16x32_bf16 v[128:131], a[64:67], a[48:51], v[128:131]
  ds_read_b128 a[0:3], v4 offset:0
  v_mfma_f32_16x16x32_bf16 v[132:135], a[68:71], a[48:51], v[132:135]
  ds_read_b128 a[4:7], v4 offset:2048
  v_mfma_f32_16x16x32_bf16 v[136:139], a[72:75], a[48:51], v[136:139]
  ds_read_b128 a[8:11], v4 offset:40960
  v_mfma_f32_16x16x32_bf16 v[140:143], a[76:79], a[48:51], v[140:143]
  s_mov_b32 m0, s27
  ds_read_b128 a[12:15], v4 offset:43008
  v_mfma_f32_16x16x32_bf16 v[144:147], a[80:83], a[48:51], v[144:147]
  buffer_load_dwordx4 v14, s[4:7], s24 offen offset:0 lds
  v_mfma_f32_16x16x32_bf16 v[148:151], a[48:51], a[84:87], v[148:151]
  ds_read_b64_tr_b16 a[16:17], v6 offset:0
  v_mfma_f32_16x16x32_bf16 v[152:155], a[48:51], a[88:91], v[152:155]
  ds_read_b64_tr_b16 a[18:19], v6 offset:2048
  v_mfma_f32_16x16x32_bf16 v[156:159], a[48:51], a[92:95], v[156:159]
  ds_read_b64_tr_b16 a[20:21], v7 offset:0
  v_mfma_f32_16x16x32_bf16 v[160:163], a[64:67], a[52:55], v[160:163]
  ds_read_b64_tr_b16 a[22:23], v7 offset:2048
  v_mfma_f32_16x16x32_bf16 v[164:167], a[68:71], a[52:55], v[164:167]
  buffer_load_dwordx4 v15, s[4:7], s24 offen offset:1024 lds
  v_mfma_f32_16x16x32_bf16 v[168:171], a[72:75], a[52:55], v[168:171]
  ds_read_b64_tr_b16 a[24:25], v8 offset:0
  v_mfma_f32_16x16x32_bf16 v[172:175], a[76:79], a[52:55], v[172:175]
  ds_read_b64_tr_b16 a[26:27], v8 offset:2048
  v_mfma_f32_16x16x32_bf16 v[176:179], a[80:83], a[52:55], v[176:179]
  ds_read_b64_tr_b16 a[28:29], v9 offset:0
  v_mfma_f32_16x16x32_bf16 v[180:183], a[52:55], a[84:87], v[180:183]
  ds_read_b64_tr_b16 a[30:31], v9 offset:2048
  v_mfma_f32_16x16x32_bf16 v[184:187], a[52:55], a[88:91], v[184:187]
  buffer_load_dwordx4 v16, s[4:7], s24 offen offset:2048 lds
  v_mfma_f32_16x16x32_bf16 v[188:191], a[52:55], a[92:95], v[188:191]
  ds_read_b64_tr_b16 a[32:33], v10 offset:0
  v_mfma_f32_16x16x32_bf16 v[192:195], a[64:67], a[56:59], v[192:195]
  ds_read_b64_tr_b16 a[34:35], v10 offset:2048
  v_mfma_f32_16x16x32_bf16 v[196:199], a[68:71], a[56:59], v[196:199]
  ds_read_b64_tr_b16 a[36:37], v11 offset:0
  v_mfma_f32_16x16x32_bf16 v[200:203], a[72:75], a[56:59], v[200:203]
  ds_read_b64_tr_b16 a[38:39], v11 offset:2048
  v_mfma_f32_16x16x32_bf16 v[204:207], a[76:79], a[56:59], v[204:207]
  buffer_load_dwordx4 v17, s[4:7], s24 offen offset:3072 lds
  v_mfma_f32_16x16x32_bf16 v[208:211], a[80:83], a[56:59], v[208:211]
  ds_read_b64_tr_b16 a[40:41], v12 offset:0
  v_mfma_f32_16x16x32_bf16 v[212:215], a[56:59], a[84:87], v[212:215]
  ds_read_b64_tr_b16 a[42:43], v12 offset:2048
  v_mfma_f32_16x16x32_bf16 v[216:219], a[56:59], a[88:91], v[216:219]
  s_add_u32 m0, m0, 4096
  ds_read_b64_tr_b16 a[44:45], v13 offset:0
  v_mfma_f32_16x16x32_bf16 v[220:223], a[56:59], a[92:95], v[220:223]
  buffer_load_dwordx4 v18, s[8:11], s25 offen offset:0 lds
  v_mfma_f32_16x16x32_bf16 v[224:227], a[64:67], a[60:63], v[224:227]
  ds_read_b64_tr_b16 a[46:47], v13 offset:2048
  s_add_u32 s24, s24, s26
  v_mfma_f32_16x16x32_bf16 v[228:231], a[68:71], a[60:63], v[228:231]
  s_cmp_ge_u32 s24, s80
  s_cselect_b32 s34, s81, 0
  v_mfma_f32_16x16x32_bf16 v[232:235], a[72:75], a[60:63], v[232:235]
  buffer_load_dwordx4 v19, s[8:11], s25 offen offset:1024 lds
  v_mfma_f32_16x16x32_bf16 v[236:239], a[76:79], a[60:63], v[236:239]
  s_sub_u32 s24, s24, s34
  s_add_u32 s27, s27, 12288
  v_mfma_f32_16x16x32_bf16 v[240:243], a[80:83], a[60:63], v[240:243]
  s_cmp_eq_u32 s27, s32
  s_cselect_b32 s27, s33, s27
  v_mfma_f32_16x16x32_bf16 v[244:247], a[60:63], a[84:87], v[244:247]
  s_cmp_eq_u32 s27, s35
  s_cselect_b32 s29, s68, s69
  v_mfma_f32_16x16x32_bf16 v[248:251], a[60:63], a[88:91], v[248:251]
  s_sub_u32 s28, s28, 1
  s_cmp_lg_u32 s28, 0
  v_mfma_f32_16x16x32_bf16 v[252:255], a[60:63], a[92:95], v[252:255]
  s_waitcnt lgkmcnt(0)
  s_cbranch_scc1 Lp1loopA
  s_mov_b32 s58, 0x3ea52b5c
  s_mov_b64 s[60:61], 0xffff
  s_mov_b32 s66, 0xffff0000
  buffer_load_ubyte v105, v105, s[72:75], 0 offen sc1
  s_mov_b32 s67, 0
  ds_read_b64_tr_b16 a[80:81], v96 offset:12288
  s_lshl_b32 s63, s23, 1
  ds_read_b64_tr_b16 a[82:83], v96 offset:14336
  s_add_u32 s63, s63, s65
  ds_read_b64_tr_b16 a[84:85], v97 offset:12288
  s_add_u32 s57, s63, 54
  ds_read_b64_tr_b16 a[86:87], v97 offset:14336
  s_lshl_b32 s57, s57, 10
  ds_read_b64_tr_b16 a[88:89], v98 offset:12288
  s_lshr_b32 s59, s63, 2
  ds_read_b64_tr_b16 a[90:91], v98 offset:14336
  global_load_dword a254, v26, s[16:17]
  s_add_u32 s59, s59, 70
  ds_read_b64_tr_b16 a[92:93], v99 offset:12288
  s_lshl_b32 s59, s59, 10
  ds_read_b64_tr_b16 a[94:95], v99 offset:14336
  s_and_b32 s63, s63, 3
  ds_read_b64_tr_b16 a[96:97], v96 offset:16384
  s_lshl_b32 s63, s63, 8
  ds_read_b64_tr_b16 a[98:99], v96 offset:18432
  s_add_u32 s59, s59, s63
  ds_read_b64_tr_b16 a[100:101], v97 offset:16384
  s_mul_i32 s38, s22, 57
  ds_read_b64_tr_b16 a[102:103], v97 offset:18432
  s_sub_u32 s39, 1023, s38
  buffer_load_dwordx4 v20, s[8:11], s25 offen offset:2048 lds
  s_min_u32 s39, s39, 56
  ds_read_b64_tr_b16 a[104:105], v98 offset:16384
  s_sub_u32 s48, s38, 7
  ds_read_b64_tr_b16 a[106:107], v98 offset:18432
  s_and_b32 s49, s48, 15
  ds_read_b64_tr_b16 a[108:109], v99 offset:16384
  s_sub_u32 s63, s48, s49
  ds_read_b64_tr_b16 a[110:111], v99 offset:18432
  s_sub_u32 s38, s63, s38
  ds_read_b64_tr_b16 a[112:113], v96 offset:20480
  s_ashr_i32 s63, s63, 3
  ds_read_b64_tr_b16 a[114:115], v96 offset:22528
  s_add_u32 s63, s63, s64
  ds_read_b64_tr_b16 a[116:117], v97 offset:20480
  buffer_load_dwordx4 v21, s[8:11], s25 offen offset:3072 lds
  s_mul_i32 s63, s63, 75776
  ds_read_b64_tr_b16 a[118:119], v97 offset:22528
  s_add_u32 s57, s57, s63
  ds_read_b64_tr_b16 a[120:121], v98 offset:20480
  s_add_u32 s59, s59, s63
  ds_read_b64_tr_b16 a[122:123], v98 offset:22528
  v_subrev_u32 v12, s49, v3
  ds_read_b64_tr_b16 a[124:125], v99 offset:20480
  v_and_b32 v12, 15, v12
  ds_read_b64_tr_b16 a[126:127], v99 offset:22528
  v_lshl_add_u32 v12, v2, 4, v12
  v_lshlrev_b32 v12, 2, v12
  s_add_u32 m0, m0, 4096
  s_nop 0
  buffer_load_dwordx4 v22, s[8:11], s25 offen offset:0 lds
  v_cmp_gt_u32 s[36:37], s49, v3
  v_lshlrev_b32 v13, 4, v3
  v_lshl_add_u32 v13, v2, 3, v13
  v_cvt_pk_bf16_f32 v64, v152, v153
  v_cvt_pk_bf16_f32 v65, v154, v155
  v_cvt_pk_bf16_f32 v72, v156, v157
  v_cvt_pk_bf16_f32 v73, v158, v159
  s_waitcnt vmcnt(11)
  ds_read_b64_tr_b16 a[128:129], v96 offset:24576
  buffer_load_dwordx4 v23, s[8:11], s25 offen offset:1024 lds
  v_cvt_pk_bf16_f32 v34, v144, v145
  ds_read_b64_tr_b16 a[130:131], v96 offset:26624
  v_cvt_pk_bf16_f32 v35, v146, v147
  ds_read_b64_tr_b16 a[132:133], v97 offset:24576
  v_cvt_pk_bf16_f32 v156, v144, v145
  ds_read_b64_tr_b16 a[134:135], v97 offset:26624
  v_cvt_pk_bf16_f32 v157, v146, v147
  ds_read_b64_tr_b16 a[136:137], v98 offset:24576
  v_cvt_pk_bf16_f32 v152, v128, v129
  ds_read_b64_tr_b16 a[138:139], v98 offset:26624
  v_cvt_pk_bf16_f32 v153, v130, v131
  ds_read_b64_tr_b16 a[140:141], v99 offset:24576
  buffer_load_dwordx4 v24, s[8:11], s25 offen offset:2048 lds
  v_cvt_pk_bf16_f32 v158, v132, v133
  ds_read_b64_tr_b16 a[142:143], v99 offset:26624
  v_cvt_pk_bf16_f32 v159, v134, v135
  v_permlane32_swap_b32 v156, v34
  ds_read_b64_tr_b16 a[144:145], v96 offset:28672
  v_permlane32_swap_b32 v157, v35
  ds_read_b64_tr_b16 a[146:147], v96 offset:30720
  v_cvt_pk_bf16_f32 v32, v136, v137
  ds_read_b64_tr_b16 a[148:149], v97 offset:28672
  v_cvt_pk_bf16_f32 v33, v138, v139
  ds_read_b64_tr_b16 a[150:151], v97 offset:30720
  v_cvt_pk_bf16_f32 v36, v140, v141
  ds_read_b64_tr_b16 a[152:153], v98 offset:28672
  buffer_load_dwordx4 v25, s[8:11], s25 offen offset:3072 lds
  v_cvt_pk_bf16_f32 v37, v142, v143
  ds_read_b64_tr_b16 a[154:155], v98 offset:30720
  v_cndmask_b32 v154, 0, v156, s[60:61]
  ds_read_b64_tr_b16 a[156:157], v99 offset:28672
  v_cndmask_b32 v156, 0, v156, s[66:67]
  ds_read_b64_tr_b16 a[158:159], v99 offset:30720
  v_cndmask_b32 v155, 0, v157, s[60:61]
  v_cndmask_b32 v157, 0, v157, s[66:67]
  ds_read_b64_tr_b16 a[160:161], v96 offset:32768
  v_cvt_pk_bf16_f32 v56, v148, v149
  ds_read_b64_tr_b16 a[162:163], v96 offset:34816
  v_cvt_pk_bf16_f32 v57, v150, v151
  ds_read_b64_tr_b16 a[164:165], v97 offset:32768
  s_add_u32 m0, s33, 36864
  s_nop 0
  buffer_load_dwordx4 v14, s[4:7], s24 offen offset:0 lds
  v_cvt_pk_bf16_f32 v66, v184, v185
  ds_read_b64_tr_b16 a[166:167], v97 offset:34816
  v_mfma_f32_16x16x32_bf16 v[128:131], v[32:35], v[152:155], v[114:117]
  ds_read_b64_tr_b16 a[168:169], v98 offset:32768
  v_cvt_pk_bf16_f32 v67, v186, v187
  ds_read_b64_tr_b16 a[170:171], v98 offset:34816
  v_cvt_pk_bf16_f32 v74, v188, v189
  ds_read_b64_tr_b16 a[172:173], v99 offset:32768
  v_mfma_f32_16x16x32_bf16 v[136:139], v[34:37], v[156:159], v[114:117]
  ds_read_b64_tr_b16 a[174:175], v99 offset:34816
  v_cvt_pk_bf16_f32 v75, v190, v191
  v_cvt_pk_bf16_f32 v40, v176, v177
  buffer_load_dwordx4 v15, s[4:7], s24 offen offset:1024 lds
  v_cvt_pk_bf16_f32 v41, v178, v179
  v_cvt_pk_bf16_f32 v188, v176, v177
  v_cvt_pk_bf16_f32 v189, v178, v179
  v_cvt_pk_bf16_f32 v184, v160, v161
  v_cvt_pk_bf16_f32 v185, v162, v163
  v_cvt_pk_bf16_f32 v190, v164, v165
  v_cvt_pk_bf16_f32 v191, v166, v167
  buffer_load_dwordx4 v16, s[4:7], s24 offen offset:2048 lds
  v_permlane32_swap_b32 v188, v40
  v_permlane32_swap_b32 v189, v41
  v_cvt_pk_bf16_f32 v38, v168, v169
  v_cvt_pk_bf16_f32 v39, v170, v171
  v_cvt_pk_bf16_f32 v42, v172, v173
  v_cvt_pk_bf16_f32 v43, v174, v175
  v_cndmask_b32 v186, 0, v188, s[60:61]
  buffer_load_dwordx4 v17, s[4:7], s24 offen offset:3072 lds
  s_sub_u32 s76, s40, 4096
  s_subb_u32 s77, s41, 0
  s_mov_b32 s78, 823296
  s_mov_b32 s79, 0x20000
  s_add_u32 s25, s24, 40960
  s_cmp_ge_u32 s25, s82
  s_cselect_b32 s34, s83, 0
  s_sub_u32 s25, s25, s34
  s_mul_i32 s26, s20, 204800
  s_mov_b32 s30, s26
  s_add_u32 s29, s26, 5120
  v_cndmask_b32 v188, 0, v188, s[66:67]
  v_cndmask_b32 v187, 0, v189, s[60:61]
  v_cndmask_b32 v189, 0, v189, s[66:67]
  v_cvt_pk_bf16_f32 v58, v180, v181
  v_cvt_pk_bf16_f32 v59, v182, v183
  v_cvt_pk_bf16_f32 v68, v216, v217
  s_waitcnt lgkmcnt(0)
  s_add_u32 m0, s33, 12288
  s_nop 0
  buffer_load_dwordx4 v28, s[8:11], s25 offen offset:0 lds
  v_mfma_f32_16x16x32_bf16 v[160:163], v[38:41], v[184:187], v[106:109]
  v_cvt_pk_bf16_f32 v69, v218, v219
  v_cvt_pk_bf16_f32 v76, v220, v221
  v_mfma_f32_16x16x32_bf16 v[164:167], v[32:35], v[184:187], v[110:113]
  v_cvt_pk_bf16_f32 v77, v222, v223
  v_cvt_pk_bf16_f32 v46, v208, v209
  v_mfma_f32_16x16x32_bf16 v[168:171], v[40:43], v[188:191], v[106:109]
  buffer_load_dwordx4 v29, s[8:11], s25 offen offset:1024 lds
  v_cvt_pk_bf16_f32 v47, v210, v211
  v_cvt_pk_bf16_f32 v220, v208, v209
  v_mfma_f32_16x16x32_bf16 v[172:175], v[34:37], v[188:191], v[110:113]
  v_cvt_pk_bf16_f32 v221, v210, v211
  v_cvt_pk_bf16_f32 v216, v192, v193
  v_cvt_pk_bf16_f32 v217, v194, v195
  v_cvt_pk_bf16_f32 v222, v196, v197
  buffer_load_dwordx4 v30, s[8:11], s25 offen offset:2048 lds
  v_cvt_pk_bf16_f32 v223, v198, v199
  v_permlane32_swap_b32 v220, v46
  v_permlane32_swap_b32 v221, v47
  v_cvt_pk_bf16_f32 v44, v200, v201
  v_cvt_pk_bf16_f32 v45, v202, v203
  v_cvt_pk_bf16_f32 v48, v204, v205
  v_cvt_pk_bf16_f32 v49, v206, v207
  buffer_load_dwordx4 v31, s[8:11], s25 offen offset:3072 lds
  s_add_u32 s25, s25, 40960
  s_cmp_ge_u32 s25, s82
  s_cselect_b32 s34, s83, 0
  s_sub_u32 s25, s25, s34
  v_cndmask_b32 v218, 0, v220, s[60:61]
  v_cndmask_b32 v220, 0, v220, s[66:67]
  v_cndmask_b32 v219, 0, v221, s[60:61]
  v_cndmask_b32 v221, 0, v221, s[66:67]
  v_cvt_pk_bf16_f32 v60, v212, v213
  v_cvt_pk_bf16_f32 v61, v214, v215
  v_cvt_pk_bf16_f32 v70, v248, v249
  s_add_u32 m0, s33, 16384
  s_nop 0
  buffer_load_dwordx4 v28, s[8:11], s25 offen offset:0 lds
  v_mfma_f32_16x16x32_bf16 v[192:195], v[44:47], v[216:219], v[106:109]
  v_cvt_pk_bf16_f32 v71, v250, v251
  v_cvt_pk_bf16_f32 v78, v252, v253
  v_mfma_f32_16x16x32_bf16 v[196:199], v[38:41], v[216:219], v[110:113]
  v_cvt_pk_bf16_f32 v79, v254, v255
  v_cvt_pk_bf16_f32 v52, v240, v241
  v_mfma_f32_16x16x32_bf16 v[200:203], v[46:49], v[220:223], v[106:109]
  buffer_load_dwordx4 v29, s[8:11], s25 offen offset:1024 lds
  v_cvt_pk_bf16_f32 v53, v242, v243
  v_cvt_pk_bf16_f32 v252, v240, v241
  v_mfma_f32_16x16x32_bf16 v[204:207], v[40:43], v[220:223], v[110:113]
  v_cvt_pk_bf16_f32 v253, v242, v243
  v_cvt_pk_bf16_f32 v248, v224, v225
  v_cvt_pk_bf16_f32 v249, v226, v227
  buffer_load_dwordx4 v30, s[8:11], s25 offen offset:2048 lds
  v_cvt_pk_bf16_f32 v254, v228, v229
  v_cvt_pk_bf16_f32 v255, v230, v231
  v_permlane32_swap_b32 v252, v52
  v_permlane32_swap_b32 v253, v53
  v_cvt_pk_bf16_f32 v50, v232, v233
  v_cvt_pk_bf16_f32 v51, v234, v235
  v_cvt_pk_bf16_f32 v54, v236, v237
  buffer_load_dwordx4 v31, s[8:11], s25 offen offset:3072 lds
  s_add_u32 s25, s25, 40960
  s_cmp_ge_u32 s25, s82
  s_cselect_b32 s34, s83, 0
  s_sub_u32 s25, s25, s34
  v_cvt_pk_bf16_f32 v55, v238, v239
  v_cndmask_b32 v250, 0, v252, s[60:61]
  v_cndmask_b32 v252, 0, v252, s[66:67]
  v_cndmask_b32 v251, 0, v253, s[60:61]
  v_cndmask_b32 v253, 0, v253, s[66:67]
  v_cvt_pk_bf16_f32 v62, v244, v245
  v_cvt_pk_bf16_f32 v63, v246, v247
  s_add_u32 m0, s33, 20480
  s_nop 0
  buffer_load_dwordx4 v28, s[8:11], s25 offen offset:0 lds
  v_mfma_f32_16x16x32_bf16 v[224:227], v[50:53], v[248:251], v[106:109]
  v_mfma_f32_16x16x32_bf16 v[228:231], v[44:47], v[248:251], v[110:113]
  v_mfma_f32_16x16x32_bf16 v[232:235], v[52:55], v[252:255], v[106:109]
  v_mfma_f32_16x16x32_bf16 v[236:239], v[46:49], v[252:255], v[110:113]
  s_mov_b32 exec_lo, 0xff00ff00
  s_mov_b32 exec_hi, 0xff00ff00
  v_mov_b32 v72, 0x3f803f80
  v_mov_b32 v73, 0x3f803f80
  v_mov_b32 v74, 0x3f803f80
  v_mov_b32 v75, 0x3f803f80
  v_mov_b32 v76, 0x3f803f80
  v_mov_b32 v77, 0x3f803f80
  v_mov_b32 v78, 0x3f803f80
  v_mov_b32 v79, 0x3f803f80
  s_mov_b64 exec, -1
  v_max3_f32 v80, v128, v129, v130
  v_max_f32 v80, v80, v131
  buffer_load_dwordx4 v29, s[8:11], s25 offen offset:1024 lds
  v_max3_f32 v81, v136, v137, v138
  v_max_f32 v81, v81, v139
  v_max_f32 v160, v160, v164
  v_max_f32 v161, v161, v165
  v_max_f32 v162, v162, v166
  v_max_f32 v163, v163, v167
  v_max3_f32 v84, v160, v161, v162
  s_waitcnt vmcnt(10)
  s_mov_b32 s35, 0x20000
LsnAw:
  v_and_b32 v27, 0x80, v105
  v_cmp_eq_u32 vcc, 0, v27
  s_sub_u32 s35, s35, 1
  s_cmp_eq_u32 s35, 0
  s_cbranch_scc1 LsnAx
  s_cbranch_vccz LsnAx
  v_subrev_u32 v27, 11534336, v104
  v_lshrrev_b32 v27, 7, v27
  buffer_load_ubyte v105, v27, s[72:75], 0 offen sc1
  s_waitcnt vmcnt(0)
  s_branch LsnAw
LsnAx:
  v_and_b32 v105, 1, v105
  v_xor_b32 v105, 1, v105
  s_and_b32 s21, s56, 127
  s_bfe_u32 s22, s56, 0x30007
  s_bfe_u32 s23, s56, 0x4000a
  v_lshlrev_b32 v10, 4, v1
  s_mul_i32 s63, s21, 75776
  v_add_u32 v4, s63, v10
  s_add_u32 s63, s63, 75776
  v_add_u32 v5, s63, v10
  s_add_u32 s63, s63, 75776
  v_add_u32 v6, s63, v10
  s_add_u32 s63, s63, 75776
  v_add_u32 v7, s63, v10
  s_add_u32 s63, s63, 75776
  v_add_u32 v8, s63, v10
  s_add_u32 s63, s63, 75776
  v_add_u32 v9, s63, v10
  s_lshl_b32 s18, s62, 10
  s_add_u32 s19, s18, 14336
  s_lshl_b32 s24, s71, 10
  s_add_u32 s24, s24, s18
  s_lshl_b32 s27, s20, 12
  s_add_u32 s27, s27, 55296
  s_lshl_b32 s28, s20, 10
  s_add_u32 s28, s28, 71680
  s_mov_b32 s4, s12
  s_mov_b32 s5, s13
  s_cmp_ge_u32 s20, 2
  s_cselect_b32 s68, 0, s14
  s_cmp_eq_u32 s71, 0
  s_cselect_b32 s6, s68, s14
  s_cmp_eq_u32 s22, 4
  s_cbranch_scc0 Lnt4
  v_mov_b32 v8, 2147483632
Lnt4:
  ds_read_b64_tr_b16 a[176:177], v96 offset:0
  buffer_load_dwordx4 v30, s[8:11], s25 offen offset:2048 lds
  v_max_f32 v84, v84, v163
  ds_read_b64_tr_b16 a[178:179], v96 offset:2048
  v_max_f32 v168, v168, v172
  ds_read_b64_tr_b16 a[180:181], v97 offset:0
  v_max_f32 v169, v169, v173
  ds_read_b64_tr_b16 a[182:183], v97 offset:2048
  v_max_f32 v170, v170, v174
  ds_read_b64_tr_b16 a[184:185], v98 offset:0
  v_max_f32 v171, v171, v175
  ds_read_b64_tr_b16 a[186:187], v98 offset:2048
  v_max3_f32 v85, v168, v169, v170
  ds_read_b64_tr_b16 a[188:189], v99 offset:0
  buffer_load_dwordx4 v31, s[8:11], s25 offen offset:3072 lds
  s_add_u32 s25, s25, 40960
  s_cmp_ge_u32 s25, s82
  s_cselect_b32 s34, s83, 0
  s_sub_u32 s25, s25, s34
  v_max_f32 v85, v85, v171
  ds_read_b64_tr_b16 a[190:191], v99 offset:2048
  v_max_f32 v192, v192, v196
  v_max_f32 v193, v193, v197
  ds_read_b64_tr_b16 a[192:193], v96 offset:4096
  v_max_f32 v194, v194, v198
  ds_read_b64_tr_b16 a[194:195], v96 offset:6144
  v_max_f32 v195, v195, v199
  ds_read_b64_tr_b16 a[196:197], v97 offset:4096
  v_max3_f32 v88, v192, v193, v194
  ds_read_b64_tr_b16 a[198:199], v97 offset:6144
  v_max_f32 v88, v88, v195
  ds_read_b64_tr_b16 a[200:201], v98 offset:4096
  s_add_u32 m0, s33, 24576
  s_nop 0
  buffer_load_dwordx4 v28, s[8:11], s25 offen offset:0 lds
  v_max_f32 v200, v200, v204
  ds_read_b64_tr_b16 a[202:203], v98 offset:6144
  v_max_f32 v201, v201, v205
  ds_read_b64_tr_b16 a[204:205], v99 offset:4096
  v_max_f32 v202, v202, v206
  ds_read_b64_tr_b16 a[206:207], v99 offset:6144
  v_max_f32 v203, v203, v207
  v_max3_f32 v89, v200, v201, v202
  ds_read_b64_tr_b16 a[208:209], v96 offset:8192
  v_max_f32 v89, v89, v203
  ds_read_b64_tr_b16 a[210:211], v96 offset:10240
  v_max_f32 v224, v224, v228
  ds_read_b64_tr_b16 a[212:213], v97 offset:8192
  buffer_load_dwordx4 v29, s[8:11], s25 offen offset:1024 lds
  v_max_f32 v225, v225, v229
  ds_read_b64_tr_b16 a[214:215], v97 offset:10240
  v_max_f32 v226, v226, v230
  ds_read_b64_tr_b16 a[216:217], v98 offset:8192
  v_max_f32 v227, v227, v231
  ds_read_b64_tr_b16 a[218:219], v98 offset:10240
  v_max3_f32 v92, v224, v225, v226
  ds_read_b64_tr_b16 a[220:221], v99 offset:8192
  v_max_f32 v92, v92, v227
  ds_read_b64_tr_b16 a[222:223], v99 offset:10240
  v_max_f32 v232, v232, v236
  v_max_f32 v233, v233, v237
  buffer_load_dwordx4 v30, s[8:11], s25 offen offset:2048 lds
  v_max_f32 v234, v234, v238
  v_max_f32 v235, v235, v239
  v_max3_f32 v93, v232, v233, v234
  v_max_f32 v93, v93, v235
  v_permlane32_swap_b32 v80, v81
  v_permlane32_swap_b32 v84, v85
  v_permlane32_swap_b32 v88, v89
  buffer_load_dwordx4 v31, s[8:11], s25 offen offset:3072 lds
  v_permlane32_swap_b32 v92, v93
  v_max_f32 v80, v80, v81
  v_max_f32 v84, v84, v85
  v_max_f32 v88, v88, v89
  v_max_f32 v92, v92, v93
  v_mov_b32 v81, v80
  v_mov_b32 v85, v84
  s_add_u32 m0, s33, 28672
  s_nop 0
  buffer_load_dwordx4 v28, s[76:79], s26 offen offset:0 lds
  v_mov_b32 v89, v88
  v_mov_b32 v93, v92
  v_permlane16_swap_b32 v80, v81
  v_permlane16_swap_b32 v84, v85
  v_permlane16_swap_b32 v88, v89
  v_permlane16_swap_b32 v92, v93
  buffer_load_dwordx4 v29, s[76:79], s26 offen offset:1024 lds
  v_max_f32 v80, v80, v81
  v_max_f32 v84, v84, v85
  v_max_f32 v88, v88, v89
  v_max_f32 v92, v92, v93
  v_mul_f32 v80, s58, v80
  v_mul_f32 v84, s58, v84
  v_mul_f32 v88, s58, v88
  buffer_load_dwordx4 v30, s[76:79], s29 offen offset:2048 lds
  v_mul_f32 v92, s58, v92
  v_mov_b32 v81, v80
  v_mov_b32 v85, v84
  v_mov_b32 v89, v88
  v_mov_b32 v93, v92
  v_permlane32_swap_b32 v80, v81
  v_permlane32_swap_b32 v84, v85
  buffer_load_dwordx4 v31, s[76:79], s29 offen offset:3072 lds
  s_add_u32 s26, s26, 51200
  s_add_u32 s29, s29, 51200
  v_permlane32_swap_b32 v88, v89
  v_permlane32_swap_b32 v92, v93
  v_pk_fma_f32 v[128:129], v[128:129], s[58:59], v[80:81] op_sel:[0,0,0] op_sel_hi:[1,0,0] neg_lo:[0,0,1] neg_hi:[0,0,1]
  v_pk_fma_f32 v[130:131], v[130:131], s[58:59], v[80:81] op_sel:[0,0,0] op_sel_hi:[1,0,0] neg_lo:[0,0,1] neg_hi:[0,0,1]
  v_exp_f32 v128, v128
  v_exp_f32 v129, v129
  v_exp_f32 v130, v130
  s_add_u32 m0, s33, 32768
  s_nop 0
  buffer_load_dwordx4 v28, s[76:79], s26 offen offset:0 lds
  v_exp_f32 v131, v131
  v_pk_fma_f32 v[136:137], v[136:137], s[58:59], v[80:81] op_sel:[0,0,1] op_sel_hi:[1,0,1] neg_lo:[0,0,1] neg_hi:[0,0,1]
  v_pk_fma_f32 v[138:139], v[138:139], s[58:59], v[80:81] op_sel:[0,0,1] op_sel_hi:[1,0,1] neg_lo:[0,0,1] neg_hi:[0,0,1]
  v_exp_f32 v136, v136
  v_exp_f32 v137, v137
  v_exp_f32 v138, v138
  v_exp_f32 v139, v139
  buffer_load_dwordx4 v29, s[76:79], s26 offen offset:1024 lds
  v_cvt_pk_bf16_f32 v144, v128, v129
  v_cvt_pk_bf16_f32 v145, v130, v131
  v_mov_b32 v146, 0
  v_mov_b32 v147, 0
  v_cvt_pk_bf16_f32 v148, v136, v137
  v_cvt_pk_bf16_f32 v149, v138, v139
  v_mov_b32 v150, 0
  buffer_load_dwordx4 v30, s[76:79], s29 offen offset:2048 lds
  v_mov_b32 v151, 0
  v_pk_fma_f32 v[160:161], v[160:161], s[58:59], v[84:85] op_sel:[0,0,0] op_sel_hi:[1,0,0] neg_lo:[0,0,1] neg_hi:[0,0,1]
  v_pk_fma_f32 v[162:163], v[162:163], s[58:59], v[84:85] op_sel:[0,0,0] op_sel_hi:[1,0,0] neg_lo:[0,0,1] neg_hi:[0,0,1]
  v_mfma_f32_16x16x32_bf16 v[136:139], v[72:75], v[144:147], 0
  v_exp_f32 v160, v160
  v_exp_f32 v161, v161
  buffer_load_dwordx4 v31, s[76:79], s29 offen offset:3072 lds
  s_add_u32 s26, s26, 51200
  s_add_u32 s29, s29, 51200
  v_exp_f32 v162, v162
  v_mfma_f32_16x16x32_bf16 v[140:143], v[72:75], v[148:151], 0
  v_exp_f32 v163, v163
  v_pk_fma_f32 v[168:169], v[168:169], s[58:59], v[84:85] op_sel:[0,0,1] op_sel_hi:[1,0,1] neg_lo:[0,0,1] neg_hi:[0,0,1]
  v_pk_fma_f32 v[170:171], v[170:171], s[58:59], v[84:85] op_sel:[0,0,1] op_sel_hi:[1,0,1] neg_lo:[0,0,1] neg_hi:[0,0,1]
  v_mfma_f32_16x16x32_bf16 v[128:131], v[56:59], v[144:147], 0
  v_exp_f32 v168, v168
  s_waitcnt lgkmcnt(0)
  s_add_u32 m0, s33, 0
  s_nop 0
  buffer_load_dwordx4 v28, s[76:79], s26 offen offset:0 lds
  v_exp_f32 v169, v169
  v_exp_f32 v170, v170
  v_mfma_f32_16x16x32_bf16 v[132:135], v[64:67], v[148:151], 0
  v_exp_f32 v171, v171
  v_cvt_pk_bf16_f32 v176, v160, v161
  v_cvt_pk_bf16_f32 v177, v162, v163
  v_and_b32 v178, v118, v176
  buffer_load_dwordx4 v29, s[76:79], s26 offen offset:1024 lds
  v_and_b32 v179, v119, v177
  v_xor_b32 v176, v176, v178
  v_xor_b32 v177, v177, v179
  v_cvt_pk_bf16_f32 v180, v168, v169
  v_cvt_pk_bf16_f32 v181, v170, v171
  v_and_b32 v182, v118, v180
  v_and_b32 v183, v119, v181
  buffer_load_dwordx4 v30, s[76:79], s29 offen offset:2048 lds
  v_xor_b32 v180, v180, v182
  v_xor_b32 v181, v181, v183
  v_pk_fma_f32 v[192:193], v[192:193], s[58:59], v[88:89] op_sel:[0,0,0] op_sel_hi:[1,0,0] neg_lo:[0,0,1] neg_hi:[0,0,1]
  v_pk_fma_f32 v[194:195], v[194:195], s[58:59], v[88:89] op_sel:[0,0,0] op_sel_hi:[1,0,0] neg_lo:[0,0,1] neg_hi:[0,0,1]
  v_mfma_f32_16x16x32_bf16 v[168:171], v[72:75], v[176:179], 0
  v_exp_f32 v192, v192
  v_exp_f32 v193, v193
  buffer_load_dwordx4 v31, s[76:79], s29 offen offset:3072 lds
  s_add_u32 s26, s26, 51200
  s_add_u32 s29, s29, 51200
  v_exp_f32 v194, v194
  v_mfma_f32_16x16x32_bf16 v[172:175], v[72:75], v[180:183], 0
  v_exp_f32 v195, v195
  v_pk_fma_f32 v[200:201], v[200:201], s[58:59], v[88:89] op_sel:[0,0,1] op_sel_hi:[1,0,1] neg_lo:[0,0,1] neg_hi:[0,0,1]
  v_pk_fma_f32 v[202:203], v[202:203], s[58:59], v[88:89] op_sel:[0,0,1] op_sel_hi:[1,0,1] neg_lo:[0,0,1] neg_hi:[0,0,1]
  v_mfma_f32_16x16x32_bf16 v[160:163], v[56:59], v[176:179], 0
  s_add_u32 m0, s33, 4096
  s_nop 0
  buffer_load_dwordx4 v28, s[76:79], s26 offen offset:0 lds
  v_exp_f32 v200, v200
  v_exp_f32 v201, v201
  v_exp_f32 v202, v202
  v_mfma_f32_16x16x32_bf16 v[164:167], v[64:67], v[180:183], 0
  v_exp_f32 v203, v203
  v_cvt_pk_bf16_f32 v208, v192, v193
  v_cvt_pk_bf16_f32 v209, v194, v195
  buffer_load_dwordx4 v29, s[76:79], s26 offen offset:1024 lds
  v_and_b32 v210, v118, v208
  v_and_b32 v211, v119, v209
  v_xor_b32 v208, v208, v210
  v_xor_b32 v209, v209, v211
  v_cvt_pk_bf16_f32 v212, v200, v201
  v_cvt_pk_bf16_f32 v213, v202, v203
  v_and_b32 v214, v118, v212
  s_mov_b32 exec_lo, 65535
  s_mov_b32 exec_hi, 0
  buffer_load_dword v11, v104, s[12:15], 0 offen sc1
  s_mov_b64 exec, -1
  buffer_load_dwordx4 v30, s[76:79], s29 offen offset:2048 lds
  v_and_b32 v215, v119, v213
  v_xor_b32 v212, v212, v214
  v_xor_b32 v213, v213, v215
  v_pk_fma_f32 v[224:225], v[224:225], s[58:59], v[92:93] op_sel:[0,0,0] op_sel_hi:[1,0,0] neg_lo:[0,0,1] neg_hi:[0,0,1]
  v_pk_fma_f32 v[226:227], v[226:227], s[58:59], v[92:93] op_sel:[0,0,0] op_sel_hi:[1,0,0] neg_lo:[0,0,1] neg_hi:[0,0,1]
  v_mfma_f32_16x16x32_bf16 v[200:203], v[74:77], v[208:211], 0
  v_exp_f32 v224, v224
  buffer_load_dwordx4 v31, s[76:79], s29 offen offset:3072 lds
  v_exp_f32 v225, v225
  v_exp_f32 v226, v226
  v_mfma_f32_16x16x32_bf16 v[204:207], v[74:77], v[212:215], 0
  v_exp_f32 v227, v227
  v_pk_fma_f32 v[232:233], v[232:233], s[58:59], v[92:93] op_sel:[0,0,1] op_sel_hi:[1,0,1] neg_lo:[0,0,1] neg_hi:[0,0,1]
  v_pk_fma_f32 v[234:235], v[234:235], s[58:59], v[92:93] op_sel:[0,0,1] op_sel_hi:[1,0,1] neg_lo:[0,0,1] neg_hi:[0,0,1]
  v_mfma_f32_16x16x32_bf16 v[192:195], v[58:61], v[208:211], 0
  s_add_u32 m0, s33, 8192
  s_nop 0
  buffer_load_dwordx4 v100, s[76:79], s30 offen offset:0 lds
  v_exp_f32 v232, v232
  v_exp_f32 v233, v233
  v_exp_f32 v234, v234
  v_mfma_f32_16x16x32_bf16 v[196:199], v[66:69], v[212:215], 0
  v_exp_f32 v235, v235
  v_cvt_pk_bf16_f32 v240, v224, v225
  v_cvt_pk_bf16_f32 v241, v226, v227
  buffer_load_dwordx4 v101, s[76:79], s30 offen offset:1024 lds
  v_and_b32 v242, v118, v240
  v_and_b32 v243, v119, v241
  v_xor_b32 v240, v240, v242
  v_xor_b32 v241, v241, v243
  v_cvt_pk_bf16_f32 v244, v232, v233
  v_cvt_pk_bf16_f32 v245, v234, v235
  buffer_load_dwordx4 v102, s[76:79], s30 offen offset:2048 lds
  v_and_b32 v246, v118, v244
  v_and_b32 v247, v119, v245
  v_xor_b32 v244, v244, v246
  v_xor_b32 v245, v245, v247
  v_mfma_f32_16x16x32_bf16 v[232:235], v[76:79], v[240:243], 0
  s_nop 0
  v_mfma_f32_16x16x32_bf16 v[236:239], v[76:79], v[244:247], 0
  v_mfma_f32_16x16x32_bf16 v[224:227], v[60:63], v[240:243], 0
  buffer_load_dwordx4 v103, s[76:79], s30 offen offset:3072 lds
  v_mfma_f32_16x16x32_bf16 v[228:231], v[68:71], v[244:247], 0
  v_mov_b32 v34, v136
  v_mov_b32 v32, v140
  v_mov_b32 v38, v168
  v_mov_b32 v36, v172
  v_mov_b32 v42, v200
  v_mov_b32 v40, v204
  s_waitcnt vmcnt(6)
  v_and_b32 v23, 1, v11
  v_cmp_ne_u32 vcc, v23, v105
  s_nop 0
  s_and_b32 vcc_lo, vcc_lo, 65535
  s_and_b32 vcc_hi, vcc_hi, 0
  s_cbranch_vccz LphAok
  s_mov_b32 exec_lo, 65535
  s_mov_b32 exec_hi, 0
  s_mov_b32 s35, 0x20000
LphA:
  buffer_load_dword v23, v104, s[12:15], 0 offen sc1
  s_sub_u32 s35, s35, 1
  s_waitcnt vmcnt(0)
  v_and_b32 v23, 1, v23
  v_cmp_ne_u32 vcc, v23, v105
  s_cmp_eq_u32 s35, 0
  s_cbranch_scc1 LphAx
  s_cbranch_vccnz LphA
LphAx:
  s_mov_b64 exec, -1
LphAok:
  buffer_load_dwordx4 a[0:3], v4, s[4:7], s24 offen sc1
  v_permlane32_swap_b32 v34, v32
  v_permlane32_swap_b32 v38, v36
  v_permlane32_swap_b32 v42, v40
  v_rcp_f32 v32, v32
  v_rcp_f32 v36, v36
  v_rcp_f32 v40, v40
  v_mov_b32 v33, v32
  buffer_load_dwordx4 a[4:7], v5, s[4:7], s24 offen sc1
  v_mov_b32 v37, v36
  v_mov_b32 v41, v40
  v_permlane32_swap_b32 v32, v33
  v_permlane32_swap_b32 v36, v37
  v_permlane32_swap_b32 v40, v41
  v_cndmask_b32 v35, v33, v32, s[60:61]
  v_pk_mul_f32 v[128:129], v[128:129], v[32:33] op_sel:[0,0] op_sel_hi:[1,0]
  buffer_load_dwordx4 a[8:11], v6, s[4:7], s24 offen sc1
  v_pk_mul_f32 v[132:133], v[132:133], v[32:33] op_sel:[0,1] op_sel_hi:[1,1]
  v_pk_mul_f32 v[130:131], v[130:131], v[32:33] op_sel:[0,0] op_sel_hi:[1,0]
  v_pk_mul_f32 v[134:135], v[134:135], v[32:33] op_sel:[0,1] op_sel_hi:[1,1]
  v_cndmask_b32 v136, v140, v136, s[60:61]
  v_cndmask_b32 v137, v141, v137, s[60:61]
  v_cndmask_b32 v138, v142, v138, s[60:61]
  v_cndmask_b32 v139, v143, v139, s[60:61]
  buffer_load_dwordx4 a[12:15], v7, s[4:7], s24 offen sc1
  v_cvt_pk_bf16_f32 v152, v128, v129
  v_cvt_pk_bf16_f32 v153, v130, v131
  v_cvt_pk_bf16_f32 v154, v132, v133
  v_cvt_pk_bf16_f32 v155, v134, v135
  v_pk_mul_f32 v[136:137], v[136:137], v[34:35] op_sel:[0,1] op_sel_hi:[1,1]
  v_pk_mul_f32 v[138:139], v[138:139], v[34:35] op_sel:[0,1] op_sel_hi:[1,1]
  buffer_load_dwordx4 a[16:19], v8, s[4:7], s24 offen sc1
  s_add_u32 s24, s24, 1024
  s_cmp_eq_u32 s24, s19
  s_cselect_b32 s24, s18, s24
  s_cselect_b32 s6, s68, s14
  ds_bpermute_b32 v144, v12, v152
  ds_bpermute_b32 v145, v12, v153
  ds_bpermute_b32 v146, v12, v154
  ds_bpermute_b32 v147, v12, v155
  v_cvt_pk_bf16_f32 v156, v136, v137
  v_cvt_pk_bf16_f32 v157, v138, v139
  ds_bpermute_b32 v148, v12, v156
  buffer_load_dwordx4 a[20:23], v4, s[4:7], s24 offen sc1
  ds_bpermute_b32 v149, v12, v157
  v_cndmask_b32 v39, v37, v36, s[60:61]
  v_pk_mul_f32 v[160:161], v[160:161], v[36:37] op_sel:[0,0] op_sel_hi:[1,0]
  v_pk_mul_f32 v[164:165], v[164:165], v[36:37] op_sel:[0,1] op_sel_hi:[1,1]
  v_pk_mul_f32 v[162:163], v[162:163], v[36:37] op_sel:[0,0] op_sel_hi:[1,0]
  v_pk_mul_f32 v[166:167], v[166:167], v[36:37] op_sel:[0,1] op_sel_hi:[1,1]
  v_cndmask_b32 v168, v172, v168, s[60:61]
  buffer_load_dwordx4 a[24:27], v5, s[4:7], s24 offen sc1
  v_cndmask_b32 v169, v173, v169, s[60:61]
  v_cndmask_b32 v170, v174, v170, s[60:61]
  v_cndmask_b32 v171, v175, v171, s[60:61]
  v_cvt_pk_bf16_f32 v184, v160, v161
  v_cvt_pk_bf16_f32 v185, v162, v163
  v_cvt_pk_bf16_f32 v186, v164, v165
  v_cvt_pk_bf16_f32 v187, v166, v167
  buffer_load_dwordx4 a[28:31], v6, s[4:7], s24 offen sc1
  v_pk_mul_f32 v[168:169], v[168:169], v[38:39] op_sel:[0,1] op_sel_hi:[1,1]
  v_pk_mul_f32 v[170:171], v[170:171], v[38:39] op_sel:[0,1] op_sel_hi:[1,1]
  ds_bpermute_b32 v176, v12, v184
  ds_bpermute_b32 v177, v12, v185
  ds_bpermute_b32 v178, v12, v186
  ds_bpermute_b32 v179, v12, v187
  v_cvt_pk_bf16_f32 v188, v168, v169
  buffer_load_dwordx4 a[32:35], v7, s[4:7], s24 offen sc1
  v_cvt_pk_bf16_f32 v189, v170, v171
  ds_bpermute_b32 v180, v12, v188
  ds_bpermute_b32 v181, v12, v189
  s_waitcnt lgkmcnt(6)
  v_add_u32 v27, s38, v3
  v_cmp_ge_u32 vcc, s39, v27
  s_add_u32 s38, s38, 16
  s_and_b64 exec, vcc, vcc
  s_cbranch_execz Lob0
  buffer_store_dwordx4 v[144:147], v10, s[12:15], s57 offen sc1
  s_mov_b32 exec_hi, 0
  s_cbranch_execz Lob0
  buffer_store_dwordx2 v[148:149], v13, s[12:15], s59 offen sc1
Lob0:
  s_mov_b64 exec, -1
  s_add_u32 s57, s57, 151552
  s_add_u32 s59, s59, 151552
  buffer_load_dwordx4 a[36:39], v8, s[4:7], s24 offen sc1
  s_add_u32 s24, s24, 1024
  s_cmp_eq_u32 s24, s19
  s_cselect_b32 s24, s18, s24
  s_cselect_b32 s6, s68, s14
  v_mov_b32 v46, v232
  v_mov_b32 v44, v236
  s_nop 1
  v_permlane32_swap_b32 v46, v44
  v_rcp_f32 v44, v44
  s_nop 0
  v_mov_b32 v45, v44
  s_nop 1
  v_permlane32_swap_b32 v44, v45
  v_cndmask_b32 v43, v41, v40, s[60:61]
  buffer_load_dwordx4 a[40:43], v4, s[4:7], s24 offen sc1
  v_pk_mul_f32 v[192:193], v[192:193], v[40:41] op_sel:[0,0] op_sel_hi:[1,0]
  v_pk_mul_f32 v[196:197], v[196:197], v[40:41] op_sel:[0,1] op_sel_hi:[1,1]
  v_pk_mul_f32 v[194:195], v[194:195], v[40:41] op_sel:[0,0] op_sel_hi:[1,0]
  v_pk_mul_f32 v[198:199], v[198:199], v[40:41] op_sel:[0,1] op_sel_hi:[1,1]
  v_cndmask_b32 v200, v204, v200, s[60:61]
  v_cndmask_b32 v201, v205, v201, s[60:61]
  v_cndmask_b32 v202, v206, v202, s[60:61]
  buffer_load_dwordx4 a[44:47], v5, s[4:7], s24 offen sc1
  v_cndmask_b32 v203, v207, v203, s[60:61]
  v_cvt_pk_bf16_f32 v216, v192, v193
  v_cvt_pk_bf16_f32 v217, v194, v195
  v_cvt_pk_bf16_f32 v218, v196, v197
  v_cvt_pk_bf16_f32 v219, v198, v199
  v_pk_mul_f32 v[200:201], v[200:201], v[42:43] op_sel:[0,1] op_sel_hi:[1,1]
  v_pk_mul_f32 v[202:203], v[202:203], v[42:43] op_sel:[0,1] op_sel_hi:[1,1]
  buffer_load_dwordx4 a[48:51], v6, s[4:7], s24 offen sc1
  ds_bpermute_b32 v208, v12, v216
  ds_bpermute_b32 v209, v12, v217
  ds_bpermute_b32 v210, v12, v218
  ds_bpermute_b32 v211, v12, v219
  v_cvt_pk_bf16_f32 v220, v200, v201
  v_cvt_pk_bf16_f32 v221, v202, v203
  ds_bpermute_b32 v212, v12, v220
  buffer_load_dwordx4 a[52:55], v7, s[4:7], s24 offen sc1
  ds_bpermute_b32 v213, v12, v221
  s_waitcnt lgkmcnt(6)
  v_cndmask_b32 v184, v176, v144, s[36:37]
  v_cndmask_b32 v185, v177, v145, s[36:37]
  v_cndmask_b32 v186, v178, v146, s[36:37]
  v_cndmask_b32 v187, v179, v147, s[36:37]
  v_cndmask_b32 v188, v180, v148, s[36:37]
  buffer_load_dwordx4 a[56:59], v8, s[4:7], s24 offen sc1
  s_add_u32 s24, s24, 1024
  s_cmp_eq_u32 s24, s19
  s_cselect_b32 s24, s18, s24
  s_cselect_b32 s6, s68, s14
  v_cndmask_b32 v189, v181, v149, s[36:37]
  v_add_u32 v27, s38, v3
  v_cmp_ge_u32 vcc, s39, v27
  s_add_u32 s38, s38, 16
  s_and_b64 exec, vcc, vcc
  s_cbranch_execz Lob1
  buffer_store_dwordx4 v[184:187], v10, s[12:15], s57 offen sc1
  s_mov_b32 exec_hi, 0
  s_cbranch_execz Lob1
  buffer_store_dwordx2 v[188:189], v13, s[12:15], s59 offen sc1
Lob1:
  s_mov_b64 exec, -1
  s_add_u32 s57, s57, 151552
  s_add_u32 s59, s59, 151552
  v_cndmask_b32 v47, v45, v44, s[60:61]
  v_pk_mul_f32 v[224:225], v[224:225], v[44:45] op_sel:[0,0] op_sel_hi:[1,0]
  v_pk_mul_f32 v[228:229], v[228:229], v[44:45] op_sel:[0,1] op_sel_hi:[1,1]
  buffer_load_dwordx4 a[60:63], v4, s[4:7], s24 offen sc1
  v_pk_mul_f32 v[226:227], v[226:227], v[44:45] op_sel:[0,0] op_sel_hi:[1,0]
  v_pk_mul_f32 v[230:231], v[230:231], v[44:45] op_sel:[0,1] op_sel_hi:[1,1]
  v_cndmask_b32 v232, v236, v232, s[60:61]
  v_cndmask_b32 v233, v237, v233, s[60:61]
  v_cndmask_b32 v234, v238, v234, s[60:61]
  v_cndmask_b32 v235, v239, v235, s[60:61]
  v_cvt_pk_bf16_f32 v248, v224, v225
  buffer_load_dwordx4 a[64:67], v5, s[4:7], s24 offen sc1
  v_cvt_pk_bf16_f32 v249, v226, v227
  v_cvt_pk_bf16_f32 v250, v228, v229
  v_cvt_pk_bf16_f32 v251, v230, v231
  v_pk_mul_f32 v[232:233], v[232:233], v[46:47] op_sel:[0,1] op_sel_hi:[1,1]
  v_pk_mul_f32 v[234:235], v[234:235], v[46:47] op_sel:[0,1] op_sel_hi:[1,1]
  ds_bpermute_b32 v240, v12, v248
  ds_bpermute_b32 v241, v12, v249
  buffer_load_dwordx4 a[68:71], v6, s[4:7], s24 offen sc1
  ds_bpermute_b32 v242, v12, v250
  ds_bpermute_b32 v243, v12, v251
  v_cvt_pk_bf16_f32 v252, v232, v233
  v_cvt_pk_bf16_f32 v253, v234, v235
  ds_bpermute_b32 v244, v12, v252
  ds_bpermute_b32 v245, v12, v253
  s_waitcnt lgkmcnt(6)
  buffer_load_dwordx4 a[72:75], v7, s[4:7], s24 offen sc1
  v_cndmask_b32 v216, v208, v176, s[36:37]
  v_cndmask_b32 v217, v209, v177, s[36:37]
  v_cndmask_b32 v218, v210, v178, s[36:37]
  v_cndmask_b32 v219, v211, v179, s[36:37]
  v_cndmask_b32 v220, v212, v180, s[36:37]
  v_cndmask_b32 v221, v213, v181, s[36:37]
  v_add_u32 v27, s38, v3
  buffer_load_dwordx4 a[76:79], v8, s[4:7], s24 offen sc1
  s_add_u32 s24, s24, 1024
  s_cmp_eq_u32 s24, s19
  s_cselect_b32 s24, s18, s24
  s_cselect_b32 s6, s68, s14
  v_cmp_ge_u32 vcc, s39, v27
  s_add_u32 s38, s38, 16
  s_and_b64 exec, vcc, vcc
  s_cbranch_execz Lob2
  buffer_store_dwordx4 v[216:219], v10, s[12:15], s57 offen sc1
  s_mov_b32 exec_hi, 0
  s_cbranch_execz Lob2
  buffer_store_dwordx2 v[220:221], v13, s[12:15], s59 offen sc1
Lob2:
  s_mov_b64 exec, -1
  s_add_u32 s57, s57, 151552
  s_add_u32 s59, s59, 151552
  s_waitcnt lgkmcnt(0)
  v_cndmask_b32 v248, v240, v208, s[36:37]
  v_cndmask_b32 v249, v241, v209, s[36:37]
  v_cndmask_b32 v250, v242, v210, s[36:37]
  v_cndmask_b32 v251, v243, v211, s[36:37]
  v_cndmask_b32 v252, v244, v212, s[36:37]
  v_cndmask_b32 v253, v245, v213, s[36:37]
  v_add_u32 v27, s38, v3
  v_cmp_ge_u32 vcc, s39, v27
  s_add_u32 s38, s38, 16
  s_and_b64 exec, vcc, vcc
  s_cbranch_execz Lob3
  buffer_store_dwordx4 v[248:251], v10, s[12:15], s57 offen sc1
  s_mov_b32 exec_hi, 0
  s_cbranch_execz Lob3
  buffer_store_dwordx2 v[252:253], v13, s[12:15], s59 offen sc1
Lob3:
  s_mov_b64 exec, -1
  s_add_u32 s57, s57, 151552
  s_add_u32 s59, s59, 151552
  v_add_u32 v27, s38, v3
  v_cmp_ge_u32 vcc, s39, v27
  s_add_u32 s38, s38, 16
  s_and_b64 exec, vcc, vcc
  s_cbranch_execz Lob4
  buffer_store_dwordx4 v[240:243], v10, s[12:15], s57 offen sc1
  s_mov_b32 exec_hi, 0
  s_cbranch_execz Lob4
  buffer_store_dwordx2 v[244:245], v13, s[12:15], s59 offen sc1
Lob4:
  s_mov_b64 exec, -1
  s_add_u32 s57, s57, 151552
  s_add_u32 s59, s59, 151552
  s_waitcnt lgkmcnt(0)
  s_cmp_eq_u32 s22, 5
  s_cbranch_scc1 LvA5
  s_branch LvA4
LswA:
  s_sub_u32 s4, s44, 4096
  s_subb_u32 s5, s45, 0
  s_mov_b32 s6, 2215936
  s_mov_b32 s8, s4
  s_mov_b32 s9, s5
  s_mov_b32 s10, s6
  s_add_u32 s24, s62, s71
  s_mul_i32 s24, s24, 40960
  s_add_u32 s25, s24, 40960
  s_add_u32 s80, s62, 14
  s_mul_i32 s80, s80, 40960
  s_mov_b32 s81, 573440
  s_mov_b32 s82, s80
  s_mov_b32 s83, s81
  s_cmp_ge_u32 s25, s82
  s_cselect_b32 s34, s83, 0
  s_sub_u32 s25, s25, s34
  s_mov_b32 s26, 122880
  s_mov_b32 s31, s26
  v_mov_b32 v14, v28
  v_mov_b32 v18, v28
  v_add_u32 v22, 40960, v28
  v_mov_b32 v15, v29
  v_mov_b32 v19, v29
  v_add_u32 v23, 40960, v29
  v_mov_b32 v16, v30
  v_mov_b32 v20, v30
  v_add_u32 v24, 40960, v30
  v_mov_b32 v17, v31
  v_mov_b32 v21, v31
  v_add_u32 v25, 40960, v31
  s_branch LswbA
LroleF:
  s_cmp_eq_u32 s23, 6
  s_cbranch_scc1 LroleN
  s_mul_i32 s57, s65, 256
  v_add_u32 v32, s57, v44
  v_and_b32 v33, 3, v1
  v_lshl_add_u32 v32, v33, 3, v32
  v_or_b32 v6, v32, v45
  v_xor_b32 v7, 32, v6
  v_xor_b32 v8, 64, v6
  v_xor_b32 v9, 96, v6
  v_xor_b32 v10, 128, v6
  v_xor_b32 v11, 160, v6
  v_xor_b32 v12, 192, v6
  v_xor_b32 v13, 224, v6
  s_mul_i32 s57, s70, 4
  s_add_u32 s57, s57, s20
  s_mul_i32 s58, s57, 4992
  s_mul_i32 s59, s57, 1920
  v_lshlrev_b32 v32, 7, v1
  v_mov_b32 v33, 0x70000000
  v_add_u32 v54, s58, v32
  v_cmp_gt_u32 vcc, 39, v1
  v_add_u32 v55, s59, v32
  s_mov_b32 s42, 819200
  v_cndmask_b32 v54, v33, v54, vcc
  v_cmp_gt_u32 vcc, 15, v1
  s_mov_b32 s43, 0x20000
  s_nop 0
  v_cndmask_b32 v55, v33, v55, vcc
  s_mov_b32 s28, 9
  s_mov_b32 s29, 12288
  s_add_u32 s35, s33, 24576
  s_mov_b32 s69, s29
  s_mov_b32 s68, 4294942720
  s_waitcnt vmcnt(6)
  s_barrier
  ds_read_b128 a[0:3], v4 offset:0
  ds_read_b128 a[4:7], v4 offset:2048
  ds_read_b128 a[8:11], v4 offset:40960
  ds_read_b128 a[12:15], v4 offset:43008
  ds_read_b64_tr_b16 a[16:17], v6 offset:0
  ds_read_b64_tr_b16 a[18:19], v6 offset:2048
  ds_read_b64_tr_b16 a[20:21], v7 offset:0
  ds_read_b64_tr_b16 a[22:23], v7 offset:2048
  ds_read_b64_tr_b16 a[24:25], v8 offset:0
  ds_read_b64_tr_b16 a[26:27], v8 offset:2048
  ds_read_b64_tr_b16 a[28:29], v9 offset:0
  ds_read_b64_tr_b16 a[30:31], v9 offset:2048
  ds_read_b64_tr_b16 a[32:33], v10 offset:0
  ds_read_b64_tr_b16 a[34:35], v10 offset:2048
  ds_read_b64_tr_b16 a[36:37], v11 offset:0
  ds_read_b64_tr_b16 a[38:39], v11 offset:2048
  ds_read_b64_tr_b16 a[40:41], v12 offset:0
  ds_read_b64_tr_b16 a[42:43], v12 offset:2048
  ds_read_b64_tr_b16 a[44:45], v13 offset:0
  ds_read_b64_tr_b16 a[46:47], v13 offset:2048
  s_waitcnt lgkmcnt(0)
  v_mfma_f32_16x16x32_bf16 v[128:131], a[16:19], a[0:3], 0
  ds_read_b128 a[48:51], v5 offset:0
  v_mfma_f32_16x16x32_bf16 v[132:135], a[20:23], a[0:3], 0
  ds_read_b128 a[52:55], v5 offset:2048
  buffer_load_dwordx4 v20, s[8:11], s25 offen offset:2048 lds
  v_add_u32 v4, s29, v4
  v_mfma_f32_16x16x32_bf16 v[136:139], a[24:27], a[0:3], 0
  ds_read_b128 a[56:59], v5 offset:40960
  v_mfma_f32_16x16x32_bf16 v[140:143], a[28:31], a[0:3], 0
  ds_read_b128 a[60:63], v5 offset:43008
  buffer_load_dwordx4 v21, s[8:11], s25 offen offset:3072 lds
  v_mfma_f32_16x16x32_bf16 v[144:147], a[32:35], a[0:3], 0
  ds_read_b64_tr_b16 a[64:65], v6 offset:4096
  v_add_u32 v5, s29, v5
  v_mfma_f32_16x16x32_bf16 v[148:151], a[36:39], a[0:3], 0
  ds_read_b64_tr_b16 a[66:67], v6 offset:6144
  s_add_u32 m0, m0, 4096
  s_nop 0
  buffer_load_dwordx4 v22, s[8:11], s25 offen offset:0 lds
  v_mfma_f32_16x16x32_bf16 v[152:155], a[40:43], a[0:3], 0
  ds_read_b64_tr_b16 a[68:69], v7 offset:4096
  v_add_u32 v6, s29, v6
  v_mfma_f32_16x16x32_bf16 v[156:159], a[44:47], a[0:3], 0
  ds_read_b64_tr_b16 a[70:71], v7 offset:6144
  buffer_load_dwordx4 v23, s[8:11], s25 offen offset:1024 lds
  v_mfma_f32_16x16x32_bf16 v[160:163], a[16:19], a[4:7], 0
  ds_read_b64_tr_b16 a[72:73], v8 offset:4096
  v_add_u32 v7, s29, v7
  v_mfma_f32_16x16x32_bf16 v[164:167], a[20:23], a[4:7], 0
  ds_read_b64_tr_b16 a[74:75], v8 offset:6144
  buffer_load_dwordx4 v24, s[8:11], s25 offen offset:2048 lds
  v_mfma_f32_16x16x32_bf16 v[168:171], a[24:27], a[4:7], 0
  ds_read_b64_tr_b16 a[76:77], v9 offset:4096
  v_add_u32 v8, s29, v8
  v_mfma_f32_16x16x32_bf16 v[172:175], a[28:31], a[4:7], 0
  ds_read_b64_tr_b16 a[78:79], v9 offset:6144
  v_mfma_f32_16x16x32_bf16 v[176:179], a[32:35], a[4:7], 0
  ds_read_b64_tr_b16 a[80:81], v10 offset:4096
  buffer_load_dwordx4 v25, s[8:11], s25 offen offset:3072 lds
  s_add_u32 s25, s25, s31
  s_cmp_ge_u32 s25, s82
  s_cselect_b32 s34, s83, 0
  s_sub_u32 s25, s25, s34
  v_add_u32 v9, s29, v9
  v_mfma_f32_16x16x32_bf16 v[180:183], a[36:39], a[4:7], 0
  ds_read_b64_tr_b16 a[82:83], v10 offset:6144
  v_mfma_f32_16x16x32_bf16 v[184:187], a[40:43], a[4:7], 0
  ds_read_b64_tr_b16 a[84:85], v11 offset:4096
  s_mov_b32 m0, s27
  s_nop 0
  buffer_load_dwordx4 v14, s[4:7], s24 offen offset:0 lds
  v_add_u32 v10, s29, v10
  v_mfma_f32_16x16x32_bf16 v[188:191], a[44:47], a[4:7], 0
  ds_read_b64_tr_b16 a[86:87], v11 offset:6144
  v_mfma_f32_16x16x32_bf16 v[192:195], a[16:19], a[8:11], 0
  ds_read_b64_tr_b16 a[88:89], v12 offset:4096
  buffer_load_dwordx4 v15, s[4:7], s24 offen offset:1024 lds
  v_add_u32 v11, s29, v11
  v_mfma_f32_16x16x32_bf16 v[196:199], a[20:23], a[8:11], 0
  ds_read_b64_tr_b16 a[90:91], v12 offset:6144
  v_mfma_f32_16x16x32_bf16 v[200:203], a[24:27], a[8:11], 0
  ds_read_b64_tr_b16 a[92:93], v13 offset:4096
  buffer_load_dwordx4 v16, s[4:7], s24 offen offset:2048 lds
  v_add_u32 v12, s29, v12
  v_mfma_f32_16x16x32_bf16 v[204:207], a[28:31], a[8:11], 0
  ds_read_b64_tr_b16 a[94:95], v13 offset:6144
  v_mfma_f32_16x16x32_bf16 v[208:211], a[32:35], a[8:11], 0
  v_add_u32 v13, s29, v13
  v_mfma_f32_16x16x32_bf16 v[212:215], a[36:39], a[8:11], 0
  buffer_load_dwordx4 v17, s[4:7], s24 offen offset:3072 lds
  v_mfma_f32_16x16x32_bf16 v[216:219], a[40:43], a[8:11], 0
  v_mfma_f32_16x16x32_bf16 v[220:223], a[44:47], a[8:11], 0
  s_add_u32 m0, m0, 4096
  s_nop 0
  buffer_load_dwordx4 v18, s[8:11], s25 offen offset:0 lds
  v_mfma_f32_16x16x32_bf16 v[224:227], a[16:19], a[12:15], 0
  v_mfma_f32_16x16x32_bf16 v[228:231], a[20:23], a[12:15], 0
  buffer_load_dwordx4 v19, s[8:11], s25 offen offset:1024 lds
  v_mfma_f32_16x16x32_bf16 v[232:235], a[24:27], a[12:15], 0
  v_mfma_f32_16x16x32_bf16 v[236:239], a[28:31], a[12:15], 0
  s_add_u32 s24, s24, s26
  s_cmp_ge_u32 s24, s80
  s_cselect_b32 s34, s81, 0
  s_sub_u32 s24, s24, s34
  s_add_u32 s27, s27, 12288
  s_cmp_eq_u32 s27, s32
  s_cselect_b32 s27, s33, s27
  v_mfma_f32_16x16x32_bf16 v[240:243], a[32:35], a[12:15], 0
  v_mfma_f32_16x16x32_bf16 v[244:247], a[36:39], a[12:15], 0
  v_mfma_f32_16x16x32_bf16 v[248:251], a[40:43], a[12:15], 0
  v_mfma_f32_16x16x32_bf16 v[252:255], a[44:47], a[12:15], 0
  s_waitcnt vmcnt(6) lgkmcnt(0)
  s_barrier
  v_mfma_f32_16x16x32_bf16 v[128:131], a[64:67], a[48:51], v[128:131]
  ds_read_b128 a[0:3], v4 offset:0
  v_mfma_f32_16x16x32_bf16 v[132:135], a[68:71], a[48:51], v[132:135]
  ds_read_b128 a[4:7], v4 offset:2048
  buffer_load_dwordx4 v20, s[8:11], s25 offen offset:2048 lds
  v_mfma_f32_16x16x32_bf16 v[136:139], a[72:75], a[48:51], v[136:139]
  ds_read_b128 a[8:11], v4 offset:40960
  v_mfma_f32_16x16x32_bf16 v[140:143], a[76:79], a[48:51], v[140:143]
  ds_read_b128 a[12:15], v4 offset:43008
  buffer_load_dwordx4 v21, s[8:11], s25 offen offset:3072 lds
  v_mfma_f32_16x16x32_bf16 v[144:147], a[80:83], a[48:51], v[144:147]
  ds_read_b64_tr_b16 a[16:17], v6 offset:0
  v_mfma_f32_16x16x32_bf16 v[148:151], a[84:87], a[48:51], v[148:151]
  ds_read_b64_tr_b16 a[18:19], v6 offset:2048
  s_add_u32 m0, m0, 4096
  s_nop 0
  buffer_load_dwordx4 v22, s[8:11], s25 offen offset:0 lds
  v_mfma_f32_16x16x32_bf16 v[152:155], a[88:91], a[48:51], v[152:155]
  ds_read_b64_tr_b16 a[20:21], v7 offset:0
  v_mfma_f32_16x16x32_bf16 v[156:159], a[92:95], a[48:51], v[156:159]
  ds_read_b64_tr_b16 a[22:23], v7 offset:2048
  buffer_load_dwordx4 v23, s[8:11], s25 offen offset:1024 lds
  v_mfma_f32_16x16x32_bf16 v[160:163], a[64:67], a[52:55], v[160:163]
  ds_read_b64_tr_b16 a[24:25], v8 offset:0
  v_mfma_f32_16x16x32_bf16 v[164:167], a[68:71], a[52:55], v[164:167]
  ds_read_b64_tr_b16 a[26:27], v8 offset:2048
  buffer_load_dwordx4 v24, s[8:11], s25 offen offset:2048 lds
  v_mfma_f32_16x16x32_bf16 v[168:171], a[72:75], a[52:55], v[168:171]
  ds_read_b64_tr_b16 a[28:29], v9 offset:0
  v_mfma_f32_16x16x32_bf16 v[172:175], a[76:79], a[52:55], v[172:175]
  ds_read_b64_tr_b16 a[30:31], v9 offset:2048
  buffer_load_dwordx4 v25, s[8:11], s25 offen offset:3072 lds
  s_add_u32 s25, s25, s31
  s_cmp_ge_u32 s25, s82
  s_cselect_b32 s34, s83, 0
  s_sub_u32 s25, s25, s34
  v_mfma_f32_16x16x32_bf16 v[176:179], a[80:83], a[52:55], v[176:179]
  ds_read_b64_tr_b16 a[32:33], v10 offset:0
  v_mfma_f32_16x16x32_bf16 v[180:183], a[84:87], a[52:55], v[180:183]
  ds_read_b64_tr_b16 a[34:35], v10 offset:2048
  s_mov_b32 m0, s27
  s_nop 0
  buffer_load_dwordx4 v14, s[4:7], s24 offen offset:0 lds
  v_mfma_f32_16x16x32_bf16 v[184:187], a[88:91], a[52:55], v[184:187]
  ds_read_b64_tr_b16 a[36:37], v11 offset:0
  v_mfma_f32_16x16x32_bf16 v[188:191], a[92:95], a[52:55], v[188:191]
  ds_read_b64_tr_b16 a[38:39], v11 offset:2048
  buffer_load_dwordx4 v15, s[4:7], s24 offen offset:1024 lds
  v_mfma_f32_16x16x32_bf16 v[192:195], a[64:67], a[56:59], v[192:195]
  ds_read_b64_tr_b16 a[40:41], v12 offset:0
  v_mfma_f32_16x16x32_bf16 v[196:199], a[68:71], a[56:59], v[196:199]
  ds_read_b64_tr_b16 a[42:43], v12 offset:2048
  buffer_load_dwordx4 v16, s[4:7], s24 offen offset:2048 lds
  v_mfma_f32_16x16x32_bf16 v[200:203], a[72:75], a[56:59], v[200:203]
  ds_read_b64_tr_b16 a[44:45], v13 offset:0
  v_mfma_f32_16x16x32_bf16 v[204:207], a[76:79], a[56:59], v[204:207]
  ds_read_b64_tr_b16 a[46:47], v13 offset:2048
  buffer_load_dwordx4 v17, s[4:7], s24 offen offset:3072 lds
  v_mfma_f32_16x16x32_bf16 v[208:211], a[80:83], a[56:59], v[208:211]
  v_mfma_f32_16x16x32_bf16 v[212:215], a[84:87], a[56:59], v[212:215]
  s_add_u32 m0, m0, 4096
  s_nop 0
  buffer_load_dwordx4 v18, s[8:11], s25 offen offset:0 lds
  v_mfma_f32_16x16x32_bf16 v[216:219], a[88:91], a[56:59], v[216:219]
  v_mfma_f32_16x16x32_bf16 v[220:223], a[92:95], a[56:59], v[220:223]
  buffer_load_dwordx4 v19, s[8:11], s25 offen offset:1024 lds
  v_mfma_f32_16x16x32_bf16 v[224:227], a[64:67], a[60:63], v[224:227]
  v_mfma_f32_16x16x32_bf16 v[228:231], a[68:71], a[60:63], v[228:231]
  v_lshrrev_b32 v41, 5, v0
  v_lshl_add_u32 v41, s2, 3, v41
  v_mul_u32_u24 v41, 768, v41
  v_and_b32 v40, 31, v0
  v_lshl_add_u32 v40, v40, 7, v41
  v_add_u32 v40, 1048576, v40
  v_min_u32 v41, 2211712, v40
  v_min_u32 v40, 2457472, v40
  s_mov_b32 exec_lo, 63
  s_mov_b32 exec_hi, 63
  global_load_dword a247, v42, s[36:37] offset:512
  global_load_dword a246, v40, s[38:39]
  global_load_dword a245, v41, s[18:19]
  s_mov_b64 exec, -1
  v_mfma_f32_16x16x32_bf16 v[232:235], a[72:75], a[60:63], v[232:235]
  v_mfma_f32_16x16x32_bf16 v[236:239], a[76:79], a[60:63], v[236:239]
  s_add_u32 s24, s24, s26
  s_cmp_ge_u32 s24, s80
  s_cselect_b32 s34, s81, 0
  s_sub_u32 s24, s24, s34
  s_add_u32 s27, s27, 12288
  s_cmp_eq_u32 s27, s32
  s_cselect_b32 s27, s33, s27
  s_cmp_eq_u32 s27, s35
  s_cselect_b32 s29, s68, s69
  v_mfma_f32_16x16x32_bf16 v[240:243], a[80:83], a[60:63], v[240:243]
  v_mfma_f32_16x16x32_bf16 v[244:247], a[84:87], a[60:63], v[244:247]
  v_mfma_f32_16x16x32_bf16 v[248:251], a[88:91], a[60:63], v[248:251]
  v_mfma_f32_16x16x32_bf16 v[252:255], a[92:95], a[60:63], v[252:255]
  s_waitcnt lgkmcnt(0)
Lp1loopF:
  v_mfma_f32_16x16x32_bf16 v[128:131], a[16:19], a[0:3], v[128:131]
  ds_read_b128 a[48:51], v5 offset:0
  v_add_u32 v4, s29, v4
  v_mfma_f32_16x16x32_bf16 v[132:135], a[20:23], a[0:3], v[132:135]
  ds_read_b128 a[52:55], v5 offset:2048
  v_mfma_f32_16x16x32_bf16 v[136:139], a[24:27], a[0:3], v[136:139]
  ds_read_b128 a[56:59], v5 offset:40960
  v_mfma_f32_16x16x32_bf16 v[140:143], a[28:31], a[0:3], v[140:143]
  ds_read_b128 a[60:63], v5 offset:43008
  v_mfma_f32_16x16x32_bf16 v[144:147], a[32:35], a[0:3], v[144:147]
  buffer_load_dwordx4 v20, s[8:11], s25 offen offset:2048 lds
  v_mfma_f32_16x16x32_bf16 v[148:151], a[36:39], a[0:3], v[148:151]
  ds_read_b64_tr_b16 a[64:65], v6 offset:4096
  v_add_u32 v5, s29, v5
  v_mfma_f32_16x16x32_bf16 v[152:155], a[40:43], a[0:3], v[152:155]
  ds_read_b64_tr_b16 a[66:67], v6 offset:6144
  v_mfma_f32_16x16x32_bf16 v[156:159], a[44:47], a[0:3], v[156:159]
  ds_read_b64_tr_b16 a[68:69], v7 offset:4096
  v_add_u32 v6, s29, v6
  v_mfma_f32_16x16x32_bf16 v[160:163], a[16:19], a[4:7], v[160:163]
  ds_read_b64_tr_b16 a[70:71], v7 offset:6144
  v_mfma_f32_16x16x32_bf16 v[164:167], a[20:23], a[4:7], v[164:167]
  buffer_load_dwordx4 v21, s[8:11], s25 offen offset:3072 lds
  v_mfma_f32_16x16x32_bf16 v[168:171], a[24:27], a[4:7], v[168:171]
  ds_read_b64_tr_b16 a[72:73], v8 offset:4096
  v_add_u32 v7, s29, v7
  v_mfma_f32_16x16x32_bf16 v[172:175], a[28:31], a[4:7], v[172:175]
  ds_read_b64_tr_b16 a[74:75], v8 offset:6144
  v_mfma_f32_16x16x32_bf16 v[176:179], a[32:35], a[4:7], v[176:179]
  ds_read_b64_tr_b16 a[76:77], v9 offset:4096
  v_add_u32 v8, s29, v8
  v_mfma_f32_16x16x32_bf16 v[180:183], a[36:39], a[4:7], v[180:183]
  s_add_u32 m0, m0, 4096
  ds_read_b64_tr_b16 a[78:79], v9 offset:6144
  v_mfma_f32_16x16x32_bf16 v[184:187], a[40:43], a[4:7], v[184:187]
  buffer_load_dwordx4 v22, s[8:11], s25 offen offset:0 lds
  v_mfma_f32_16x16x32_bf16 v[188:191], a[44:47], a[4:7], v[188:191]
  ds_read_b64_tr_b16 a[80:81], v10 offset:4096
  v_add_u32 v9, s29, v9
  v_mfma_f32_16x16x32_bf16 v[192:195], a[16:19], a[8:11], v[192:195]
  ds_read_b64_tr_b16 a[82:83], v10 offset:6144
  v_mfma_f32_16x16x32_bf16 v[196:199], a[20:23], a[8:11], v[196:199]
  ds_read_b64_tr_b16 a[84:85], v11 offset:4096
  v_add_u32 v10, s29, v10
  v_mfma_f32_16x16x32_bf16 v[200:203], a[24:27], a[8:11], v[200:203]
  ds_read_b64_tr_b16 a[86:87], v11 offset:6144
  v_mfma_f32_16x16x32_bf16 v[204:207], a[28:31], a[8:11], v[204:207]
  buffer_load_dwordx4 v23, s[8:11], s25 offen offset:1024 lds
  v_mfma_f32_16x16x32_bf16 v[208:211], a[32:35], a[8:11], v[208:211]
  ds_read_b64_tr_b16 a[88:89], v12 offset:4096
  v_add_u32 v11, s29, v11
  v_mfma_f32_16x16x32_bf16 v[212:215], a[36:39], a[8:11], v[212:215]
  ds_read_b64_tr_b16 a[90:91], v12 offset:6144
  v_mfma_f32_16x16x32_bf16 v[216:219], a[40:43], a[8:11], v[216:219]
  ds_read_b64_tr_b16 a[92:93], v13 offset:4096
  v_add_u32 v12, s29, v12
  v_mfma_f32_16x16x32_bf16 v[220:223], a[44:47], a[8:11], v[220:223]
  buffer_load_dwordx4 v24, s[8:11], s25 offen offset:2048 lds
  v_mfma_f32_16x16x32_bf16 v[224:227], a[16:19], a[12:15], v[224:227]
  ds_read_b64_tr_b16 a[94:95], v13 offset:6144
  v_mfma_f32_16x16x32_bf16 v[228:231], a[20:23], a[12:15], v[228:231]
  v_add_u32 v13, s29, v13
  v_mfma_f32_16x16x32_bf16 v[232:235], a[24:27], a[12:15], v[232:235]
  buffer_load_dwordx4 v25, s[8:11], s25 offen offset:3072 lds
  v_mfma_f32_16x16x32_bf16 v[236:239], a[28:31], a[12:15], v[236:239]
  s_add_u32 s25, s25, s31
  s_cmp_ge_u32 s25, s82
  v_mfma_f32_16x16x32_bf16 v[240:243], a[32:35], a[12:15], v[240:243]
  s_cselect_b32 s34, s83, 0
  s_sub_u32 s25, s25, s34
  v_mfma_f32_16x16x32_bf16 v[244:247], a[36:39], a[12:15], v[244:247]
  s_cmp_eq_u32 s28, 3
  s_cbranch_scc1 LswF
LswbF:
  v_mfma_f32_16x16x32_bf16 v[248:251], a[40:43], a[12:15], v[248:251]
  v_mfma_f32_16x16x32_bf16 v[252:255], a[44:47], a[12:15], v[252:255]
  s_waitcnt vmcnt(12) lgkmcnt(0)
  s_barrier
  s_sub_u32 s34, 4, s28
  s_cmp_lt_u32 s34, 1
  s_cbranch_scc1 LtcF
LtcbF:
  v_mfma_f32_16x16x32_bf16 v[128:131], a[64:67], a[48:51], v[128:131]
  ds_read_b128 a[0:3], v4 offset:0
  v_mfma_f32_16x16x32_bf16 v[132:135], a[68:71], a[48:51], v[132:135]
  ds_read_b128 a[4:7], v4 offset:2048
  v_mfma_f32_16x16x32_bf16 v[136:139], a[72:75], a[48:51], v[136:139]
  ds_read_b128 a[8:11], v4 offset:40960
  v_mfma_f32_16x16x32_bf16 v[140:143], a[76:79], a[48:51], v[140:143]
  s_mov_b32 m0, s27
  ds_read_b128 a[12:15], v4 offset:43008
  v_mfma_f32_16x16x32_bf16 v[144:147], a[80:83], a[48:51], v[144:147]
  buffer_load_dwordx4 v14, s[4:7], s24 offen offset:0 lds
  v_mfma_f32_16x16x32_bf16 v[148:151], a[84:87], a[48:51], v[148:151]
  ds_read_b64_tr_b16 a[16:17], v6 offset:0
  v_mfma_f32_16x16x32_bf16 v[152:155], a[88:91], a[48:51], v[152:155]
  ds_read_b64_tr_b16 a[18:19], v6 offset:2048
  v_mfma_f32_16x16x32_bf16 v[156:159], a[92:95], a[48:51], v[156:159]
  ds_read_b64_tr_b16 a[20:21], v7 offset:0
  v_mfma_f32_16x16x32_bf16 v[160:163], a[64:67], a[52:55], v[160:163]
  ds_read_b64_tr_b16 a[22:23], v7 offset:2048
  v_mfma_f32_16x16x32_bf16 v[164:167], a[68:71], a[52:55], v[164:167]
  buffer_load_dwordx4 v15, s[4:7], s24 offen offset:1024 lds
  v_mfma_f32_16x16x32_bf16 v[168:171], a[72:75], a[52:55], v[168:171]
  ds_read_b64_tr_b16 a[24:25], v8 offset:0
  v_mfma_f32_16x16x32_bf16 v[172:175], a[76:79], a[52:55], v[172:175]
  ds_read_b64_tr_b16 a[26:27], v8 offset:2048
  v_mfma_f32_16x16x32_bf16 v[176:179], a[80:83], a[52:55], v[176:179]
  ds_read_b64_tr_b16 a[28:29], v9 offset:0
  v_mfma_f32_16x16x32_bf16 v[180:183], a[84:87], a[52:55], v[180:183]
  ds_read_b64_tr_b16 a[30:31], v9 offset:2048
  v_mfma_f32_16x16x32_bf16 v[184:187], a[88:91], a[52:55], v[184:187]
  buffer_load_dwordx4 v16, s[4:7], s24 offen offset:2048 lds
  v_mfma_f32_16x16x32_bf16 v[188:191], a[92:95], a[52:55], v[188:191]
  ds_read_b64_tr_b16 a[32:33], v10 offset:0
  v_mfma_f32_16x16x32_bf16 v[192:195], a[64:67], a[56:59], v[192:195]
  ds_read_b64_tr_b16 a[34:35], v10 offset:2048
  v_mfma_f32_16x16x32_bf16 v[196:199], a[68:71], a[56:59], v[196:199]
  ds_read_b64_tr_b16 a[36:37], v11 offset:0
  v_mfma_f32_16x16x32_bf16 v[200:203], a[72:75], a[56:59], v[200:203]
  ds_read_b64_tr_b16 a[38:39], v11 offset:2048
  v_mfma_f32_16x16x32_bf16 v[204:207], a[76:79], a[56:59], v[204:207]
  buffer_load_dwordx4 v17, s[4:7], s24 offen offset:3072 lds
  v_mfma_f32_16x16x32_bf16 v[208:211], a[80:83], a[56:59], v[208:211]
  ds_read_b64_tr_b16 a[40:41], v12 offset:0
  v_mfma_f32_16x16x32_bf16 v[212:215], a[84:87], a[56:59], v[212:215]
  ds_read_b64_tr_b16 a[42:43], v12 offset:2048
  v_mfma_f32_16x16x32_bf16 v[216:219], a[88:91], a[56:59], v[216:219]
  s_add_u32 m0, m0, 4096
  ds_read_b64_tr_b16 a[44:45], v13 offset:0
  v_mfma_f32_16x16x32_bf16 v[220:223], a[92:95], a[56:59], v[220:223]
  buffer_load_dwordx4 v18, s[8:11], s25 offen offset:0 lds
  v_mfma_f32_16x16x32_bf16 v[224:227], a[64:67], a[60:63], v[224:227]
  ds_read_b64_tr_b16 a[46:47], v13 offset:2048
  s_add_u32 s24, s24, s26
  v_mfma_f32_16x16x32_bf16 v[228:231], a[68:71], a[60:63], v[228:231]
  s_cmp_ge_u32 s24, s80
  s_cselect_b32 s34, s81, 0
  v_mfma_f32_16x16x32_bf16 v[232:235], a[72:75], a[60:63], v[232:235]
  buffer_load_dwordx4 v19, s[8:11], s25 offen offset:1024 lds
  v_mfma_f32_16x16x32_bf16 v[236:239], a[76:79], a[60:63], v[236:239]
  s_sub_u32 s24, s24, s34
  s_add_u32 s27, s27, 12288
  v_mfma_f32_16x16x32_bf16 v[240:243], a[80:83], a[60:63], v[240:243]
  s_cmp_eq_u32 s27, s32
  s_cselect_b32 s27, s33, s27
  v_mfma_f32_16x16x32_bf16 v[244:247], a[84:87], a[60:63], v[244:247]
  s_cmp_eq_u32 s27, s35
  s_cselect_b32 s29, s68, s69
  v_mfma_f32_16x16x32_bf16 v[248:251], a[88:91], a[60:63], v[248:251]
  s_sub_u32 s28, s28, 1
  s_cmp_lg_u32 s28, 0
  v_mfma_f32_16x16x32_bf16 v[252:255], a[92:95], a[60:63], v[252:255]
  s_waitcnt lgkmcnt(0)
  s_cbranch_scc1 Lp1loopF
  s_lshl_b32 s57, s22, 3
  s_add_u32 s57, s57, s64
  s_lshl_b32 s59, s57, 6
  s_mul_i32 s57, s57, 75776
  s_lshl_b32 s58, s23, 13
  s_add_u32 s57, s57, s58
  s_mul_i32 s58, s65, 4096
  s_add_u32 s57, s57, s58
  v_lshlrev_b32 v4, 4, v1
  buffer_load_ubyte v105, v105, s[72:75], 0 offen sc1
  global_load_dword a254, v26, s[16:17]
  v_cvt_pk_bf16_f32 v32, v128, v129
  v_cvt_pk_bf16_f32 v33, v130, v131
  v_cvt_pk_bf16_f32 v34, v132, v133
  v_cvt_pk_bf16_f32 v35, v134, v135
  v_pk_max_i16 v32, v32, 0
  v_pk_max_i16 v33, v33, 0
  v_pk_max_i16 v34, v34, 0
  v_pk_max_i16 v35, v35, 0
  buffer_store_dwordx4 v[32:35], v4, s[12:15], s57 offen offset:0 sc1
  v_cvt_pk_bf16_f32 v36, v136, v137
  v_cvt_pk_bf16_f32 v37, v138, v139
  v_cvt_pk_bf16_f32 v38, v140, v141
  v_cvt_pk_bf16_f32 v39, v142, v143
  v_pk_max_i16 v36, v36, 0
  v_pk_max_i16 v37, v37, 0
  v_pk_max_i16 v38, v38, 0
  v_pk_max_i16 v39, v39, 0
  buffer_store_dwordx4 v[36:39], v4, s[12:15], s57 offen offset:1024 sc1
  v_cvt_pk_bf16_f32 v40, v144, v145
  v_cvt_pk_bf16_f32 v41, v146, v147
  v_cvt_pk_bf16_f32 v42, v148, v149
  v_cvt_pk_bf16_f32 v43, v150, v151
  v_pk_max_i16 v40, v40, 0
  v_pk_max_i16 v41, v41, 0
  v_pk_max_i16 v42, v42, 0
  v_pk_max_i16 v43, v43, 0
  buffer_store_dwordx4 v[40:43], v4, s[12:15], s57 offen offset:2048 sc1
  v_cvt_pk_bf16_f32 v44, v152, v153
  v_cvt_pk_bf16_f32 v45, v154, v155
  v_cvt_pk_bf16_f32 v46, v156, v157
  v_cvt_pk_bf16_f32 v47, v158, v159
  v_pk_max_i16 v44, v44, 0
  v_pk_max_i16 v45, v45, 0
  v_pk_max_i16 v46, v46, 0
  v_pk_max_i16 v47, v47, 0
  buffer_store_dwordx4 v[44:47], v4, s[12:15], s57 offen offset:3072 sc1
  s_add_u32 s57, s57, 151552
  v_cvt_pk_bf16_f32 v32, v160, v161
  v_cvt_pk_bf16_f32 v33, v162, v163
  v_cvt_pk_bf16_f32 v34, v164, v165
  v_cvt_pk_bf16_f32 v35, v166, v167
  v_pk_max_i16 v32, v32, 0
  v_pk_max_i16 v33, v33, 0
  v_pk_max_i16 v34, v34, 0
  v_pk_max_i16 v35, v35, 0
  buffer_store_dwordx4 v[32:35], v4, s[12:15], s57 offen offset:0 sc1
  v_cvt_pk_bf16_f32 v36, v168, v169
  v_cvt_pk_bf16_f32 v37, v170, v171
  v_cvt_pk_bf16_f32 v38, v172, v173
  v_cvt_pk_bf16_f32 v39, v174, v175
  v_pk_max_i16 v36, v36, 0
  v_pk_max_i16 v37, v37, 0
  v_pk_max_i16 v38, v38, 0
  v_pk_max_i16 v39, v39, 0
  buffer_store_dwordx4 v[36:39], v4, s[12:15], s57 offen offset:1024 sc1
  v_cvt_pk_bf16_f32 v40, v176, v177
  v_cvt_pk_bf16_f32 v41, v178, v179
  v_cvt_pk_bf16_f32 v42, v180, v181
  v_cvt_pk_bf16_f32 v43, v182, v183
  v_pk_max_i16 v40, v40, 0
  v_pk_max_i16 v41, v41, 0
  v_pk_max_i16 v42, v42, 0
  v_pk_max_i16 v43, v43, 0
  buffer_store_dwordx4 v[40:43], v4, s[12:15], s57 offen offset:2048 sc1
  v_cvt_pk_bf16_f32 v44, v184, v185
  v_cvt_pk_bf16_f32 v45, v186, v187
  v_cvt_pk_bf16_f32 v46, v188, v189
  v_cvt_pk_bf16_f32 v47, v190, v191
  v_pk_max_i16 v44, v44, 0
  v_pk_max_i16 v45, v45, 0
  v_pk_max_i16 v46, v46, 0
  v_pk_max_i16 v47, v47, 0
  buffer_store_dwordx4 v[44:47], v4, s[12:15], s57 offen offset:3072 sc1
  s_add_u32 s57, s57, 151552
  v_cvt_pk_bf16_f32 v32, v192, v193
  v_cvt_pk_bf16_f32 v33, v194, v195
  v_cvt_pk_bf16_f32 v34, v196, v197
  v_cvt_pk_bf16_f32 v35, v198, v199
  v_pk_max_i16 v32, v32, 0
  v_pk_max_i16 v33, v33, 0
  v_pk_max_i16 v34, v34, 0
  v_pk_max_i16 v35, v35, 0
  buffer_store_dwordx4 v[32:35], v4, s[12:15], s57 offen offset:0 sc1
  v_cvt_pk_bf16_f32 v36, v200, v201
  v_cvt_pk_bf16_f32 v37, v202, v203
  v_cvt_pk_bf16_f32 v38, v204, v205
  v_cvt_pk_bf16_f32 v39, v206, v207
  v_pk_max_i16 v36, v36, 0
  v_pk_max_i16 v37, v37, 0
  v_pk_max_i16 v38, v38, 0
  v_pk_max_i16 v39, v39, 0
  buffer_store_dwordx4 v[36:39], v4, s[12:15], s57 offen offset:1024 sc1
  v_cvt_pk_bf16_f32 v40, v208, v209
  v_cvt_pk_bf16_f32 v41, v210, v211
  v_cvt_pk_bf16_f32 v42, v212, v213
  v_cvt_pk_bf16_f32 v43, v214, v215
  v_pk_max_i16 v40, v40, 0
  v_pk_max_i16 v41, v41, 0
  v_pk_max_i16 v42, v42, 0
  v_pk_max_i16 v43, v43, 0
  buffer_store_dwordx4 v[40:43], v4, s[12:15], s57 offen offset:2048 sc1
  v_cvt_pk_bf16_f32 v44, v216, v217
  v_cvt_pk_bf16_f32 v45, v218, v219
  v_cvt_pk_bf16_f32 v46, v220, v221
  v_cvt_pk_bf16_f32 v47, v222, v223
  v_pk_max_i16 v44, v44, 0
  v_pk_max_i16 v45, v45, 0
  v_pk_max_i16 v46, v46, 0
  v_pk_max_i16 v47, v47, 0
  buffer_store_dwordx4 v[44:47], v4, s[12:15], s57 offen offset:3072 sc1
  s_add_u32 s57, s57, 151552
  v_cvt_pk_bf16_f32 v32, v224, v225
  v_cvt_pk_bf16_f32 v33, v226, v227
  v_cvt_pk_bf16_f32 v34, v228, v229
  v_cvt_pk_bf16_f32 v35, v230, v231
  v_pk_max_i16 v32, v32, 0
  v_pk_max_i16 v33, v33, 0
  v_pk_max_i16 v34, v34, 0
  v_pk_max_i16 v35, v35, 0
  buffer_store_dwordx4 v[32:35], v4, s[12:15], s57 offen offset:0 sc1
  v_cvt_pk_bf16_f32 v36, v232, v233
  v_cvt_pk_bf16_f32 v37, v234, v235
  v_cvt_pk_bf16_f32 v38, v236, v237
  v_cvt_pk_bf16_f32 v39, v238, v239
  v_pk_max_i16 v36, v36, 0
  v_pk_max_i16 v37, v37, 0
  v_pk_max_i16 v38, v38, 0
  v_pk_max_i16 v39, v39, 0
  buffer_store_dwordx4 v[36:39], v4, s[12:15], s57 offen offset:1024 sc1
  v_cvt_pk_bf16_f32 v40, v240, v241
  v_cvt_pk_bf16_f32 v41, v242, v243
  v_cvt_pk_bf16_f32 v42, v244, v245
  v_cvt_pk_bf16_f32 v43, v246, v247
  v_pk_max_i16 v40, v40, 0
  v_pk_max_i16 v41, v41, 0
  v_pk_max_i16 v42, v42, 0
  v_pk_max_i16 v43, v43, 0
  buffer_store_dwordx4 v[40:43], v4, s[12:15], s57 offen offset:2048 sc1
  v_cvt_pk_bf16_f32 v44, v248, v249
  v_cvt_pk_bf16_f32 v45, v250, v251
  v_cvt_pk_bf16_f32 v46, v252, v253
  v_cvt_pk_bf16_f32 v47, v254, v255
  v_pk_max_i16 v44, v44, 0
  v_pk_max_i16 v45, v45, 0
  v_pk_max_i16 v46, v46, 0
  v_pk_max_i16 v47, v47, 0
  buffer_store_dwordx4 v[44:47], v4, s[12:15], s57 offen offset:3072 sc1
  s_waitcnt vmcnt(12)
  ds_read_b64_tr_b16 a[80:81], v96 offset:12288
  ds_read_b64_tr_b16 a[82:83], v96 offset:14336
  ds_read_b64_tr_b16 a[84:85], v97 offset:12288
  ds_read_b64_tr_b16 a[86:87], v97 offset:14336
  ds_read_b64_tr_b16 a[88:89], v98 offset:12288
  ds_read_b64_tr_b16 a[90:91], v98 offset:14336
  ds_read_b64_tr_b16 a[92:93], v99 offset:12288
  ds_read_b64_tr_b16 a[94:95], v99 offset:14336
  ds_read_b64_tr_b16 a[96:97], v96 offset:16384
  ds_read_b64_tr_b16 a[98:99], v96 offset:18432
  ds_read_b64_tr_b16 a[100:101], v97 offset:16384
  ds_read_b64_tr_b16 a[102:103], v97 offset:18432
  ds_read_b64_tr_b16 a[104:105], v98 offset:16384
  ds_read_b64_tr_b16 a[106:107], v98 offset:18432
  ds_read_b64_tr_b16 a[108:109], v99 offset:16384
  ds_read_b64_tr_b16 a[110:111], v99 offset:18432
  ds_read_b64_tr_b16 a[112:113], v96 offset:20480
  ds_read_b64_tr_b16 a[114:115], v96 offset:22528
  ds_read_b64_tr_b16 a[116:117], v97 offset:20480
  ds_read_b64_tr_b16 a[118:119], v97 offset:22528
  ds_read_b64_tr_b16 a[120:121], v98 offset:20480
  ds_read_b64_tr_b16 a[122:123], v98 offset:22528
  ds_read_b64_tr_b16 a[124:125], v99 offset:20480
  ds_read_b64_tr_b16 a[126:127], v99 offset:22528
  ds_read_b64_tr_b16 a[128:129], v96 offset:24576
  ds_read_b64_tr_b16 a[130:131], v96 offset:26624
  ds_read_b64_tr_b16 a[132:133], v97 offset:24576
  ds_read_b64_tr_b16 a[134:135], v97 offset:26624
  ds_read_b64_tr_b16 a[136:137], v98 offset:24576
  ds_read_b64_tr_b16 a[138:139], v98 offset:26624
  ds_read_b64_tr_b16 a[140:141], v99 offset:24576
  ds_read_b64_tr_b16 a[142:143], v99 offset:26624
  ds_read_b64_tr_b16 a[144:145], v96 offset:28672
  ds_read_b64_tr_b16 a[146:147], v96 offset:30720
  ds_read_b64_tr_b16 a[148:149], v97 offset:28672
  ds_read_b64_tr_b16 a[150:151], v97 offset:30720
  ds_read_b64_tr_b16 a[152:153], v98 offset:28672
  ds_read_b64_tr_b16 a[154:155], v98 offset:30720
  ds_read_b64_tr_b16 a[156:157], v99 offset:28672
  ds_read_b64_tr_b16 a[158:159], v99 offset:30720
  ds_read_b64_tr_b16 a[160:161], v96 offset:32768
  ds_read_b64_tr_b16 a[162:163], v96 offset:34816
  ds_read_b64_tr_b16 a[164:165], v97 offset:32768
  ds_read_b64_tr_b16 a[166:167], v97 offset:34816
  ds_read_b64_tr_b16 a[168:169], v98 offset:32768
  ds_read_b64_tr_b16 a[170:171], v98 offset:34816
  ds_read_b64_tr_b16 a[172:173], v99 offset:32768
  ds_read_b64_tr_b16 a[174:175], v99 offset:34816
  ds_read_b64_tr_b16 a[176:177], v96 offset:0
  ds_read_b64_tr_b16 a[178:179], v96 offset:2048
  ds_read_b64_tr_b16 a[180:181], v97 offset:0
  ds_read_b64_tr_b16 a[182:183], v97 offset:2048
  ds_read_b64_tr_b16 a[184:185], v98 offset:0
  ds_read_b64_tr_b16 a[186:187], v98 offset:2048
  ds_read_b64_tr_b16 a[188:189], v99 offset:0
  ds_read_b64_tr_b16 a[190:191], v99 offset:2048
  s_waitcnt vmcnt(0)
  s_mov_b32 s35, 0x20000
LsnFw:
  v_and_b32 v27, 0x80, v105
  v_cmp_eq_u32 vcc, 0, v27
  s_sub_u32 s35, s35, 1
  s_cmp_eq_u32 s35, 0
  s_cbranch_scc1 LsnFx
  s_cbranch_vccz LsnFx
  v_subrev_u32 v27, 11534336, v104
  v_lshrrev_b32 v27, 7, v27
  buffer_load_ubyte v105, v27, s[72:75], 0 offen sc1
  s_waitcnt vmcnt(0)
  s_branch LsnFw
LsnFx:
  v_and_b32 v105, 1, v105
  v_xor_b32 v105, 1, v105
  s_barrier
  s_cmp_lg_u32 s20, 0
  s_cbranch_scc1 LsigF
  s_mov_b32 exec_lo, 0
  s_mov_b32 exec_hi, 0x10000
  buffer_store_dword v105, v104, s[12:15], 0 offen sc1
  s_mov_b64 exec, -1
LsigF:
  buffer_load_dwordx4 v20, s[8:11], s25 offen offset:2048 lds
  buffer_load_dwordx4 v21, s[8:11], s25 offen offset:3072 lds
  s_add_u32 m0, m0, 4096
  s_nop 0
  buffer_load_dwordx4 v22, s[8:11], s25 offen offset:0 lds
  buffer_load_dwordx4 v23, s[8:11], s25 offen offset:1024 lds
  buffer_load_dwordx4 v24, s[8:11], s25 offen offset:2048 lds
  buffer_load_dwordx4 v25, s[8:11], s25 offen offset:3072 lds
  s_add_u32 m0, s33, 36864
  s_nop 0
  buffer_load_dwordx4 v14, s[4:7], s24 offen offset:0 lds
  buffer_load_dwordx4 v15, s[4:7], s24 offen offset:1024 lds
  buffer_load_dwordx4 v16, s[4:7], s24 offen offset:2048 lds
  buffer_load_dwordx4 v17, s[4:7], s24 offen offset:3072 lds
  s_sub_u32 s76, s40, 4096
  s_subb_u32 s77, s41, 0
  s_mov_b32 s78, 823296
  s_mov_b32 s79, 0x20000
  s_add_u32 s25, s24, 40960
  s_cmp_ge_u32 s25, s82
  s_cselect_b32 s34, s83, 0
  s_sub_u32 s25, s25, s34
  s_mul_i32 s26, s20, 204800
  s_mov_b32 s30, s26
  s_add_u32 s29, s26, 5120
  s_and_b32 s21, s56, 127
  s_bfe_u32 s22, s56, 0x30007
  s_bfe_u32 s23, s56, 0x4000a
  v_lshlrev_b32 v10, 4, v1
  s_mul_i32 s63, s21, 75776
  v_add_u32 v4, s63, v10
  s_add_u32 s63, s63, 75776
  v_add_u32 v5, s63, v10
  s_add_u32 s63, s63, 75776
  v_add_u32 v6, s63, v10
  s_add_u32 s63, s63, 75776
  v_add_u32 v7, s63, v10
  s_add_u32 s63, s63, 75776
  v_add_u32 v8, s63, v10
  s_add_u32 s63, s63, 75776
  v_add_u32 v9, s63, v10
  s_lshl_b32 s18, s62, 10
  s_add_u32 s19, s18, 14336
  s_lshl_b32 s24, s71, 10
  s_add_u32 s24, s24, s18
  s_lshl_b32 s27, s20, 12
  s_add_u32 s27, s27, 55296
  s_lshl_b32 s28, s20, 10
  s_add_u32 s28, s28, 71680
  s_mov_b32 s4, s12
  s_mov_b32 s5, s13
  s_cmp_ge_u32 s20, 2
  s_cselect_b32 s68, 0, s14
  s_cmp_eq_u32 s71, 0
  s_cselect_b32 s6, s68, s14
  s_waitcnt lgkmcnt(0)
  s_add_u32 m0, s33, 12288
  s_nop 0
  buffer_load_dwordx4 v28, s[8:11], s25 offen offset:0 lds
  buffer_load_dwordx4 v29, s[8:11], s25 offen offset:1024 lds
  buffer_load_dwordx4 v30, s[8:11], s25 offen offset:2048 lds
  buffer_load_dwordx4 v31, s[8:11], s25 offen offset:3072 lds
  s_add_u32 s25, s25, 40960
  s_cmp_ge_u32 s25, s82
  s_cselect_b32 s34, s83, 0
  s_sub_u32 s25, s25, s34
  s_add_u32 m0, s33, 16384
  s_nop 0
  buffer_load_dwordx4 v28, s[8:11], s25 offen offset:0 lds
  buffer_load_dwordx4 v29, s[8:11], s25 offen offset:1024 lds
  buffer_load_dwordx4 v30, s[8:11], s25 offen offset:2048 lds
  buffer_load_dwordx4 v31, s[8:11], s25 offen offset:3072 lds
  s_add_u32 s25, s25, 40960
  s_cmp_ge_u32 s25, s82
  s_cselect_b32 s34, s83, 0
  s_sub_u32 s25, s25, s34
  s_add_u32 m0, s33, 20480
  s_nop 0
  buffer_load_dwordx4 v28, s[8:11], s25 offen offset:0 lds
  buffer_load_dwordx4 v29, s[8:11], s25 offen offset:1024 lds
  buffer_load_dwordx4 v30, s[8:11], s25 offen offset:2048 lds
  buffer_load_dwordx4 v31, s[8:11], s25 offen offset:3072 lds
  s_add_u32 s25, s25, 40960
  s_cmp_ge_u32 s25, s82
  s_cselect_b32 s34, s83, 0
  s_sub_u32 s25, s25, s34
  s_waitcnt vmcnt(12)
  ds_read_b64_tr_b16 a[192:193], v96 offset:4096
  ds_read_b64_tr_b16 a[194:195], v96 offset:6144
  ds_read_b64_tr_b16 a[196:197], v97 offset:4096
  ds_read_b64_tr_b16 a[198:199], v97 offset:6144
  ds_read_b64_tr_b16 a[200:201], v98 offset:4096
  ds_read_b64_tr_b16 a[202:203], v98 offset:6144
  ds_read_b64_tr_b16 a[204:205], v99 offset:4096
  ds_read_b64_tr_b16 a[206:207], v99 offset:6144
  ds_read_b64_tr_b16 a[208:209], v96 offset:8192
  ds_read_b64_tr_b16 a[210:211], v96 offset:10240
  ds_read_b64_tr_b16 a[212:213], v97 offset:8192
  ds_read_b64_tr_b16 a[214:215], v97 offset:10240
  ds_read_b64_tr_b16 a[216:217], v98 offset:8192
  ds_read_b64_tr_b16 a[218:219], v98 offset:10240
  ds_read_b64_tr_b16 a[220:221], v99 offset:8192
  ds_read_b64_tr_b16 a[222:223], v99 offset:10240
  s_add_u32 m0, s33, 24576
  s_nop 0
  buffer_load_dwordx4 v28, s[8:11], s25 offen offset:0 lds
  buffer_load_dwordx4 v29, s[8:11], s25 offen offset:1024 lds
  buffer_load_dwordx4 v30, s[8:11], s25 offen offset:2048 lds
  buffer_load_dwordx4 v31, s[8:11], s25 offen offset:3072 lds
  s_add_u32 m0, s33, 28672
  s_nop 0
  buffer_load_dwordx4 v28, s[76:79], s26 offen offset:0 lds
  buffer_load_dwordx4 v29, s[76:79], s26 offen offset:1024 lds
  buffer_load_dwordx4 v30, s[76:79], s29 offen offset:2048 lds
  buffer_load_dwordx4 v31, s[76:79], s29 offen offset:3072 lds
  s_add_u32 s26, s26, 51200
  s_add_u32 s29, s29, 51200
  s_add_u32 m0, s33, 32768
  s_nop 0
  buffer_load_dwordx4 v28, s[76:79], s26 offen offset:0 lds
  buffer_load_dwordx4 v29, s[76:79], s26 offen offset:1024 lds
  buffer_load_dwordx4 v30, s[76:79], s29 offen offset:2048 lds
  buffer_load_dwordx4 v31, s[76:79], s29 offen offset:3072 lds
  s_add_u32 s26, s26, 51200
  s_add_u32 s29, s29, 51200
  s_add_u32 m0, s33, 0
  s_nop 0
  buffer_load_dwordx4 v28, s[76:79], s26 offen offset:0 lds
  buffer_load_dwordx4 v29, s[76:79], s26 offen offset:1024 lds
  buffer_load_dwordx4 v30, s[76:79], s29 offen offset:2048 lds
  buffer_load_dwordx4 v31, s[76:79], s29 offen offset:3072 lds
  s_add_u32 s26, s26, 51200
  s_add_u32 s29, s29, 51200
  s_waitcnt lgkmcnt(0)
  s_add_u32 m0, s33, 4096
  s_nop 0
  buffer_load_dwordx4 v28, s[76:79], s26 offen offset:0 lds
  buffer_load_dwordx4 v29, s[76:79], s26 offen offset:1024 lds
  buffer_load_dwordx4 v30, s[76:79], s29 offen offset:2048 lds
  buffer_load_dwordx4 v31, s[76:79], s29 offen offset:3072 lds
  s_mov_b32 exec_lo, 65535
  s_mov_b32 exec_hi, 0
  buffer_load_dword v23, v104, s[12:15], 0 offen sc1
  s_mov_b64 exec, -1
  s_add_u32 m0, s33, 8192
  s_nop 0
  buffer_load_dwordx4 v100, s[76:79], s30 offen offset:0 lds
  buffer_load_dwordx4 v101, s[76:79], s30 offen offset:1024 lds
  buffer_load_dwordx4 v102, s[76:79], s30 offen offset:2048 lds
  buffer_load_dwordx4 v103, s[76:79], s30 offen offset:3072 lds
  s_waitcnt vmcnt(4) lgkmcnt(0)
  v_and_b32 v23, 1, v23
  v_cmp_ne_u32 vcc, v23, v105
  s_nop 0
  s_and_b32 vcc_lo, vcc_lo, 65535
  s_and_b32 vcc_hi, vcc_hi, 0
  s_cbranch_vccz LphFok
  s_mov_b32 exec_lo, 65535
  s_mov_b32 exec_hi, 0
  s_mov_b32 s35, 0x20000
LphF:
  buffer_load_dword v23, v104, s[12:15], 0 offen sc1
  s_sub_u32 s35, s35, 1
  s_waitcnt vmcnt(0)
  v_and_b32 v23, 1, v23
  v_cmp_ne_u32 vcc, v23, v105
  s_cmp_eq_u32 s35, 0
  s_cbranch_scc1 LphFx
  s_cbranch_vccnz LphF
LphFx:
  s_mov_b64 exec, -1
LphFok:
  buffer_load_dwordx4 a[0:3], v4, s[4:7], s24 offen sc1
  buffer_load_dwordx4 a[4:7], v5, s[4:7], s24 offen sc1
  buffer_load_dwordx4 a[8:11], v6, s[4:7], s24 offen sc1
  buffer_load_dwordx4 a[12:15], v7, s[4:7], s24 offen sc1
  buffer_load_dwordx4 a[16:19], v8, s[4:7], s24 offen sc1
  s_add_u32 s24, s24, 1024
  s_cmp_eq_u32 s24, s19
  s_cselect_b32 s24, s18, s24
  s_cselect_b32 s6, s68, s14
  buffer_load_dwordx4 a[20:23], v4, s[4:7], s24 offen sc1
  buffer_load_dwordx4 a[24:27], v5, s[4:7], s24 offen sc1
  buffer_load_dwordx4 a[28:31], v6, s[4:7], s24 offen sc1
  buffer_load_dwordx4 a[32:35], v7, s[4:7], s24 offen sc1
  buffer_load_dwordx4 a[36:39], v8, s[4:7], s24 offen sc1
  s_add_u32 s24, s24, 1024
  s_cmp_eq_u32 s24, s19
  s_cselect_b32 s24, s18, s24
  s_cselect_b32 s6, s68, s14
  buffer_load_dwordx4 a[40:43], v4, s[4:7], s24 offen sc1
  buffer_load_dwordx4 a[44:47], v5, s[4:7], s24 offen sc1
  buffer_load_dwordx4 a[48:51], v6, s[4:7], s24 offen sc1
  buffer_load_dwordx4 a[52:55], v7, s[4:7], s24 offen sc1
  buffer_load_dwordx4 a[56:59], v8, s[4:7], s24 offen sc1
  s_add_u32 s24, s24, 1024
  s_cmp_eq_u32 s24, s19
  s_cselect_b32 s24, s18, s24
  s_cselect_b32 s6, s68, s14
  buffer_load_dwordx4 a[60:63], v4, s[4:7], s24 offen sc1
  buffer_load_dwordx4 a[64:67], v5, s[4:7], s24 offen sc1
  buffer_load_dwordx4 a[68:71], v6, s[4:7], s24 offen sc1
  buffer_load_dwordx4 a[72:75], v7, s[4:7], s24 offen sc1
  buffer_load_dwordx4 a[76:79], v8, s[4:7], s24 offen sc1
  s_add_u32 s24, s24, 1024
  s_cmp_eq_u32 s24, s19
  s_cselect_b32 s24, s18, s24
  s_cselect_b32 s6, s68, s14
  s_branch LvF5
LswF:
  s_sub_u32 s4, s44, 4096
  s_subb_u32 s5, s45, 0
  s_mov_b32 s6, 2215936
  s_mov_b32 s8, s4
  s_mov_b32 s9, s5
  s_mov_b32 s10, s6
  s_add_u32 s24, s62, s71
  s_mul_i32 s24, s24, 40960
  s_add_u32 s25, s24, 40960
  s_add_u32 s80, s62, 14
  s_mul_i32 s80, s80, 40960
  s_mov_b32 s81, 573440
  s_mov_b32 s82, s80
  s_mov_b32 s83, s81
  s_cmp_ge_u32 s25, s82
  s_cselect_b32 s34, s83, 0
  s_sub_u32 s25, s25, s34
  s_mov_b32 s26, 122880
  s_mov_b32 s31, s26
  v_mov_b32 v14, v28
  v_mov_b32 v18, v28
  v_add_u32 v22, 40960, v28
  v_mov_b32 v15, v29
  v_mov_b32 v19, v29
  v_add_u32 v23, 40960, v29
  v_mov_b32 v16, v30
  v_mov_b32 v20, v30
  v_add_u32 v24, 40960, v30
  v_mov_b32 v17, v31
  v_mov_b32 v21, v31
  v_add_u32 v25, 40960, v31
  s_branch LswbF
LtcF:
  buffer_load_dword a253, v54, s[44:47], 0 offen
  buffer_load_dword a252, v55, s[40:43], 0 offen
  v_add_u32 v54, 4992, v54
  v_add_u32 v55, 1920, v55
  s_branch LtcbF
LroleN:
  s_mul_i32 s57, s65, 192
  v_add_u32 v32, s57, v44
  v_and_b32 v33, 3, v1
  v_lshl_add_u32 v32, v33, 3, v32
  v_add_u32 v6, 0, v32
  v_xor_b32 v6, v6, v45
  v_add_u32 v7, 32, v32
  v_xor_b32 v7, v7, v45
  v_add_u32 v8, 64, v32
  v_xor_b32 v8, v8, v45
  v_add_u32 v9, 96, v32
  v_xor_b32 v9, v9, v45
  v_add_u32 v10, 128, v32
  v_xor_b32 v10, v10, v45
  v_add_u32 v11, 160, v32
  v_xor_b32 v11, v11, v45
  s_add_u32 s57, s33, 36864
  s_add_u32 s57, s57, s30
  v_lshl_add_u32 v13, v2, 4, s57
  s_mul_i32 s57, s70, 4
  s_add_u32 s57, s57, s20
  s_mul_i32 s58, s57, 4992
  s_mul_i32 s59, s57, 1920
  v_lshlrev_b32 v32, 7, v1
  v_mov_b32 v33, 0x70000000
  v_add_u32 v54, s58, v32
  v_cmp_gt_u32 vcc, 39, v1
  v_add_u32 v55, s59, v32
  s_mov_b32 s42, 819200
  v_cndmask_b32 v54, v33, v54, vcc
  v_cmp_gt_u32 vcc, 15, v1
  s_mov_b32 s43, 0x20000
  s_nop 0
  v_cndmask_b32 v55, v33, v55, vcc
  s_mov_b32 s28, 9
  s_mov_b32 s29, 12288
  s_add_u32 s35, s33, 24576
  s_mov_b32 s69, s29
  s_mov_b32 s68, 4294942720
  s_waitcnt vmcnt(6)
  s_barrier
  ds_read_b128 a[0:3], v4 offset:0
  ds_read_b128 a[4:7], v4 offset:2048
  ds_read_b128 a[8:11], v4 offset:40960
  ds_read_b128 a[12:15], v4 offset:43008
  ds_read_b64_tr_b16 a[16:17], v6 offset:0
  ds_read_b64_tr_b16 a[18:19], v6 offset:2048
  ds_read_b64_tr_b16 a[20:21], v7 offset:0
  ds_read_b64_tr_b16 a[22:23], v7 offset:2048
  ds_read_b64_tr_b16 a[24:25], v8 offset:0
  ds_read_b64_tr_b16 a[26:27], v8 offset:2048
  ds_read_b64_tr_b16 a[28:29], v9 offset:0
  ds_read_b64_tr_b16 a[30:31], v9 offset:2048
  ds_read_b64_tr_b16 a[32:33], v10 offset:0
  ds_read_b64_tr_b16 a[34:35], v10 offset:2048
  ds_read_b64_tr_b16 a[36:37], v11 offset:0
  ds_read_b64_tr_b16 a[38:39], v11 offset:2048
  ds_read_b128 a[44:47], v13 offset:0
  s_cmp_lg_u32 s70, 6
  s_cbranch_scc1 Lsn2
  s_cmp_lg_u32 s20, 1
  s_cbranch_scc1 Lsn2
  v_and_b32 v48, 1, v48
  v_and_b32 v49, 1, v49
  v_and_b32 v50, 1, v50
  v_and_b32 v51, 1, v51
  v_lshl_or_b32 v48, v49, 8, v48
  v_lshl_or_b32 v50, v51, 8, v50
  v_lshl_or_b32 v48, v50, 16, v48
  v_or_b32 v48, 0x80808080, v48
  v_lshlrev_b32 v52, 2, v1
  buffer_store_dword v48, v52, s[72:75], 0 offen sc1
Lsn2:
  s_waitcnt lgkmcnt(0)
  v_mfma_f32_16x16x32_bf16 v[128:131], a[16:19], a[0:3], 0
  ds_read_b128 a[48:51], v5 offset:0
  v_mfma_f32_16x16x32_bf16 v[132:135], a[20:23], a[0:3], 0
  ds_read_b128 a[52:55], v5 offset:2048
  buffer_load_dwordx4 v20, s[8:11], s25 offen offset:2048 lds
  v_add_u32 v4, s29, v4
  v_mfma_f32_16x16x32_bf16 v[136:139], a[24:27], a[0:3], 0
  ds_read_b128 a[56:59], v5 offset:40960
  buffer_load_dwordx4 v21, s[8:11], s25 offen offset:3072 lds
  v_mfma_f32_16x16x32_bf16 v[140:143], a[28:31], a[0:3], 0
  ds_read_b128 a[60:63], v5 offset:43008
  v_mfma_f32_16x16x32_bf16 v[144:147], a[32:35], a[0:3], 0
  ds_read_b64_tr_b16 a[64:65], v6 offset:4096
  s_add_u32 m0, m0, 4096
  s_nop 0
  buffer_load_dwordx4 v22, s[8:11], s25 offen offset:0 lds
  v_add_u32 v5, s29, v5
  v_mfma_f32_16x16x32_bf16 v[148:151], a[36:39], a[0:3], 0
  ds_read_b64_tr_b16 a[66:67], v6 offset:6144
  v_mfma_f32_16x16x32_bf16 v[156:159], a[44:47], a[0:3], 0
  ds_read_b64_tr_b16 a[68:69], v7 offset:4096
  buffer_load_dwordx4 v23, s[8:11], s25 offen offset:1024 lds
  v_add_u32 v6, s29, v6
  v_mfma_f32_16x16x32_bf16 v[160:163], a[16:19], a[4:7], 0
  ds_read_b64_tr_b16 a[70:71], v7 offset:6144
  v_mfma_f32_16x16x32_bf16 v[164:167], a[20:23], a[4:7], 0
  ds_read_b64_tr_b16 a[72:73], v8 offset:4096
  buffer_load_dwordx4 v24, s[8:11], s25 offen offset:2048 lds
  v_add_u32 v7, s29, v7
  v_mfma_f32_16x16x32_bf16 v[168:171], a[24:27], a[4:7], 0
  ds_read_b64_tr_b16 a[74:75], v8 offset:6144
  v_mfma_f32_16x16x32_bf16 v[172:175], a[28:31], a[4:7], 0
  ds_read_b64_tr_b16 a[76:77], v9 offset:4096
  buffer_load_dwordx4 v25, s[8:11], s25 offen offset:3072 lds
  s_add_u32 s25, s25, s31
  s_cmp_ge_u32 s25, s82
  s_cselect_b32 s34, s83, 0
  s_sub_u32 s25, s25, s34
  v_add_u32 v8, s29, v8
  v_mfma_f32_16x16x32_bf16 v[176:179], a[32:35], a[4:7], 0
  ds_read_b64_tr_b16 a[78:79], v9 offset:6144
  v_mfma_f32_16x16x32_bf16 v[180:183], a[36:39], a[4:7], 0
  ds_read_b64_tr_b16 a[80:81], v10 offset:4096
  s_mov_b32 m0, s27
  s_nop 0
  buffer_load_dwordx4 v14, s[4:7], s24 offen offset:0 lds
  v_add_u32 v9, s29, v9
  v_mfma_f32_16x16x32_bf16 v[188:191], a[44:47], a[4:7], 0
  ds_read_b64_tr_b16 a[82:83], v10 offset:6144
  v_mfma_f32_16x16x32_bf16 v[192:195], a[16:19], a[8:11], 0
  ds_read_b64_tr_b16 a[84:85], v11 offset:4096
  buffer_load_dwordx4 v15, s[4:7], s24 offen offset:1024 lds
  v_add_u32 v10, s29, v10
  v_mfma_f32_16x16x32_bf16 v[196:199], a[20:23], a[8:11], 0
  ds_read_b64_tr_b16 a[86:87], v11 offset:6144
  v_mfma_f32_16x16x32_bf16 v[200:203], a[24:27], a[8:11], 0
  ds_read_b128 a[92:95], v13 offset:64
  buffer_load_dwordx4 v16, s[4:7], s24 offen offset:2048 lds
  v_add_u32 v11, s29, v11
  v_mfma_f32_16x16x32_bf16 v[204:207], a[28:31], a[8:11], 0
  v_add_u32 v13, 128, v13
  v_mfma_f32_16x16x32_bf16 v[208:211], a[32:35], a[8:11], 0
  buffer_load_dwordx4 v17, s[4:7], s24 offen offset:3072 lds
  v_mfma_f32_16x16x32_bf16 v[212:215], a[36:39], a[8:11], 0
  v_mfma_f32_16x16x32_bf16 v[220:223], a[44:47], a[8:11], 0
  s_add_u32 m0, m0, 4096
  s_nop 0
  buffer_load_dwordx4 v18, s[8:11], s25 offen offset:0 lds
  v_mfma_f32_16x16x32_bf16 v[224:227], a[16:19], a[12:15], 0
  v_mfma_f32_16x16x32_bf16 v[228:231], a[20:23], a[12:15], 0
  buffer_load_dwordx4 v19, s[8:11], s25 offen offset:1024 lds
  v_mfma_f32_16x16x32_bf16 v[232:235], a[24:27], a[12:15], 0
  v_mfma_f32_16x16x32_bf16 v[236:239], a[28:31], a[12:15], 0
  s_add_u32 s24, s24, s26
  s_cmp_ge_u32 s24, s80
  s_cselect_b32 s34, s81, 0
  s_sub_u32 s24, s24, s34
  s_add_u32 s27, s27, 12288
  s_cmp_eq_u32 s27, s32
  s_cselect_b32 s27, s33, s27
  v_mfma_f32_16x16x32_bf16 v[240:243], a[32:35], a[12:15], 0
  v_mfma_f32_16x16x32_bf16 v[244:247], a[36:39], a[12:15], 0
  v_mfma_f32_16x16x32_bf16 v[252:255], a[44:47], a[12:15], 0
  s_waitcnt vmcnt(6) lgkmcnt(0)
  s_barrier
  v_mfma_f32_16x16x32_bf16 v[128:131], a[64:67], a[48:51], v[128:131]
  ds_read_b128 a[0:3], v4 offset:0
  v_mfma_f32_16x16x32_bf16 v[132:135], a[68:71], a[48:51], v[132:135]
  ds_read_b128 a[4:7], v4 offset:2048
  buffer_load_dwordx4 v20, s[8:11], s25 offen offset:2048 lds
  v_mfma_f32_16x16x32_bf16 v[136:139], a[72:75], a[48:51], v[136:139]
  ds_read_b128 a[8:11], v4 offset:40960
  buffer_load_dwordx4 v21, s[8:11], s25 offen offset:3072 lds
  v_mfma_f32_16x16x32_bf16 v[140:143], a[76:79], a[48:51], v[140:143]
  ds_read_b128 a[12:15], v4 offset:43008
  v_mfma_f32_16x16x32_bf16 v[144:147], a[80:83], a[48:51], v[144:147]
  ds_read_b64_tr_b16 a[16:17], v6 offset:0
  s_add_u32 m0, m0, 4096
  s_nop 0
  buffer_load_dwordx4 v22, s[8:11], s25 offen offset:0 lds
  v_mfma_f32_16x16x32_bf16 v[148:151], a[84:87], a[48:51], v[148:151]
  ds_read_b64_tr_b16 a[18:19], v6 offset:2048
  v_mfma_f32_16x16x32_bf16 v[156:159], a[92:95], a[48:51], v[156:159]
  ds_read_b64_tr_b16 a[20:21], v7 offset:0
  buffer_load_dwordx4 v23, s[8:11], s25 offen offset:1024 lds
  v_mfma_f32_16x16x32_bf16 v[160:163], a[64:67], a[52:55], v[160:163]
  ds_read_b64_tr_b16 a[22:23], v7 offset:2048
  v_mfma_f32_16x16x32_bf16 v[164:167], a[68:71], a[52:55], v[164:167]
  ds_read_b64_tr_b16 a[24:25], v8 offset:0
  buffer_load_dwordx4 v24, s[8:11], s25 offen offset:2048 lds
  v_mfma_f32_16x16x32_bf16 v[168:171], a[72:75], a[52:55], v[168:171]
  ds_read_b64_tr_b16 a[26:27], v8 offset:2048
  buffer_load_dwordx4 v25, s[8:11], s25 offen offset:3072 lds
  s_add_u32 s25, s25, s31
  s_cmp_ge_u32 s25, s82
  s_cselect_b32 s34, s83, 0
  s_sub_u32 s25, s25, s34
  v_mfma_f32_16x16x32_bf16 v[172:175], a[76:79], a[52:55], v[172:175]
  ds_read_b64_tr_b16 a[28:29], v9 offset:0
  v_mfma_f32_16x16x32_bf16 v[176:179], a[80:83], a[52:55], v[176:179]
  ds_read_b64_tr_b16 a[30:31], v9 offset:2048
  s_mov_b32 m0, s27
  s_nop 0
  buffer_load_dwordx4 v14, s[4:7], s24 offen offset:0 lds
  v_mfma_f32_16x16x32_bf16 v[180:183], a[84:87], a[52:55], v[180:183]
  ds_read_b64_tr_b16 a[32:33], v10 offset:0
  v_mfma_f32_16x16x32_bf16 v[188:191], a[92:95], a[52:55], v[188:191]
  ds_read_b64_tr_b16 a[34:35], v10 offset:2048
  buffer_load_dwordx4 v15, s[4:7], s24 offen offset:1024 lds
  v_mfma_f32_16x16x32_bf16 v[192:195], a[64:67], a[56:59], v[192:195]
  ds_read_b64_tr_b16 a[36:37], v11 offset:0
  v_mfma_f32_16x16x32_bf16 v[196:199], a[68:71], a[56:59], v[196:199]
  ds_read_b64_tr_b16 a[38:39], v11 offset:2048
  buffer_load_dwordx4 v16, s[4:7], s24 offen offset:2048 lds
  v_mfma_f32_16x16x32_bf16 v[200:203], a[72:75], a[56:59], v[200:203]
  ds_read_b128 a[44:47], v13 offset:0
  v_mfma_f32_16x16x32_bf16 v[204:207], a[76:79], a[56:59], v[204:207]
  buffer_load_dwordx4 v17, s[4:7], s24 offen offset:3072 lds
  v_mfma_f32_16x16x32_bf16 v[208:211], a[80:83], a[56:59], v[208:211]
  s_add_u32 m0, m0, 4096
  s_nop 0
  buffer_load_dwordx4 v18, s[8:11], s25 offen offset:0 lds
  v_mfma_f32_16x16x32_bf16 v[212:215], a[84:87], a[56:59], v[212:215]
  v_mfma_f32_16x16x32_bf16 v[220:223], a[92:95], a[56:59], v[220:223]
  buffer_load_dwordx4 v19, s[8:11], s25 offen offset:1024 lds
  v_mfma_f32_16x16x32_bf16 v[224:227], a[64:67], a[60:63], v[224:227]
  v_mfma_f32_16x16x32_bf16 v[228:231], a[68:71], a[60:63], v[228:231]
  v_lshrrev_b32 v41, 5, v0
  v_lshl_add_u32 v41, s2, 3, v41
  v_mul_u32_u24 v41, 768, v41
  v_and_b32 v40, 31, v0
  v_lshl_add_u32 v40, v40, 7, v41
  v_add_u32 v40, 1048576, v40
  v_min_u32 v41, 2211712, v40
  v_min_u32 v40, 2457472, v40
  s_mov_b32 exec_lo, 63
  s_mov_b32 exec_hi, 63
  global_load_dword a247, v42, s[36:37] offset:512
  global_load_dword a246, v40, s[38:39]
  global_load_dword a245, v41, s[18:19]
  s_mov_b64 exec, -1
  v_mfma_f32_16x16x32_bf16 v[232:235], a[72:75], a[60:63], v[232:235]
  v_mfma_f32_16x16x32_bf16 v[236:239], a[76:79], a[60:63], v[236:239]
  s_add_u32 s24, s24, s26
  s_cmp_ge_u32 s24, s80
  s_cselect_b32 s34, s81, 0
  s_sub_u32 s24, s24, s34
  s_add_u32 s27, s27, 12288
  s_cmp_eq_u32 s27, s32
  s_cselect_b32 s27, s33, s27
  s_cmp_eq_u32 s27, s35
  s_cselect_b32 s29, s68, s69
  v_mfma_f32_16x16x32_bf16 v[240:243], a[80:83], a[60:63], v[240:243]
  v_mfma_f32_16x16x32_bf16 v[244:247], a[84:87], a[60:63], v[244:247]
  v_mfma_f32_16x16x32_bf16 v[252:255], a[92:95], a[60:63], v[252:255]
  s_waitcnt lgkmcnt(0)
Lp1loopN:
  v_mfma_f32_16x16x32_bf16 v[128:131], a[16:19], a[0:3], v[128:131]
  ds_read_b128 a[48:51], v5 offset:0
  v_add_u32 v4, s29, v4
  v_mfma_f32_16x16x32_bf16 v[132:135], a[20:23], a[0:3], v[132:135]
  ds_read_b128 a[52:55], v5 offset:2048
  v_mfma_f32_16x16x32_bf16 v[136:139], a[24:27], a[0:3], v[136:139]
  buffer_load_dwordx4 v20, s[8:11], s25 offen offset:2048 lds
  v_mfma_f32_16x16x32_bf16 v[140:143], a[28:31], a[0:3], v[140:143]
  ds_read_b128 a[56:59], v5 offset:40960
  v_mfma_f32_16x16x32_bf16 v[144:147], a[32:35], a[0:3], v[144:147]
  ds_read_b128 a[60:63], v5 offset:43008
  v_mfma_f32_16x16x32_bf16 v[148:151], a[36:39], a[0:3], v[148:151]
  ds_read_b64_tr_b16 a[64:65], v6 offset:4096
  v_add_u32 v5, s29, v5
  v_mfma_f32_16x16x32_bf16 v[156:159], a[44:47], a[0:3], v[156:159]
  buffer_load_dwordx4 v21, s[8:11], s25 offen offset:3072 lds
  v_mfma_f32_16x16x32_bf16 v[160:163], a[16:19], a[4:7], v[160:163]
  ds_read_b64_tr_b16 a[66:67], v6 offset:6144
  v_mfma_f32_16x16x32_bf16 v[164:167], a[20:23], a[4:7], v[164:167]
  ds_read_b64_tr_b16 a[68:69], v7 offset:4096
  v_add_u32 v6, s29, v6
  v_mfma_f32_16x16x32_bf16 v[168:171], a[24:27], a[4:7], v[168:171]
  s_add_u32 m0, m0, 4096
  ds_read_b64_tr_b16 a[70:71], v7 offset:6144
  v_mfma_f32_16x16x32_bf16 v[172:175], a[28:31], a[4:7], v[172:175]
  buffer_load_dwordx4 v22, s[8:11], s25 offen offset:0 lds
  v_mfma_f32_16x16x32_bf16 v[176:179], a[32:35], a[4:7], v[176:179]
  ds_read_b64_tr_b16 a[72:73], v8 offset:4096
  v_add_u32 v7, s29, v7
  v_mfma_f32_16x16x32_bf16 v[180:183], a[36:39], a[4:7], v[180:183]
  ds_read_b64_tr_b16 a[74:75], v8 offset:6144
  v_mfma_f32_16x16x32_bf16 v[188:191], a[44:47], a[4:7], v[188:191]
  ds_read_b64_tr_b16 a[76:77], v9 offset:4096
  v_add_u32 v8, s29, v8
  v_mfma_f32_16x16x32_bf16 v[192:195], a[16:19], a[8:11], v[192:195]
  buffer_load_dwordx4 v23, s[8:11], s25 offen offset:1024 lds
  v_mfma_f32_16x16x32_bf16 v[196:199], a[20:23], a[8:11], v[196:199]
  ds_read_b64_tr_b16 a[78:79], v9 offset:6144
  v_mfma_f32_16x16x32_bf16 v[200:203], a[24:27], a[8:11], v[200:203]
  ds_read_b64_tr_b16 a[80:81], v10 offset:4096
  v_add_u32 v9, s29, v9
  v_mfma_f32_16x16x32_bf16 v[204:207], a[28:31], a[8:11], v[204:207]
  ds_read_b64_tr_b16 a[82:83], v10 offset:6144
  v_mfma_f32_16x16x32_bf16 v[208:211], a[32:35], a[8:11], v[208:211]
  buffer_load_dwordx4 v24, s[8:11], s25 offen offset:2048 lds
  v_mfma_f32_16x16x32_bf16 v[212:215], a[36:39], a[8:11], v[212:215]
  ds_read_b64_tr_b16 a[84:85], v11 offset:4096
  v_add_u32 v10, s29, v10
  v_mfma_f32_16x16x32_bf16 v[220:223], a[44:47], a[8:11], v[220:223]
  ds_read_b64_tr_b16 a[86:87], v11 offset:6144
  v_mfma_f32_16x16x32_bf16 v[224:227], a[16:19], a[12:15], v[224:227]
  ds_read_b128 a[92:95], v13 offset:64
  v_add_u32 v11, s29, v11
  v_mfma_f32_16x16x32_bf16 v[228:231], a[20:23], a[12:15], v[228:231]
  buffer_load_dwordx4 v25, s[8:11], s25 offen offset:3072 lds
  v_mfma_f32_16x16x32_bf16 v[232:235], a[24:27], a[12:15], v[232:235]
  v_add_u32 v13, 128, v13
  s_add_u32 s25, s25, s31
  v_mfma_f32_16x16x32_bf16 v[236:239], a[28:31], a[12:15], v[236:239]
  s_cmp_ge_u32 s25, s82
  s_cselect_b32 s34, s83, 0
  v_mfma_f32_16x16x32_bf16 v[240:243], a[32:35], a[12:15], v[240:243]
  s_sub_u32 s25, s25, s34
  s_cmp_eq_u32 s28, 3
  v_mfma_f32_16x16x32_bf16 v[244:247], a[36:39], a[12:15], v[244:247]
  s_cbranch_scc1 LswN
LswbN:
  v_mfma_f32_16x16x32_bf16 v[252:255], a[44:47], a[12:15], v[252:255]
  s_waitcnt vmcnt(12) lgkmcnt(0)
  s_barrier
  s_sub_u32 s34, 4, s28
  s_cmp_lt_u32 s34, 1
  s_cbranch_scc1 LtcN
LtcbN:
  v_mfma_f32_16x16x32_bf16 v[128:131], a[64:67], a[48:51], v[128:131]
  ds_read_b128 a[0:3], v4 offset:0
  v_mfma_f32_16x16x32_bf16 v[132:135], a[68:71], a[48:51], v[132:135]
  s_mov_b32 m0, s27
  ds_read_b128 a[4:7], v4 offset:2048
  v_mfma_f32_16x16x32_bf16 v[136:139], a[72:75], a[48:51], v[136:139]
  buffer_load_dwordx4 v14, s[4:7], s24 offen offset:0 lds
  v_mfma_f32_16x16x32_bf16 v[140:143], a[76:79], a[48:51], v[140:143]
  ds_read_b128 a[8:11], v4 offset:40960
  v_mfma_f32_16x16x32_bf16 v[144:147], a[80:83], a[48:51], v[144:147]
  ds_read_b128 a[12:15], v4 offset:43008
  v_mfma_f32_16x16x32_bf16 v[148:151], a[84:87], a[48:51], v[148:151]
  ds_read_b64_tr_b16 a[16:17], v6 offset:0
  v_mfma_f32_16x16x32_bf16 v[156:159], a[92:95], a[48:51], v[156:159]
  buffer_load_dwordx4 v15, s[4:7], s24 offen offset:1024 lds
  v_mfma_f32_16x16x32_bf16 v[160:163], a[64:67], a[52:55], v[160:163]
  ds_read_b64_tr_b16 a[18:19], v6 offset:2048
  v_mfma_f32_16x16x32_bf16 v[164:167], a[68:71], a[52:55], v[164:167]
  ds_read_b64_tr_b16 a[20:21], v7 offset:0
  v_mfma_f32_16x16x32_bf16 v[168:171], a[72:75], a[52:55], v[168:171]
  ds_read_b64_tr_b16 a[22:23], v7 offset:2048
  v_mfma_f32_16x16x32_bf16 v[172:175], a[76:79], a[52:55], v[172:175]
  buffer_load_dwordx4 v16, s[4:7], s24 offen offset:2048 lds
  v_mfma_f32_16x16x32_bf16 v[176:179], a[80:83], a[52:55], v[176:179]
  ds_read_b64_tr_b16 a[24:25], v8 offset:0
  v_mfma_f32_16x16x32_bf16 v[180:183], a[84:87], a[52:55], v[180:183]
  ds_read_b64_tr_b16 a[26:27], v8 offset:2048
  v_mfma_f32_16x16x32_bf16 v[188:191], a[92:95], a[52:55], v[188:191]
  ds_read_b64_tr_b16 a[28:29], v9 offset:0
  v_mfma_f32_16x16x32_bf16 v[192:195], a[64:67], a[56:59], v[192:195]
  buffer_load_dwordx4 v17, s[4:7], s24 offen offset:3072 lds
  v_mfma_f32_16x16x32_bf16 v[196:199], a[68:71], a[56:59], v[196:199]
  ds_read_b64_tr_b16 a[30:31], v9 offset:2048
  v_mfma_f32_16x16x32_bf16 v[200:203], a[72:75], a[56:59], v[200:203]
  ds_read_b64_tr_b16 a[32:33], v10 offset:0
  v_mfma_f32_16x16x32_bf16 v[204:207], a[76:79], a[56:59], v[204:207]
  s_add_u32 m0, m0, 4096
  ds_read_b64_tr_b16 a[34:35], v10 offset:2048
  v_mfma_f32_16x16x32_bf16 v[208:211], a[80:83], a[56:59], v[208:211]
  buffer_load_dwordx4 v18, s[8:11], s25 offen offset:0 lds
  v_mfma_f32_16x16x32_bf16 v[212:215], a[84:87], a[56:59], v[212:215]
  ds_read_b64_tr_b16 a[36:37], v11 offset:0
  s_add_u32 s24, s24, s26
  v_mfma_f32_16x16x32_bf16 v[220:223], a[92:95], a[56:59], v[220:223]
  ds_read_b64_tr_b16 a[38:39], v11 offset:2048
  s_cmp_ge_u32 s24, s80
  v_mfma_f32_16x16x32_bf16 v[224:227], a[64:67], a[60:63], v[224:227]
  ds_read_b128 a[44:47], v13 offset:0
  s_cselect_b32 s34, s81, 0
  v_mfma_f32_16x16x32_bf16 v[228:231], a[68:71], a[60:63], v[228:231]
  buffer_load_dwordx4 v19, s[8:11], s25 offen offset:1024 lds
  v_mfma_f32_16x16x32_bf16 v[232:235], a[72:75], a[60:63], v[232:235]
  s_sub_u32 s24, s24, s34
  s_add_u32 s27, s27, 12288
  v_mfma_f32_16x16x32_bf16 v[236:239], a[76:79], a[60:63], v[236:239]
  s_cmp_eq_u32 s27, s32
  s_cselect_b32 s27, s33, s27
  v_mfma_f32_16x16x32_bf16 v[240:243], a[80:83], a[60:63], v[240:243]
  s_cmp_eq_u32 s27, s35
  s_cselect_b32 s29, s68, s69
  v_mfma_f32_16x16x32_bf16 v[244:247], a[84:87], a[60:63], v[244:247]
  s_sub_u32 s28, s28, 1
  s_cmp_lg_u32 s28, 0
  v_mfma_f32_16x16x32_bf16 v[252:255], a[92:95], a[60:63], v[252:255]
  s_waitcnt lgkmcnt(0)
  s_cbranch_scc1 Lp1loopN
  s_lshl_b32 s57, s22, 3
  s_add_u32 s57, s57, s64
  s_lshl_b32 s59, s57, 6
  s_mul_i32 s57, s57, 75776
  s_lshl_b32 s58, s23, 13
  s_add_u32 s57, s57, s58
  s_mul_i32 s58, s65, 3072
  s_add_u32 s57, s57, s58
  v_lshlrev_b32 v4, 4, v1
  buffer_load_ubyte v105, v105, s[72:75], 0 offen sc1
  global_load_dword a254, v26, s[16:17]
  v_cvt_pk_bf16_f32 v32, v128, v129
  v_cvt_pk_bf16_f32 v33, v130, v131
  v_cvt_pk_bf16_f32 v34, v132, v133
  v_cvt_pk_bf16_f32 v35, v134, v135
  v_pk_max_i16 v32, v32, 0
  v_pk_max_i16 v33, v33, 0
  v_pk_max_i16 v34, v34, 0
  v_pk_max_i16 v35, v35, 0
  buffer_store_dwordx4 v[32:35], v4, s[12:15], s57 offen offset:0 sc1
  v_cvt_pk_bf16_f32 v36, v136, v137
  v_cvt_pk_bf16_f32 v37, v138, v139
  v_cvt_pk_bf16_f32 v38, v140, v141
  v_cvt_pk_bf16_f32 v39, v142, v143
  v_pk_max_i16 v36, v36, 0
  v_pk_max_i16 v37, v37, 0
  v_pk_max_i16 v38, v38, 0
  v_pk_max_i16 v39, v39, 0
  buffer_store_dwordx4 v[36:39], v4, s[12:15], s57 offen offset:1024 sc1
  v_cvt_pk_bf16_f32 v40, v144, v145
  v_cvt_pk_bf16_f32 v41, v146, v147
  v_cvt_pk_bf16_f32 v42, v148, v149
  v_cvt_pk_bf16_f32 v43, v150, v151
  v_pk_max_i16 v40, v40, 0
  v_pk_max_i16 v41, v41, 0
  v_pk_max_i16 v42, v42, 0
  v_pk_max_i16 v43, v43, 0
  buffer_store_dwordx4 v[40:43], v4, s[12:15], s57 offen offset:2048 sc1
  s_add_u32 s57, s57, 151552
  v_cvt_pk_bf16_f32 v44, v160, v161
  v_cvt_pk_bf16_f32 v45, v162, v163
  v_cvt_pk_bf16_f32 v46, v164, v165
  v_cvt_pk_bf16_f32 v47, v166, v167
  v_pk_max_i16 v44, v44, 0
  v_pk_max_i16 v45, v45, 0
  v_pk_max_i16 v46, v46, 0
  v_pk_max_i16 v47, v47, 0
  buffer_store_dwordx4 v[44:47], v4, s[12:15], s57 offen offset:0 sc1
  v_cvt_pk_bf16_f32 v32, v168, v169
  v_cvt_pk_bf16_f32 v33, v170, v171
  v_cvt_pk_bf16_f32 v34, v172, v173
  v_cvt_pk_bf16_f32 v35, v174, v175
  v_pk_max_i16 v32, v32, 0
  v_pk_max_i16 v33, v33, 0
  v_pk_max_i16 v34, v34, 0
  v_pk_max_i16 v35, v35, 0
  buffer_store_dwordx4 v[32:35], v4, s[12:15], s57 offen offset:1024 sc1
  v_cvt_pk_bf16_f32 v36, v176, v177
  v_cvt_pk_bf16_f32 v37, v178, v179
  v_cvt_pk_bf16_f32 v38, v180, v181
  v_cvt_pk_bf16_f32 v39, v182, v183
  v_pk_max_i16 v36, v36, 0
  v_pk_max_i16 v37, v37, 0
  v_pk_max_i16 v38, v38, 0
  v_pk_max_i16 v39, v39, 0
  buffer_store_dwordx4 v[36:39], v4, s[12:15], s57 offen offset:2048 sc1
  s_add_u32 s57, s57, 151552
  v_cvt_pk_bf16_f32 v40, v192, v193
  v_cvt_pk_bf16_f32 v41, v194, v195
  v_cvt_pk_bf16_f32 v42, v196, v197
  v_cvt_pk_bf16_f32 v43, v198, v199
  v_pk_max_i16 v40, v40, 0
  v_pk_max_i16 v41, v41, 0
  v_pk_max_i16 v42, v42, 0
  v_pk_max_i16 v43, v43, 0
  buffer_store_dwordx4 v[40:43], v4, s[12:15], s57 offen offset:0 sc1
  v_cvt_pk_bf16_f32 v44, v200, v201
  v_cvt_pk_bf16_f32 v45, v202, v203
  v_cvt_pk_bf16_f32 v46, v204, v205
  v_cvt_pk_bf16_f32 v47, v206, v207
  v_pk_max_i16 v44, v44, 0
  v_pk_max_i16 v45, v45, 0
  v_pk_max_i16 v46, v46, 0
  v_pk_max_i16 v47, v47, 0
  buffer_store_dwordx4 v[44:47], v4, s[12:15], s57 offen offset:1024 sc1
  v_cvt_pk_bf16_f32 v32, v208, v209
  v_cvt_pk_bf16_f32 v33, v210, v211
  v_cvt_pk_bf16_f32 v34, v212, v213
  v_cvt_pk_bf16_f32 v35, v214, v215
  v_pk_max_i16 v32, v32, 0
  v_pk_max_i16 v33, v33, 0
  v_pk_max_i16 v34, v34, 0
  v_pk_max_i16 v35, v35, 0
  buffer_store_dwordx4 v[32:35], v4, s[12:15], s57 offen offset:2048 sc1
  s_add_u32 s57, s57, 151552
  v_cvt_pk_bf16_f32 v36, v224, v225
  v_cvt_pk_bf16_f32 v37, v226, v227
  v_cvt_pk_bf16_f32 v38, v228, v229
  v_cvt_pk_bf16_f32 v39, v230, v231
  v_pk_max_i16 v36, v36, 0
  v_pk_max_i16 v37, v37, 0
  v_pk_max_i16 v38, v38, 0
  v_pk_max_i16 v39, v39, 0
  buffer_store_dwordx4 v[36:39], v4, s[12:15], s57 offen offset:0 sc1
  v_cvt_pk_bf16_f32 v40, v232, v233
  v_cvt_pk_bf16_f32 v41, v234, v235
  v_cvt_pk_bf16_f32 v42, v236, v237
  v_cvt_pk_bf16_f32 v43, v238, v239
  v_pk_max_i16 v40, v40, 0
  v_pk_max_i16 v41, v41, 0
  v_pk_max_i16 v42, v42, 0
  v_pk_max_i16 v43, v43, 0
  buffer_store_dwordx4 v[40:43], v4, s[12:15], s57 offen offset:1024 sc1
  v_cvt_pk_bf16_f32 v44, v240, v241
  v_cvt_pk_bf16_f32 v45, v242, v243
  v_cvt_pk_bf16_f32 v46, v244, v245
  v_cvt_pk_bf16_f32 v47, v246, v247
  v_pk_max_i16 v44, v44, 0
  v_pk_max_i16 v45, v45, 0
  v_pk_max_i16 v46, v46, 0
  v_pk_max_i16 v47, v47, 0
  buffer_store_dwordx4 v[44:47], v4, s[12:15], s57 offen offset:2048 sc1
  s_add_u32 s59, s59, 10485760
  v_lshlrev_b32 v4, 2, v1
  s_cmp_eq_u32 s65, 0
  s_cselect_b32 s58, 16, 0
  v_cmp_gt_u32 vcc, s58, v1
  v_mov_b32 v5, 2147483632
  s_nop 0
  v_cndmask_b32 v4, v5, v4, vcc
  v_mul_f32 v156, 0xbfb8aa3b, v156
  v_exp_f32 v156, v156
  s_nop 0
  v_add_f32 v156, 1.0, v156
  v_rcp_f32 v156, v156
  buffer_store_dword v156, v4, s[12:15], s59 offen offset:0 sc1
  v_mul_f32 v188, 0xbfb8aa3b, v188
  v_exp_f32 v188, v188
  s_nop 0
  v_add_f32 v188, 1.0, v188
  v_rcp_f32 v188, v188
  buffer_store_dword v188, v4, s[12:15], s59 offen offset:128 sc1
  v_mul_f32 v220, 0xbfb8aa3b, v220
  v_exp_f32 v220, v220
  s_nop 0
  v_add_f32 v220, 1.0, v220
  v_rcp_f32 v220, v220
  buffer_store_dword v220, v4, s[12:15], s59 offen offset:256 sc1
  v_mul_f32 v252, 0xbfb8aa3b, v252
  v_exp_f32 v252, v252
  s_nop 0
  v_add_f32 v252, 1.0, v252
  v_rcp_f32 v252, v252
  buffer_store_dword v252, v4, s[12:15], s59 offen offset:384 sc1
  s_waitcnt vmcnt(12)
  ds_read_b64_tr_b16 a[80:81], v96 offset:12288
  ds_read_b64_tr_b16 a[82:83], v96 offset:14336
  ds_read_b64_tr_b16 a[84:85], v97 offset:12288
  ds_read_b64_tr_b16 a[86:87], v97 offset:14336
  ds_read_b64_tr_b16 a[88:89], v98 offset:12288
  ds_read_b64_tr_b16 a[90:91], v98 offset:14336
  ds_read_b64_tr_b16 a[92:93], v99 offset:12288
  ds_read_b64_tr_b16 a[94:95], v99 offset:14336
  ds_read_b64_tr_b16 a[96:97], v96 offset:16384
  ds_read_b64_tr_b16 a[98:99], v96 offset:18432
  ds_read_b64_tr_b16 a[100:101], v97 offset:16384
  ds_read_b64_tr_b16 a[102:103], v97 offset:18432
  ds_read_b64_tr_b16 a[104:105], v98 offset:16384
  ds_read_b64_tr_b16 a[106:107], v98 offset:18432
  ds_read_b64_tr_b16 a[108:109], v99 offset:16384
  ds_read_b64_tr_b16 a[110:111], v99 offset:18432
  ds_read_b64_tr_b16 a[112:113], v96 offset:20480
  ds_read_b64_tr_b16 a[114:115], v96 offset:22528
  ds_read_b64_tr_b16 a[116:117], v97 offset:20480
  ds_read_b64_tr_b16 a[118:119], v97 offset:22528
  ds_read_b64_tr_b16 a[120:121], v98 offset:20480
  ds_read_b64_tr_b16 a[122:123], v98 offset:22528
  ds_read_b64_tr_b16 a[124:125], v99 offset:20480
  ds_read_b64_tr_b16 a[126:127], v99 offset:22528
  ds_read_b64_tr_b16 a[128:129], v96 offset:24576
  ds_read_b64_tr_b16 a[130:131], v96 offset:26624
  ds_read_b64_tr_b16 a[132:133], v97 offset:24576
  ds_read_b64_tr_b16 a[134:135], v97 offset:26624
  ds_read_b64_tr_b16 a[136:137], v98 offset:24576
  ds_read_b64_tr_b16 a[138:139], v98 offset:26624
  ds_read_b64_tr_b16 a[140:141], v99 offset:24576
  ds_read_b64_tr_b16 a[142:143], v99 offset:26624
  ds_read_b64_tr_b16 a[144:145], v96 offset:28672
  ds_read_b64_tr_b16 a[146:147], v96 offset:30720
  ds_read_b64_tr_b16 a[148:149], v97 offset:28672
  ds_read_b64_tr_b16 a[150:151], v97 offset:30720
  ds_read_b64_tr_b16 a[152:153], v98 offset:28672
  ds_read_b64_tr_b16 a[154:155], v98 offset:30720
  ds_read_b64_tr_b16 a[156:157], v99 offset:28672
  ds_read_b64_tr_b16 a[158:159], v99 offset:30720
  ds_read_b64_tr_b16 a[160:161], v96 offset:32768
  ds_read_b64_tr_b16 a[162:163], v96 offset:34816
  ds_read_b64_tr_b16 a[164:165], v97 offset:32768
  ds_read_b64_tr_b16 a[166:167], v97 offset:34816
  ds_read_b64_tr_b16 a[168:169], v98 offset:32768
  ds_read_b64_tr_b16 a[170:171], v98 offset:34816
  ds_read_b64_tr_b16 a[172:173], v99 offset:32768
  ds_read_b64_tr_b16 a[174:175], v99 offset:34816
  ds_read_b64_tr_b16 a[176:177], v96 offset:0
  ds_read_b64_tr_b16 a[178:179], v96 offset:2048
  ds_read_b64_tr_b16 a[180:181], v97 offset:0
  ds_read_b64_tr_b16 a[182:183], v97 offset:2048
  ds_read_b64_tr_b16 a[184:185], v98 offset:0
  ds_read_b64_tr_b16 a[186:187], v98 offset:2048
  ds_read_b64_tr_b16 a[188:189], v99 offset:0
  ds_read_b64_tr_b16 a[190:191], v99 offset:2048
  s_waitcnt vmcnt(0)
  s_mov_b32 s35, 0x20000
LsnNw:
  v_and_b32 v27, 0x80, v105
  v_cmp_eq_u32 vcc, 0, v27
  s_sub_u32 s35, s35, 1
  s_cmp_eq_u32 s35, 0
  s_cbranch_scc1 LsnNx
  s_cbranch_vccz LsnNx
  v_subrev_u32 v27, 11534336, v104
  v_lshrrev_b32 v27, 7, v27
  buffer_load_ubyte v105, v27, s[72:75], 0 offen sc1
  s_waitcnt vmcnt(0)
  s_branch LsnNw
LsnNx:
  v_and_b32 v105, 1, v105
  v_xor_b32 v105, 1, v105
  s_barrier
  s_cmp_lg_u32 s20, 0
  s_cbranch_scc1 LsigN
  s_mov_b32 exec_lo, 0
  s_mov_b32 exec_hi, 0x10000
  buffer_store_dword v105, v104, s[12:15], 0 offen sc1
  s_mov_b64 exec, -1
LsigN:
  buffer_load_dwordx4 v20, s[8:11], s25 offen offset:2048 lds
  buffer_load_dwordx4 v21, s[8:11], s25 offen offset:3072 lds
  s_add_u32 m0, m0, 4096
  s_nop 0
  buffer_load_dwordx4 v22, s[8:11], s25 offen offset:0 lds
  buffer_load_dwordx4 v23, s[8:11], s25 offen offset:1024 lds
  buffer_load_dwordx4 v24, s[8:11], s25 offen offset:2048 lds
  buffer_load_dwordx4 v25, s[8:11], s25 offen offset:3072 lds
  s_add_u32 m0, s33, 36864
  s_nop 0
  buffer_load_dwordx4 v14, s[4:7], s24 offen offset:0 lds
  buffer_load_dwordx4 v15, s[4:7], s24 offen offset:1024 lds
  buffer_load_dwordx4 v16, s[4:7], s24 offen offset:2048 lds
  buffer_load_dwordx4 v17, s[4:7], s24 offen offset:3072 lds
  s_sub_u32 s76, s40, 4096
  s_subb_u32 s77, s41, 0
  s_mov_b32 s78, 823296
  s_mov_b32 s79, 0x20000
  s_add_u32 s25, s24, 40960
  s_cmp_ge_u32 s25, s82
  s_cselect_b32 s34, s83, 0
  s_sub_u32 s25, s25, s34
  s_mul_i32 s26, s20, 204800
  s_mov_b32 s30, s26
  s_add_u32 s29, s26, 5120
  s_and_b32 s21, s56, 127
  s_bfe_u32 s22, s56, 0x30007
  s_bfe_u32 s23, s56, 0x4000a
  v_lshlrev_b32 v10, 4, v1
  s_mul_i32 s63, s21, 75776
  v_add_u32 v4, s63, v10
  s_add_u32 s63, s63, 75776
  v_add_u32 v5, s63, v10
  s_add_u32 s63, s63, 75776
  v_add_u32 v6, s63, v10
  s_add_u32 s63, s63, 75776
  v_add_u32 v7, s63, v10
  s_add_u32 s63, s63, 75776
  v_add_u32 v8, s63, v10
  s_add_u32 s63, s63, 75776
  v_add_u32 v9, s63, v10
  s_lshl_b32 s18, s62, 10
  s_add_u32 s19, s18, 14336
  s_lshl_b32 s24, s71, 10
  s_add_u32 s24, s24, s18
  s_lshl_b32 s27, s20, 12
  s_add_u32 s27, s27, 55296
  s_lshl_b32 s28, s20, 10
  s_add_u32 s28, s28, 71680
  s_mov_b32 s4, s12
  s_mov_b32 s5, s13
  s_cmp_ge_u32 s20, 2
  s_cselect_b32 s68, 0, s14
  s_cmp_eq_u32 s71, 0
  s_cselect_b32 s6, s68, s14
  s_waitcnt lgkmcnt(0)
  s_add_u32 m0, s33, 12288
  s_nop 0
  buffer_load_dwordx4 v28, s[8:11], s25 offen offset:0 lds
  buffer_load_dwordx4 v29, s[8:11], s25 offen offset:1024 lds
  buffer_load_dwordx4 v30, s[8:11], s25 offen offset:2048 lds
  buffer_load_dwordx4 v31, s[8:11], s25 offen offset:3072 lds
  s_add_u32 s25, s25, 40960
  s_cmp_ge_u32 s25, s82
  s_cselect_b32 s34, s83, 0
  s_sub_u32 s25, s25, s34
  s_add_u32 m0, s33, 16384
  s_nop 0
  buffer_load_dwordx4 v28, s[8:11], s25 offen offset:0 lds
  buffer_load_dwordx4 v29, s[8:11], s25 offen offset:1024 lds
  buffer_load_dwordx4 v30, s[8:11], s25 offen offset:2048 lds
  buffer_load_dwordx4 v31, s[8:11], s25 offen offset:3072 lds
  s_add_u32 s25, s25, 40960
  s_cmp_ge_u32 s25, s82
  s_cselect_b32 s34, s83, 0
  s_sub_u32 s25, s25, s34
  s_add_u32 m0, s33, 20480
  s_nop 0
  buffer_load_dwordx4 v28, s[8:11], s25 offen offset:0 lds
  buffer_load_dwordx4 v29, s[8:11], s25 offen offset:1024 lds
  buffer_load_dwordx4 v30, s[8:11], s25 offen offset:2048 lds
  buffer_load_dwordx4 v31, s[8:11], s25 offen offset:3072 lds
  s_add_u32 s25, s25, 40960
  s_cmp_ge_u32 s25, s82
  s_cselect_b32 s34, s83, 0
  s_sub_u32 s25, s25, s34
  s_waitcnt vmcnt(12)
  ds_read_b64_tr_b16 a[192:193], v96 offset:4096
  ds_read_b64_tr_b16 a[194:195], v96 offset:6144
  ds_read_b64_tr_b16 a[196:197], v97 offset:4096
  ds_read_b64_tr_b16 a[198:199], v97 offset:6144
  ds_read_b64_tr_b16 a[200:201], v98 offset:4096
  ds_read_b64_tr_b16 a[202:203], v98 offset:6144
  ds_read_b64_tr_b16 a[204:205], v99 offset:4096
  ds_read_b64_tr_b16 a[206:207], v99 offset:6144
  ds_read_b64_tr_b16 a[208:209], v96 offset:8192
  ds_read_b64_tr_b16 a[210:211], v96 offset:10240
  ds_read_b64_tr_b16 a[212:213], v97 offset:8192
  ds_read_b64_tr_b16 a[214:215], v97 offset:10240
  ds_read_b64_tr_b16 a[216:217], v98 offset:8192
  ds_read_b64_tr_b16 a[218:219], v98 offset:10240
  ds_read_b64_tr_b16 a[220:221], v99 offset:8192
  ds_read_b64_tr_b16 a[222:223], v99 offset:10240
  s_add_u32 m0, s33, 24576
  s_nop 0
  buffer_load_dwordx4 v28, s[8:11], s25 offen offset:0 lds
  buffer_load_dwordx4 v29, s[8:11], s25 offen offset:1024 lds
  buffer_load_dwordx4 v30, s[8:11], s25 offen offset:2048 lds
  buffer_load_dwordx4 v31, s[8:11], s25 offen offset:3072 lds
  s_add_u32 m0, s33, 28672
  s_nop 0
  buffer_load_dwordx4 v28, s[76:79], s26 offen offset:0 lds
  buffer_load_dwordx4 v29, s[76:79], s26 offen offset:1024 lds
  buffer_load_dwordx4 v30, s[76:79], s29 offen offset:2048 lds
  buffer_load_dwordx4 v31, s[76:79], s29 offen offset:3072 lds
  s_add_u32 s26, s26, 51200
  s_add_u32 s29, s29, 51200
  s_add_u32 m0, s33, 32768
  s_nop 0
  buffer_load_dwordx4 v28, s[76:79], s26 offen offset:0 lds
  buffer_load_dwordx4 v29, s[76:79], s26 offen offset:1024 lds
  buffer_load_dwordx4 v30, s[76:79], s29 offen offset:2048 lds
  buffer_load_dwordx4 v31, s[76:79], s29 offen offset:3072 lds
  s_add_u32 s26, s26, 51200
  s_add_u32 s29, s29, 51200
  s_add_u32 m0, s33, 0
  s_nop 0
  buffer_load_dwordx4 v28, s[76:79], s26 offen offset:0 lds
  buffer_load_dwordx4 v29, s[76:79], s26 offen offset:1024 lds
  buffer_load_dwordx4 v30, s[76:79], s29 offen offset:2048 lds
  buffer_load_dwordx4 v31, s[76:79], s29 offen offset:3072 lds
  s_add_u32 s26, s26, 51200
  s_add_u32 s29, s29, 51200
  s_waitcnt lgkmcnt(0)
  s_add_u32 m0, s33, 4096
  s_nop 0
  buffer_load_dwordx4 v28, s[76:79], s26 offen offset:0 lds
  buffer_load_dwordx4 v29, s[76:79], s26 offen offset:1024 lds
  buffer_load_dwordx4 v30, s[76:79], s29 offen offset:2048 lds
  buffer_load_dwordx4 v31, s[76:79], s29 offen offset:3072 lds
  s_mov_b32 exec_lo, 65535
  s_mov_b32 exec_hi, 0
  buffer_load_dword v23, v104, s[12:15], 0 offen sc1
  s_mov_b64 exec, -1
  s_add_u32 m0, s33, 8192
  s_nop 0
  buffer_load_dwordx4 v100, s[76:79], s30 offen offset:0 lds
  buffer_load_dwordx4 v101, s[76:79], s30 offen offset:1024 lds
  buffer_load_dwordx4 v102, s[76:79], s30 offen offset:2048 lds
  buffer_load_dwordx4 v103, s[76:79], s30 offen offset:3072 lds
  s_waitcnt vmcnt(4) lgkmcnt(0)
  v_and_b32 v23, 1, v23
  v_cmp_ne_u32 vcc, v23, v105
  s_nop 0
  s_and_b32 vcc_lo, vcc_lo, 65535
  s_and_b32 vcc_hi, vcc_hi, 0
  s_cbranch_vccz LphNok
  s_mov_b32 exec_lo, 65535
  s_mov_b32 exec_hi, 0
  s_mov_b32 s35, 0x20000
LphN:
  buffer_load_dword v23, v104, s[12:15], 0 offen sc1
  s_sub_u32 s35, s35, 1
  s_waitcnt vmcnt(0)
  v_and_b32 v23, 1, v23
  v_cmp_ne_u32 vcc, v23, v105
  s_cmp_eq_u32 s35, 0
  s_cbranch_scc1 LphNx
  s_cbranch_vccnz LphN
LphNx:
  s_mov_b64 exec, -1
LphNok:
  buffer_load_dwordx4 a[0:3], v4, s[4:7], s24 offen sc1
  buffer_load_dwordx4 a[4:7], v5, s[4:7], s24 offen sc1
  buffer_load_dwordx4 a[8:11], v6, s[4:7], s24 offen sc1
  buffer_load_dwordx4 a[12:15], v7, s[4:7], s24 offen sc1
  buffer_load_dwordx4 a[16:19], v8, s[4:7], s24 offen sc1
  buffer_load_dwordx4 a[20:23], v9, s[4:7], s24 offen sc1
  s_add_u32 s24, s24, 1024
  s_cmp_eq_u32 s24, s19
  s_cselect_b32 s24, s18, s24
  s_cselect_b32 s6, s68, s14
  buffer_load_dwordx4 a[24:27], v4, s[4:7], s24 offen sc1
  buffer_load_dwordx4 a[28:31], v5, s[4:7], s24 offen sc1
  buffer_load_dwordx4 a[32:35], v6, s[4:7], s24 offen sc1
  buffer_load_dwordx4 a[36:39], v7, s[4:7], s24 offen sc1
  buffer_load_dwordx4 a[40:43], v8, s[4:7], s24 offen sc1
  buffer_load_dwordx4 a[44:47], v9, s[4:7], s24 offen sc1
  s_add_u32 s24, s24, 1024
  s_cmp_eq_u32 s24, s19
  s_cselect_b32 s24, s18, s24
  s_cselect_b32 s6, s68, s14
  buffer_load_dwordx4 a[48:51], v4, s[4:7], s24 offen sc1
  buffer_load_dwordx4 a[52:55], v5, s[4:7], s24 offen sc1
  buffer_load_dwordx4 a[56:59], v6, s[4:7], s24 offen sc1
  buffer_load_dwordx4 a[60:63], v7, s[4:7], s24 offen sc1
  buffer_load_dwordx4 a[64:67], v8, s[4:7], s24 offen sc1
  buffer_load_dwordx4 a[68:71], v9, s[4:7], s24 offen sc1
  s_add_u32 s24, s24, 1024
  s_cmp_eq_u32 s24, s19
  s_cselect_b32 s24, s18, s24
  s_cselect_b32 s6, s68, s14
  buffer_load_dwordx4 a[72:75], v4, s[4:7], s24 offen sc1
  buffer_load_dwordx4 a[76:79], v5, s[4:7], s24 offen sc1
  buffer_load_dwordx4 v[184:187], v6, s[4:7], s24 offen sc1
  buffer_load_dwordx4 v[188:191], v7, s[4:7], s24 offen sc1
  buffer_load_dwordx4 v[192:195], v8, s[4:7], s24 offen sc1
  buffer_load_dwordx4 v[196:199], v9, s[4:7], s24 offen sc1
  s_add_u32 s24, s24, 1024
  s_cmp_eq_u32 s24, s19
  s_cselect_b32 s24, s18, s24
  s_cselect_b32 s6, s68, s14
  s_branch LvN6
LswN:
  s_sub_u32 s4, s44, 4096
  s_subb_u32 s5, s45, 0
  s_mov_b32 s6, 2215936
  s_mov_b32 s8, s4
  s_mov_b32 s9, s5
  s_mov_b32 s10, s6
  s_add_u32 s24, s62, s71
  s_mul_i32 s24, s24, 40960
  s_add_u32 s25, s24, 40960
  s_add_u32 s80, s62, 14
  s_mul_i32 s80, s80, 40960
  s_mov_b32 s81, 573440
  s_mov_b32 s82, s80
  s_mov_b32 s83, s81
  s_cmp_ge_u32 s25, s82
  s_cselect_b32 s34, s83, 0
  s_sub_u32 s25, s25, s34
  s_mov_b32 s26, 122880
  s_mov_b32 s31, s26
  v_mov_b32 v14, v28
  v_mov_b32 v18, v28
  v_add_u32 v22, 40960, v28
  v_mov_b32 v15, v29
  v_mov_b32 v19, v29
  v_add_u32 v23, 40960, v29
  v_mov_b32 v16, v30
  v_mov_b32 v20, v30
  v_add_u32 v24, 40960, v30
  v_mov_b32 v17, v31
  v_mov_b32 v21, v31
  v_add_u32 v25, 40960, v31
  s_branch LswbN
LtcN:
  buffer_load_dword a253, v54, s[44:47], 0 offen
  buffer_load_dword a252, v55, s[40:43], 0 offen
  v_add_u32 v54, 4992, v54
  v_add_u32 v55, 1920, v55
  s_branch LtcbN
LvA5:
  s_waitcnt vmcnt(15)
  v_mfma_f32_16x16x32_bf16 v[32:35], a[80:83], a[0:3], 0
  v_mfma_f32_16x16x32_bf16 v[36:39], a[84:87], a[0:3], 0
  v_mfma_f32_16x16x32_bf16 v[40:43], a[88:91], a[0:3], 0
  v_mfma_f32_16x16x32_bf16 v[44:47], a[92:95], a[0:3], 0
  buffer_load_dwordx4 a[0:3], v4, s[4:7], s24 offen sc1
  v_mfma_f32_16x16x32_bf16 v[48:51], a[80:83], a[4:7], 0
  v_mfma_f32_16x16x32_bf16 v[52:55], a[84:87], a[4:7], 0
  v_mfma_f32_16x16x32_bf16 v[56:59], a[88:91], a[4:7], 0
  v_mfma_f32_16x16x32_bf16 v[60:63], a[92:95], a[4:7], 0
  buffer_load_dwordx4 a[4:7], v5, s[4:7], s24 offen sc1
  v_mfma_f32_16x16x32_bf16 v[64:67], a[80:83], a[8:11], 0
  v_mfma_f32_16x16x32_bf16 v[68:71], a[84:87], a[8:11], 0
  v_mfma_f32_16x16x32_bf16 v[72:75], a[88:91], a[8:11], 0
  v_mfma_f32_16x16x32_bf16 v[76:79], a[92:95], a[8:11], 0
  buffer_load_dwordx4 a[8:11], v6, s[4:7], s24 offen sc1
  v_mfma_f32_16x16x32_bf16 v[80:83], a[80:83], a[12:15], 0
  v_mfma_f32_16x16x32_bf16 v[84:87], a[84:87], a[12:15], 0
  v_mfma_f32_16x16x32_bf16 v[88:91], a[88:91], a[12:15], 0
  v_mfma_f32_16x16x32_bf16 v[92:95], a[92:95], a[12:15], 0
  buffer_load_dwordx4 a[12:15], v7, s[4:7], s24 offen sc1
  v_mfma_f32_16x16x32_bf16 v[108:111], a[80:83], a[16:19], 0
  v_mfma_f32_16x16x32_bf16 v[112:115], a[84:87], a[16:19], 0
  v_mfma_f32_16x16x32_bf16 v[116:119], a[88:91], a[16:19], 0
  v_mfma_f32_16x16x32_bf16 v[120:123], a[92:95], a[16:19], 0
  buffer_load_dwordx4 a[16:19], v8, s[4:7], s24 offen sc1
  s_waitcnt vmcnt(15)
  v_mfma_f32_16x16x32_bf16 v[32:35], a[96:99], a[20:23], v[32:35]
  s_add_u32 s24, s24, 1024
  v_mfma_f32_16x16x32_bf16 v[36:39], a[100:103], a[20:23], v[36:39]
  v_mfma_f32_16x16x32_bf16 v[40:43], a[104:107], a[20:23], v[40:43]
  s_cmp_eq_u32 s24, s19
  s_cselect_b32 s24, s18, s24
  s_cselect_b32 s6, s68, s14
  v_mfma_f32_16x16x32_bf16 v[44:47], a[108:111], a[20:23], v[44:47]
  buffer_load_dwordx4 a[20:23], v4, s[4:7], s24 offen sc1
  v_mfma_f32_16x16x32_bf16 v[48:51], a[96:99], a[24:27], v[48:51]
  v_mfma_f32_16x16x32_bf16 v[52:55], a[100:103], a[24:27], v[52:55]
  v_mfma_f32_16x16x32_bf16 v[56:59], a[104:107], a[24:27], v[56:59]
  v_mfma_f32_16x16x32_bf16 v[60:63], a[108:111], a[24:27], v[60:63]
  buffer_load_dwordx4 a[24:27], v5, s[4:7], s24 offen sc1
  v_mfma_f32_16x16x32_bf16 v[64:67], a[96:99], a[28:31], v[64:67]
  v_mfma_f32_16x16x32_bf16 v[68:71], a[100:103], a[28:31], v[68:71]
  v_mfma_f32_16x16x32_bf16 v[72:75], a[104:107], a[28:31], v[72:75]
  v_mfma_f32_16x16x32_bf16 v[76:79], a[108:111], a[28:31], v[76:79]
  buffer_load_dwordx4 a[28:31], v6, s[4:7], s24 offen sc1
  v_mfma_f32_16x16x32_bf16 v[80:83], a[96:99], a[32:35], v[80:83]
  v_mfma_f32_16x16x32_bf16 v[84:87], a[100:103], a[32:35], v[84:87]
  v_mfma_f32_16x16x32_bf16 v[88:91], a[104:107], a[32:35], v[88:91]
  v_mfma_f32_16x16x32_bf16 v[92:95], a[108:111], a[32:35], v[92:95]
  buffer_load_dwordx4 a[32:35], v7, s[4:7], s24 offen sc1
  v_mfma_f32_16x16x32_bf16 v[108:111], a[96:99], a[36:39], v[108:111]
  v_mfma_f32_16x16x32_bf16 v[112:115], a[100:103], a[36:39], v[112:115]
  v_mfma_f32_16x16x32_bf16 v[116:119], a[104:107], a[36:39], v[116:119]
  v_mfma_f32_16x16x32_bf16 v[120:123], a[108:111], a[36:39], v[120:123]
  buffer_load_dwordx4 a[36:39], v8, s[4:7], s24 offen sc1
  s_waitcnt vmcnt(15)
  s_waitcnt vmcnt(10)
  s_barrier
  s_cmp_lg_u32 s20, 0
  s_cbranch_scc1 LsigA5
  s_mov_b32 exec_lo, 0
  s_mov_b32 exec_hi, 0x10000
  buffer_store_dword v105, v104, s[12:15], 0 offen sc1
  s_mov_b64 exec, -1
LsigA5:
  v_mfma_f32_16x16x32_bf16 v[32:35], a[112:115], a[40:43], v[32:35]
  v_xor_b32 v24, v2, v3
  s_add_u32 s24, s24, 1024
  v_mfma_f32_16x16x32_bf16 v[36:39], a[116:119], a[40:43], v[36:39]
  v_lshlrev_b32 v24, 4, v24
  v_mfma_f32_16x16x32_bf16 v[40:43], a[120:123], a[40:43], v[40:43]
  v_lshl_add_u32 v24, v3, 8, v24
  s_cmp_eq_u32 s24, s19
  s_cselect_b32 s24, s18, s24
  s_cselect_b32 s6, s68, s14
  v_mfma_f32_16x16x32_bf16 v[44:47], a[124:127], a[40:43], v[44:47]
  buffer_load_dwordx4 a[40:43], v4, s[4:7], s24 offen sc1
  v_mfma_f32_16x16x32_bf16 v[48:51], a[112:115], a[44:47], v[48:51]
  v_mfma_f32_16x16x32_bf16 v[52:55], a[116:119], a[44:47], v[52:55]
  v_add_u32 v172, s33, v24
  v_mfma_f32_16x16x32_bf16 v[56:59], a[120:123], a[44:47], v[56:59]
  v_xor_b32 v173, 64, v172
  v_mfma_f32_16x16x32_bf16 v[60:63], a[124:127], a[44:47], v[60:63]
  buffer_load_dwordx4 a[44:47], v5, s[4:7], s24 offen sc1
  v_mfma_f32_16x16x32_bf16 v[64:67], a[112:115], a[48:51], v[64:67]
  v_xor_b32 v174, 128, v172
  v_mfma_f32_16x16x32_bf16 v[68:71], a[116:119], a[48:51], v[68:71]
  v_mfma_f32_16x16x32_bf16 v[72:75], a[120:123], a[48:51], v[72:75]
  v_xor_b32 v175, 192, v172
  v_mfma_f32_16x16x32_bf16 v[76:79], a[124:127], a[48:51], v[76:79]
  buffer_load_dwordx4 a[48:51], v6, s[4:7], s24 offen sc1
  v_mfma_f32_16x16x32_bf16 v[80:83], a[112:115], a[52:55], v[80:83]
  v_bfe_u32 v24, v0, 3, 4
  v_mfma_f32_16x16x32_bf16 v[84:87], a[116:119], a[52:55], v[84:87]
  v_and_b32 v25, 7, v0
  v_mfma_f32_16x16x32_bf16 v[88:91], a[120:123], a[52:55], v[88:91]
  v_mfma_f32_16x16x32_bf16 v[92:95], a[124:127], a[52:55], v[92:95]
  buffer_load_dwordx4 a[52:55], v7, s[4:7], s24 offen sc1
  v_mfma_f32_16x16x32_bf16 v[108:111], a[112:115], a[56:59], v[108:111]
  v_lshlrev_b32 v26, 1, v25
  v_mfma_f32_16x16x32_bf16 v[112:115], a[116:119], a[56:59], v[112:115]
  v_xor_b32 v26, v26, v24
  v_mfma_f32_16x16x32_bf16 v[116:119], a[120:123], a[56:59], v[116:119]
  v_mfma_f32_16x16x32_bf16 v[120:123], a[124:127], a[56:59], v[120:123]
  buffer_load_dwordx4 a[56:59], v8, s[4:7], s24 offen sc1
  s_waitcnt vmcnt(15)
  v_mfma_f32_16x16x32_bf16 v[32:35], a[128:131], a[60:63], v[32:35]
  v_lshlrev_b32 v26, 4, v26
  s_add_u32 s24, s24, 1024
  v_mfma_f32_16x16x32_bf16 v[36:39], a[132:135], a[60:63], v[36:39]
  v_lshl_add_u32 v26, v24, 8, v26
  v_mfma_f32_16x16x32_bf16 v[40:43], a[136:139], a[60:63], v[40:43]
  s_lshr_b32 s59, s20, 1
  s_cmp_eq_u32 s24, s19
  s_cselect_b32 s24, s18, s24
  s_cselect_b32 s6, s68, s14
  v_mfma_f32_16x16x32_bf16 v[44:47], a[140:143], a[60:63], v[44:47]
  buffer_load_dwordx4 a[60:63], v4, s[4:7], s24 offen sc1
  v_mfma_f32_16x16x32_bf16 v[48:51], a[128:131], a[64:67], v[48:51]
  s_lshl_b32 s58, s59, 12
  v_mfma_f32_16x16x32_bf16 v[52:55], a[132:135], a[64:67], v[52:55]
  v_mfma_f32_16x16x32_bf16 v[56:59], a[136:139], a[64:67], v[56:59]
  v_add_u32 v176, s58, v26
  v_mfma_f32_16x16x32_bf16 v[60:63], a[140:143], a[64:67], v[60:63]
  buffer_load_dwordx4 a[64:67], v5, s[4:7], s24 offen sc1
  v_mfma_f32_16x16x32_bf16 v[64:67], a[128:131], a[68:71], v[64:67]
  v_xor_b32 v177, 16, v176
  v_mfma_f32_16x16x32_bf16 v[68:71], a[132:135], a[68:71], v[68:71]
  v_add_u32 v178, 81920, v176
  v_mfma_f32_16x16x32_bf16 v[72:75], a[136:139], a[68:71], v[72:75]
  v_add_u32 v179, 81920, v177
  v_mfma_f32_16x16x32_bf16 v[76:79], a[140:143], a[68:71], v[76:79]
  buffer_load_dwordx4 a[68:71], v6, s[4:7], s24 offen sc1
  v_mfma_f32_16x16x32_bf16 v[80:83], a[128:131], a[72:75], v[80:83]
  v_mfma_f32_16x16x32_bf16 v[84:87], a[132:135], a[72:75], v[84:87]
  s_mov_b32 s72, s50
  v_mfma_f32_16x16x32_bf16 v[88:91], a[136:139], a[72:75], v[88:91]
  s_mov_b32 s73, s51
  v_mfma_f32_16x16x32_bf16 v[92:95], a[140:143], a[72:75], v[92:95]
  buffer_load_dwordx4 a[72:75], v7, s[4:7], s24 offen sc1
  v_mfma_f32_16x16x32_bf16 v[108:111], a[128:131], a[76:79], v[108:111]
  s_mov_b32 s74, 2621440
  v_mfma_f32_16x16x32_bf16 v[112:115], a[132:135], a[76:79], v[112:115]
  s_lshl_b32 s23, s23, 7
  v_mfma_f32_16x16x32_bf16 v[116:119], a[136:139], a[76:79], v[116:119]
  v_mfma_f32_16x16x32_bf16 v[120:123], a[140:143], a[76:79], v[120:123]
  buffer_load_dwordx4 a[76:79], v8, s[4:7], s24 offen sc1
  s_waitcnt vmcnt(15)
  v_mfma_f32_16x16x32_bf16 v[32:35], a[144:147], a[0:3], v[32:35]
  v_lshl_add_u32 v25, v25, 4, s23
  s_add_u32 s24, s24, 1024
  v_mfma_f32_16x16x32_bf16 v[36:39], a[148:151], a[0:3], v[36:39]
  v_mul_u32_u24 v24, 2560, v24
  v_mfma_f32_16x16x32_bf16 v[40:43], a[152:155], a[0:3], v[40:43]
  s_add_u32 s58, s59, s21
  s_cmp_eq_u32 s24, s19
  s_cselect_b32 s24, s18, s24
  s_cselect_b32 s6, s68, s14
  v_mfma_f32_16x16x32_bf16 v[44:47], a[156:159], a[0:3], v[44:47]
  buffer_load_dwordx4 a[0:3], v4, s[4:7], s24 offen sc1
  v_mfma_f32_16x16x32_bf16 v[48:51], a[144:147], a[4:7], v[48:51]
  s_and_b32 s59, s58, 1
  v_mfma_f32_16x16x32_bf16 v[52:55], a[148:151], a[4:7], v[52:55]
  v_mfma_f32_16x16x32_bf16 v[56:59], a[152:155], a[4:7], v[56:59]
  s_lshr_b32 s58, s58, 1
  v_mfma_f32_16x16x32_bf16 v[60:63], a[156:159], a[4:7], v[60:63]
  buffer_load_dwordx4 a[4:7], v5, s[4:7], s24 offen sc1
  v_mfma_f32_16x16x32_bf16 v[64:67], a[144:147], a[8:11], v[64:67]
  s_lshl_b32 s58, s58, 5
  v_mfma_f32_16x16x32_bf16 v[68:71], a[148:151], a[8:11], v[68:71]
  s_add_u32 s58, s58, s59
  v_mfma_f32_16x16x32_bf16 v[72:75], a[152:155], a[8:11], v[72:75]
  s_mul_i32 s58, s58, 1280
  v_mfma_f32_16x16x32_bf16 v[76:79], a[156:159], a[8:11], v[76:79]
  buffer_load_dwordx4 a[8:11], v6, s[4:7], s24 offen sc1
  v_mfma_f32_16x16x32_bf16 v[80:83], a[144:147], a[12:15], v[80:83]
  v_mfma_f32_16x16x32_bf16 v[84:87], a[148:151], a[12:15], v[84:87]
  v_add3_u32 v180, v24, v25, s58
  v_mfma_f32_16x16x32_bf16 v[88:91], a[152:155], a[12:15], v[88:91]
  s_lshl_b32 s63, s21, 6
  v_mfma_f32_16x16x32_bf16 v[92:95], a[156:159], a[12:15], v[92:95]
  buffer_load_dwordx4 a[12:15], v7, s[4:7], s24 offen sc1
  v_mfma_f32_16x16x32_bf16 v[108:111], a[144:147], a[16:19], v[108:111]
  s_add_u32 s63, s63, 10485760
  v_mfma_f32_16x16x32_bf16 v[112:115], a[148:151], a[16:19], v[112:115]
  v_lshlrev_b32 v22, 2, v3
  v_mfma_f32_16x16x32_bf16 v[116:119], a[152:155], a[16:19], v[116:119]
  v_mfma_f32_16x16x32_bf16 v[120:123], a[156:159], a[16:19], v[120:123]
  buffer_load_dwordx4 a[16:19], v8, s[4:7], s24 offen sc1
  s_waitcnt vmcnt(15)
  v_mfma_f32_16x16x32_bf16 v[32:35], a[160:163], a[20:23], v[32:35]
  ds_read_b64_tr_b16 a[80:81], v96 offset:28672
  s_add_u32 s24, s24, 1024
  v_mfma_f32_16x16x32_bf16 v[36:39], a[164:167], a[20:23], v[36:39]
  ds_read_b64_tr_b16 a[82:83], v96 offset:30720
  v_mfma_f32_16x16x32_bf16 v[40:43], a[168:171], a[20:23], v[40:43]
  ds_read_b64_tr_b16 a[84:85], v97 offset:28672
  s_cmp_eq_u32 s24, s19
  s_cselect_b32 s24, s18, s24
  s_cselect_b32 s6, s68, s14
  v_mfma_f32_16x16x32_bf16 v[44:47], a[172:175], a[20:23], v[44:47]
  buffer_load_dwordx4 a[20:23], v4, s[4:7], s24 offen sc1
  v_mfma_f32_16x16x32_bf16 v[48:51], a[160:163], a[24:27], v[48:51]
  ds_read_b64_tr_b16 a[86:87], v97 offset:30720
  v_mfma_f32_16x16x32_bf16 v[52:55], a[164:167], a[24:27], v[52:55]
  v_mfma_f32_16x16x32_bf16 v[56:59], a[168:171], a[24:27], v[56:59]
  ds_read_b64_tr_b16 a[88:89], v98 offset:28672
  v_mfma_f32_16x16x32_bf16 v[60:63], a[172:175], a[24:27], v[60:63]
  buffer_load_dwordx4 a[24:27], v5, s[4:7], s24 offen sc1
  v_mfma_f32_16x16x32_bf16 v[64:67], a[160:163], a[28:31], v[64:67]
  ds_read_b64_tr_b16 a[90:91], v98 offset:30720
  v_mfma_f32_16x16x32_bf16 v[68:71], a[164:167], a[28:31], v[68:71]
  ds_read_b64_tr_b16 a[92:93], v99 offset:28672
  v_mfma_f32_16x16x32_bf16 v[72:75], a[168:171], a[28:31], v[72:75]
  ds_read_b64_tr_b16 a[94:95], v99 offset:30720
  v_mfma_f32_16x16x32_bf16 v[76:79], a[172:175], a[28:31], v[76:79]
  buffer_load_dwordx4 a[28:31], v6, s[4:7], s24 offen sc1
  v_mfma_f32_16x16x32_bf16 v[80:83], a[160:163], a[32:35], v[80:83]
  v_mfma_f32_16x16x32_bf16 v[84:87], a[164:167], a[32:35], v[84:87]
  v_mfma_f32_16x16x32_bf16 v[88:91], a[168:171], a[32:35], v[88:91]
  v_mfma_f32_16x16x32_bf16 v[92:95], a[172:175], a[32:35], v[92:95]
  buffer_load_dwordx4 a[32:35], v7, s[4:7], s24 offen sc1
  v_mfma_f32_16x16x32_bf16 v[108:111], a[160:163], a[36:39], v[108:111]
  v_mfma_f32_16x16x32_bf16 v[112:115], a[164:167], a[36:39], v[112:115]
  v_mfma_f32_16x16x32_bf16 v[116:119], a[168:171], a[36:39], v[116:119]
  v_mfma_f32_16x16x32_bf16 v[120:123], a[172:175], a[36:39], v[120:123]
  buffer_load_dwordx4 a[36:39], v8, s[4:7], s24 offen sc1
  s_waitcnt vmcnt(15)
  v_mfma_f32_16x16x32_bf16 v[32:35], a[176:179], a[40:43], v[32:35]
  ds_read_b64_tr_b16 a[96:97], v96 offset:32768
  s_add_u32 s24, s24, 1024
  v_mfma_f32_16x16x32_bf16 v[36:39], a[180:183], a[40:43], v[36:39]
  ds_read_b64_tr_b16 a[98:99], v96 offset:34816
  v_mfma_f32_16x16x32_bf16 v[40:43], a[184:187], a[40:43], v[40:43]
  ds_read_b64_tr_b16 a[100:101], v97 offset:32768
  s_cmp_eq_u32 s24, s19
  s_cselect_b32 s24, s18, s24
  s_cselect_b32 s6, s68, s14
  v_mfma_f32_16x16x32_bf16 v[44:47], a[188:191], a[40:43], v[44:47]
  buffer_load_dwordx4 a[40:43], v4, s[4:7], s24 offen sc1
  v_mfma_f32_16x16x32_bf16 v[48:51], a[176:179], a[44:47], v[48:51]
  ds_read_b64_tr_b16 a[102:103], v97 offset:34816
  v_mfma_f32_16x16x32_bf16 v[52:55], a[180:183], a[44:47], v[52:55]
  v_mfma_f32_16x16x32_bf16 v[56:59], a[184:187], a[44:47], v[56:59]
  ds_read_b64_tr_b16 a[104:105], v98 offset:32768
  v_mfma_f32_16x16x32_bf16 v[60:63], a[188:191], a[44:47], v[60:63]
  buffer_load_dwordx4 a[44:47], v5, s[4:7], s24 offen sc1
  v_mfma_f32_16x16x32_bf16 v[64:67], a[176:179], a[48:51], v[64:67]
  ds_read_b64_tr_b16 a[106:107], v98 offset:34816
  v_mfma_f32_16x16x32_bf16 v[68:71], a[180:183], a[48:51], v[68:71]
  ds_read_b64_tr_b16 a[108:109], v99 offset:32768
  v_mfma_f32_16x16x32_bf16 v[72:75], a[184:187], a[48:51], v[72:75]
  ds_read_b64_tr_b16 a[110:111], v99 offset:34816
  v_mfma_f32_16x16x32_bf16 v[76:79], a[188:191], a[48:51], v[76:79]
  buffer_load_dwordx4 a[48:51], v6, s[4:7], s24 offen sc1
  v_mfma_f32_16x16x32_bf16 v[80:83], a[176:179], a[52:55], v[80:83]
  v_mfma_f32_16x16x32_bf16 v[84:87], a[180:183], a[52:55], v[84:87]
  v_mfma_f32_16x16x32_bf16 v[88:91], a[184:187], a[52:55], v[88:91]
  v_mfma_f32_16x16x32_bf16 v[92:95], a[188:191], a[52:55], v[92:95]
  buffer_load_dwordx4 a[52:55], v7, s[4:7], s24 offen sc1
  v_mfma_f32_16x16x32_bf16 v[108:111], a[176:179], a[56:59], v[108:111]
  v_mfma_f32_16x16x32_bf16 v[112:115], a[180:183], a[56:59], v[112:115]
  v_mfma_f32_16x16x32_bf16 v[116:119], a[184:187], a[56:59], v[116:119]
  v_mfma_f32_16x16x32_bf16 v[120:123], a[188:191], a[56:59], v[120:123]
  buffer_load_dwordx4 a[56:59], v8, s[4:7], s24 offen sc1
  s_waitcnt vmcnt(15)
  v_mfma_f32_16x16x32_bf16 v[32:35], a[192:195], a[60:63], v[32:35]
  ds_read_b64_tr_b16 a[112:113], v96 offset:0
  s_add_u32 s24, s24, 1024
  v_mfma_f32_16x16x32_bf16 v[36:39], a[196:199], a[60:63], v[36:39]
  ds_read_b64_tr_b16 a[114:115], v96 offset:2048
  v_mfma_f32_16x16x32_bf16 v[40:43], a[200:203], a[60:63], v[40:43]
  ds_read_b64_tr_b16 a[116:117], v97 offset:0
  s_cmp_eq_u32 s24, s19
  s_cselect_b32 s24, s18, s24
  s_cselect_b32 s6, s68, s14
  v_mfma_f32_16x16x32_bf16 v[44:47], a[204:207], a[60:63], v[44:47]
  buffer_load_dwordx4 a[60:63], v4, s[4:7], s24 offen sc1
  v_mfma_f32_16x16x32_bf16 v[48:51], a[192:195], a[64:67], v[48:51]
  ds_read_b64_tr_b16 a[118:119], v97 offset:2048
  v_mfma_f32_16x16x32_bf16 v[52:55], a[196:199], a[64:67], v[52:55]
  v_mfma_f32_16x16x32_bf16 v[56:59], a[200:203], a[64:67], v[56:59]
  ds_read_b64_tr_b16 a[120:121], v98 offset:0
  v_mfma_f32_16x16x32_bf16 v[60:63], a[204:207], a[64:67], v[60:63]
  buffer_load_dwordx4 a[64:67], v5, s[4:7], s24 offen sc1
  v_mfma_f32_16x16x32_bf16 v[64:67], a[192:195], a[68:71], v[64:67]
  ds_read_b64_tr_b16 a[122:123], v98 offset:2048
  v_mfma_f32_16x16x32_bf16 v[68:71], a[196:199], a[68:71], v[68:71]
  ds_read_b64_tr_b16 a[124:125], v99 offset:0
  v_mfma_f32_16x16x32_bf16 v[72:75], a[200:203], a[68:71], v[72:75]
  ds_read_b64_tr_b16 a[126:127], v99 offset:2048
  v_mfma_f32_16x16x32_bf16 v[76:79], a[204:207], a[68:71], v[76:79]
  buffer_load_dwordx4 a[68:71], v6, s[4:7], s24 offen sc1
  v_mfma_f32_16x16x32_bf16 v[80:83], a[192:195], a[72:75], v[80:83]
  v_mfma_f32_16x16x32_bf16 v[84:87], a[196:199], a[72:75], v[84:87]
  v_mfma_f32_16x16x32_bf16 v[88:91], a[200:203], a[72:75], v[88:91]
  v_mfma_f32_16x16x32_bf16 v[92:95], a[204:207], a[72:75], v[92:95]
  buffer_load_dwordx4 a[72:75], v7, s[4:7], s24 offen sc1
  v_mfma_f32_16x16x32_bf16 v[108:111], a[192:195], a[76:79], v[108:111]
  v_mfma_f32_16x16x32_bf16 v[112:115], a[196:199], a[76:79], v[112:115]
  v_mfma_f32_16x16x32_bf16 v[116:119], a[200:203], a[76:79], v[116:119]
  v_mfma_f32_16x16x32_bf16 v[120:123], a[204:207], a[76:79], v[120:123]
  buffer_load_dwordx4 a[76:79], v8, s[4:7], s24 offen sc1
  s_waitcnt vmcnt(15)
  v_mfma_f32_16x16x32_bf16 v[32:35], a[208:211], a[0:3], v[32:35]
  ds_read_b64_tr_b16 a[240:241], v96 offset:36864
  ds_read_b64_tr_b16 a[242:243], v96 offset:38912
  s_add_u32 s24, s24, 1024
  v_mfma_f32_16x16x32_bf16 v[36:39], a[212:215], a[0:3], v[36:39]
  ds_read_b64_tr_b16 a[244:245], v97 offset:36864
  s_mov_b32 exec_lo, 4294901760
  s_mov_b32 exec_hi, 65535
  buffer_load_dword v23, v104, s[12:15], 0 offen sc1
  s_mov_b64 exec, -1
  v_mfma_f32_16x16x32_bf16 v[40:43], a[216:219], a[0:3], v[40:43]
  ds_read_b64_tr_b16 a[246:247], v97 offset:38912
  s_cmp_eq_u32 s24, s19
  s_cselect_b32 s24, s18, s24
  s_cselect_b32 s6, s68, s14
  v_mfma_f32_16x16x32_bf16 v[44:47], a[220:223], a[0:3], v[44:47]
  buffer_load_dwordx4 a[0:3], v4, s[4:7], s24 offen sc1
  v_mfma_f32_16x16x32_bf16 v[48:51], a[208:211], a[4:7], v[48:51]
  ds_read_b64_tr_b16 a[248:249], v98 offset:36864
  v_mfma_f32_16x16x32_bf16 v[52:55], a[212:215], a[4:7], v[52:55]
  ds_read_b64_tr_b16 a[250:251], v98 offset:38912
  v_mfma_f32_16x16x32_bf16 v[56:59], a[216:219], a[4:7], v[56:59]
  ds_read_b64_tr_b16 a[252:253], v99 offset:36864
  v_mfma_f32_16x16x32_bf16 v[60:63], a[220:223], a[4:7], v[60:63]
  buffer_load_dwordx4 a[4:7], v5, s[4:7], s24 offen sc1
  v_mfma_f32_16x16x32_bf16 v[64:67], a[208:211], a[8:11], v[64:67]
  ds_read_b64_tr_b16 a[254:255], v99 offset:38912
  v_mfma_f32_16x16x32_bf16 v[68:71], a[212:215], a[8:11], v[68:71]
  ds_read_b64_tr_b16 a[128:129], v96 offset:4096
  v_mfma_f32_16x16x32_bf16 v[72:75], a[216:219], a[8:11], v[72:75]
  ds_read_b64_tr_b16 a[130:131], v96 offset:6144
  v_mfma_f32_16x16x32_bf16 v[76:79], a[220:223], a[8:11], v[76:79]
  buffer_load_dwordx4 a[8:11], v6, s[4:7], s24 offen sc1
  v_mfma_f32_16x16x32_bf16 v[80:83], a[208:211], a[12:15], v[80:83]
  ds_read_b64_tr_b16 a[132:133], v97 offset:4096
  v_mfma_f32_16x16x32_bf16 v[84:87], a[212:215], a[12:15], v[84:87]
  ds_read_b64_tr_b16 a[134:135], v97 offset:6144
  v_mfma_f32_16x16x32_bf16 v[88:91], a[216:219], a[12:15], v[88:91]
  ds_read_b64_tr_b16 a[136:137], v98 offset:4096
  v_mfma_f32_16x16x32_bf16 v[92:95], a[220:223], a[12:15], v[92:95]
  buffer_load_dwordx4 a[12:15], v7, s[4:7], s24 offen sc1
  v_mfma_f32_16x16x32_bf16 v[108:111], a[208:211], a[16:19], v[108:111]
  ds_read_b64_tr_b16 a[138:139], v98 offset:6144
  v_mfma_f32_16x16x32_bf16 v[112:115], a[212:215], a[16:19], v[112:115]
  ds_read_b64_tr_b16 a[140:141], v99 offset:4096
  v_mfma_f32_16x16x32_bf16 v[116:119], a[216:219], a[16:19], v[116:119]
  ds_read_b64_tr_b16 a[142:143], v99 offset:6144
  v_mfma_f32_16x16x32_bf16 v[120:123], a[220:223], a[16:19], v[120:123]
  buffer_load_dwordx4 a[16:19], v8, s[4:7], s24 offen sc1
  s_waitcnt vmcnt(16) lgkmcnt(0)
  v_mfma_f32_16x16x32_bf16 v[32:35], a[240:243], a[20:23], v[32:35]
  ds_read_b64_tr_b16 a[224:225], v96 offset:12288
  ds_read_b64_tr_b16 a[226:227], v96 offset:14336
  s_add_u32 s24, s24, 1024
  v_mfma_f32_16x16x32_bf16 v[36:39], a[244:247], a[20:23], v[36:39]
  ds_read_b64_tr_b16 a[228:229], v97 offset:12288
  v_mfma_f32_16x16x32_bf16 v[40:43], a[248:251], a[20:23], v[40:43]
  ds_read_b64_tr_b16 a[230:231], v97 offset:14336
  s_cmp_eq_u32 s24, s19
  s_cselect_b32 s24, s18, s24
  s_cselect_b32 s6, s68, s14
  v_mfma_f32_16x16x32_bf16 v[44:47], a[252:255], a[20:23], v[44:47]
  buffer_load_dwordx4 a[20:23], v4, s[4:7], s24 offen sc1
  v_mfma_f32_16x16x32_bf16 v[48:51], a[240:243], a[24:27], v[48:51]
  ds_read_b64_tr_b16 a[232:233], v98 offset:12288
  v_mfma_f32_16x16x32_bf16 v[52:55], a[244:247], a[24:27], v[52:55]
  ds_read_b64_tr_b16 a[234:235], v98 offset:14336
  v_mfma_f32_16x16x32_bf16 v[56:59], a[248:251], a[24:27], v[56:59]
  ds_read_b64_tr_b16 a[236:237], v99 offset:12288
  v_mfma_f32_16x16x32_bf16 v[60:63], a[252:255], a[24:27], v[60:63]
  buffer_load_dwordx4 a[24:27], v5, s[4:7], s24 offen sc1
  v_mfma_f32_16x16x32_bf16 v[64:67], a[240:243], a[28:31], v[64:67]
  ds_read_b64_tr_b16 a[238:239], v99 offset:14336
  v_mfma_f32_16x16x32_bf16 v[68:71], a[244:247], a[28:31], v[68:71]
  ds_read_b64_tr_b16 a[144:145], v96 offset:8192
  v_mfma_f32_16x16x32_bf16 v[72:75], a[248:251], a[28:31], v[72:75]
  ds_read_b64_tr_b16 a[146:147], v96 offset:10240
  v_mfma_f32_16x16x32_bf16 v[76:79], a[252:255], a[28:31], v[76:79]
  buffer_load_dwordx4 a[28:31], v6, s[4:7], s24 offen sc1
  v_mfma_f32_16x16x32_bf16 v[80:83], a[240:243], a[32:35], v[80:83]
  ds_read_b64_tr_b16 a[148:149], v97 offset:8192
  v_mfma_f32_16x16x32_bf16 v[84:87], a[244:247], a[32:35], v[84:87]
  ds_read_b64_tr_b16 a[150:151], v97 offset:10240
  v_mfma_f32_16x16x32_bf16 v[88:91], a[248:251], a[32:35], v[88:91]
  ds_read_b64_tr_b16 a[152:153], v98 offset:8192
  v_mfma_f32_16x16x32_bf16 v[92:95], a[252:255], a[32:35], v[92:95]
  buffer_load_dwordx4 a[32:35], v7, s[4:7], s24 offen sc1
  v_mfma_f32_16x16x32_bf16 v[108:111], a[240:243], a[36:39], v[108:111]
  ds_read_b64_tr_b16 a[154:155], v98 offset:10240
  v_mfma_f32_16x16x32_bf16 v[112:115], a[244:247], a[36:39], v[112:115]
  ds_read_b64_tr_b16 a[156:157], v99 offset:8192
  v_mfma_f32_16x16x32_bf16 v[116:119], a[248:251], a[36:39], v[116:119]
  ds_read_b64_tr_b16 a[158:159], v99 offset:10240
  v_mfma_f32_16x16x32_bf16 v[120:123], a[252:255], a[36:39], v[120:123]
  buffer_load_dwordx4 a[36:39], v8, s[4:7], s24 offen sc1
  s_waitcnt vmcnt(10) lgkmcnt(0)
  v_and_b32 v23, 1, v23
  v_cmp_ne_u32 vcc, v23, v105
  s_nop 0
  s_and_b32 vcc_lo, vcc_lo, 4294901760
  s_and_b32 vcc_hi, vcc_hi, 65535
  s_cbranch_vccz LpoA5ok
  s_mov_b32 exec_lo, 4294901760
  s_mov_b32 exec_hi, 65535
  s_mov_b32 s35, 0x20000
LpoA5:
  buffer_load_dword v23, v104, s[12:15], 0 offen sc1
  s_sub_u32 s35, s35, 1
  s_waitcnt vmcnt(0)
  v_and_b32 v23, 1, v23
  v_cmp_ne_u32 vcc, v23, v105
  s_cmp_eq_u32 s35, 0
  s_cbranch_scc1 LpoA5x
  s_cbranch_vccnz LpoA5
LpoA5x:
  s_mov_b64 exec, -1
LpoA5ok:
  v_mfma_f32_16x16x32_bf16 v[32:35], a[224:227], a[40:43], v[32:35]
  ds_read_b64_tr_b16 a[240:241], v96 offset:16384
  v_mfma_f32_16x16x32_bf16 v[36:39], a[228:231], a[40:43], v[36:39]
  ds_read_b64_tr_b16 a[242:243], v96 offset:18432
  buffer_load_dword v10, v22, s[12:15], s63 offen offset:0 sc1
  v_mfma_f32_16x16x32_bf16 v[40:43], a[232:235], a[40:43], v[40:43]
  ds_read_b64_tr_b16 a[244:245], v97 offset:16384
  v_mfma_f32_16x16x32_bf16 v[44:47], a[236:239], a[40:43], v[44:47]
  buffer_load_dwordx4 a[160:163], v4, s[12:15], s27 offen offset:0 sc1
  v_mfma_f32_16x16x32_bf16 v[48:51], a[224:227], a[44:47], v[48:51]
  ds_read_b64_tr_b16 a[246:247], v97 offset:18432
  v_mfma_f32_16x16x32_bf16 v[52:55], a[228:231], a[44:47], v[52:55]
  buffer_load_dword v11, v22, s[12:15], s63 offen offset:64 sc1
  v_mfma_f32_16x16x32_bf16 v[56:59], a[232:235], a[44:47], v[56:59]
  ds_read_b64_tr_b16 a[248:249], v98 offset:16384
  v_mfma_f32_16x16x32_bf16 v[60:63], a[236:239], a[44:47], v[60:63]
  buffer_load_dwordx4 a[164:167], v4, s[12:15], s27 offen offset:1024 sc1
  v_mfma_f32_16x16x32_bf16 v[64:67], a[224:227], a[48:51], v[64:67]
  ds_read_b64_tr_b16 a[250:251], v98 offset:18432
  v_mfma_f32_16x16x32_bf16 v[68:71], a[228:231], a[48:51], v[68:71]
  ds_read_b64_tr_b16 a[252:253], v99 offset:16384
  buffer_load_dword v12, v22, s[12:15], s63 offen offset:128 sc1
  v_mfma_f32_16x16x32_bf16 v[72:75], a[232:235], a[48:51], v[72:75]
  ds_read_b64_tr_b16 a[254:255], v99 offset:18432
  v_mfma_f32_16x16x32_bf16 v[76:79], a[236:239], a[48:51], v[76:79]
  buffer_load_dwordx4 a[168:171], v4, s[12:15], s27 offen offset:2048 sc1
  v_mfma_f32_16x16x32_bf16 v[80:83], a[224:227], a[52:55], v[80:83]
  v_mfma_f32_16x16x32_bf16 v[84:87], a[228:231], a[52:55], v[84:87]
  buffer_load_dword v13, v22, s[12:15], s63 offen offset:192 sc1
  v_mfma_f32_16x16x32_bf16 v[88:91], a[232:235], a[52:55], v[88:91]
  v_mfma_f32_16x16x32_bf16 v[92:95], a[236:239], a[52:55], v[92:95]
  buffer_load_dwordx4 a[172:175], v4, s[12:15], s27 offen offset:3072 sc1
  v_mfma_f32_16x16x32_bf16 v[108:111], a[224:227], a[56:59], v[108:111]
  v_mfma_f32_16x16x32_bf16 v[112:115], a[228:231], a[56:59], v[112:115]
  buffer_load_dword v14, v22, s[12:15], s63 offen offset:256 sc1
  v_mfma_f32_16x16x32_bf16 v[116:119], a[232:235], a[56:59], v[116:119]
  v_mfma_f32_16x16x32_bf16 v[120:123], a[236:239], a[56:59], v[120:123]
  buffer_load_dwordx4 a[176:179], v4, s[12:15], s28 offen offset:0 sc1
  s_waitcnt vmcnt(21) lgkmcnt(0)
  v_mfma_f32_16x16x32_bf16 v[32:35], a[240:243], a[60:63], v[32:35]
  ds_read_b64_tr_b16 a[224:225], v96 offset:20480
  v_mfma_f32_16x16x32_bf16 v[36:39], a[244:247], a[60:63], v[36:39]
  ds_read_b64_tr_b16 a[226:227], v96 offset:22528
  v_mfma_f32_16x16x32_bf16 v[40:43], a[248:251], a[60:63], v[40:43]
  ds_read_b64_tr_b16 a[228:229], v97 offset:20480
  v_mfma_f32_16x16x32_bf16 v[44:47], a[252:255], a[60:63], v[44:47]
  buffer_load_dwordx4 a[180:183], v5, s[12:15], s27 offen offset:0 sc1
  v_mfma_f32_16x16x32_bf16 v[48:51], a[240:243], a[64:67], v[48:51]
  ds_read_b64_tr_b16 a[230:231], v97 offset:22528
  v_mfma_f32_16x16x32_bf16 v[52:55], a[244:247], a[64:67], v[52:55]
  v_mfma_f32_16x16x32_bf16 v[56:59], a[248:251], a[64:67], v[56:59]
  ds_read_b64_tr_b16 a[232:233], v98 offset:20480
  v_mfma_f32_16x16x32_bf16 v[60:63], a[252:255], a[64:67], v[60:63]
  buffer_load_dwordx4 a[184:187], v5, s[12:15], s27 offen offset:1024 sc1
  v_mfma_f32_16x16x32_bf16 v[64:67], a[240:243], a[68:71], v[64:67]
  ds_read_b64_tr_b16 a[234:235], v98 offset:22528
  v_mfma_f32_16x16x32_bf16 v[68:71], a[244:247], a[68:71], v[68:71]
  ds_read_b64_tr_b16 a[236:237], v99 offset:20480
  v_mfma_f32_16x16x32_bf16 v[72:75], a[248:251], a[68:71], v[72:75]
  ds_read_b64_tr_b16 a[238:239], v99 offset:22528
  v_mfma_f32_16x16x32_bf16 v[76:79], a[252:255], a[68:71], v[76:79]
  buffer_load_dwordx4 a[188:191], v5, s[12:15], s27 offen offset:2048 sc1
  v_mfma_f32_16x16x32_bf16 v[80:83], a[240:243], a[72:75], v[80:83]
  v_mfma_f32_16x16x32_bf16 v[84:87], a[244:247], a[72:75], v[84:87]
  v_mfma_f32_16x16x32_bf16 v[88:91], a[248:251], a[72:75], v[88:91]
  v_mfma_f32_16x16x32_bf16 v[92:95], a[252:255], a[72:75], v[92:95]
  buffer_load_dwordx4 a[192:195], v5, s[12:15], s27 offen offset:3072 sc1
  v_mfma_f32_16x16x32_bf16 v[108:111], a[240:243], a[76:79], v[108:111]
  v_mfma_f32_16x16x32_bf16 v[112:115], a[244:247], a[76:79], v[112:115]
  v_mfma_f32_16x16x32_bf16 v[116:119], a[248:251], a[76:79], v[116:119]
  v_mfma_f32_16x16x32_bf16 v[120:123], a[252:255], a[76:79], v[120:123]
  buffer_load_dwordx4 a[196:199], v5, s[12:15], s28 offen offset:0 sc1
  s_waitcnt vmcnt(20) lgkmcnt(0)
  v_mfma_f32_16x16x32_bf16 v[32:35], a[224:227], a[0:3], v[32:35]
  ds_read_b64_tr_b16 a[240:241], v96 offset:24576
  v_mfma_f32_16x16x32_bf16 v[36:39], a[228:231], a[0:3], v[36:39]
  ds_read_b64_tr_b16 a[242:243], v96 offset:26624
  v_mfma_f32_16x16x32_bf16 v[40:43], a[232:235], a[0:3], v[40:43]
  ds_read_b64_tr_b16 a[244:245], v97 offset:24576
  v_mfma_f32_16x16x32_bf16 v[44:47], a[236:239], a[0:3], v[44:47]
  buffer_load_dwordx4 a[200:203], v6, s[12:15], s27 offen offset:0 sc1
  v_mfma_f32_16x16x32_bf16 v[48:51], a[224:227], a[4:7], v[48:51]
  ds_read_b64_tr_b16 a[246:247], v97 offset:26624
  v_mfma_f32_16x16x32_bf16 v[52:55], a[228:231], a[4:7], v[52:55]
  v_mfma_f32_16x16x32_bf16 v[56:59], a[232:235], a[4:7], v[56:59]
  ds_read_b64_tr_b16 a[248:249], v98 offset:24576
  v_mfma_f32_16x16x32_bf16 v[60:63], a[236:239], a[4:7], v[60:63]
  buffer_load_dwordx4 a[204:207], v6, s[12:15], s27 offen offset:1024 sc1
  v_mfma_f32_16x16x32_bf16 v[64:67], a[224:227], a[8:11], v[64:67]
  ds_read_b64_tr_b16 a[250:251], v98 offset:26624
  v_mfma_f32_16x16x32_bf16 v[68:71], a[228:231], a[8:11], v[68:71]
  ds_read_b64_tr_b16 a[252:253], v99 offset:24576
  v_mfma_f32_16x16x32_bf16 v[72:75], a[232:235], a[8:11], v[72:75]
  ds_read_b64_tr_b16 a[254:255], v99 offset:26624
  v_mfma_f32_16x16x32_bf16 v[76:79], a[236:239], a[8:11], v[76:79]
  buffer_load_dwordx4 a[208:211], v6, s[12:15], s27 offen offset:2048 sc1
  v_mfma_f32_16x16x32_bf16 v[80:83], a[224:227], a[12:15], v[80:83]
  v_mfma_f32_16x16x32_bf16 v[84:87], a[228:231], a[12:15], v[84:87]
  v_mfma_f32_16x16x32_bf16 v[88:91], a[232:235], a[12:15], v[88:91]
  v_mfma_f32_16x16x32_bf16 v[92:95], a[236:239], a[12:15], v[92:95]
  buffer_load_dwordx4 a[212:215], v6, s[12:15], s27 offen offset:3072 sc1
  v_mfma_f32_16x16x32_bf16 v[108:111], a[224:227], a[16:19], v[108:111]
  v_mfma_f32_16x16x32_bf16 v[112:115], a[228:231], a[16:19], v[112:115]
  v_mfma_f32_16x16x32_bf16 v[116:119], a[232:235], a[16:19], v[116:119]
  v_mfma_f32_16x16x32_bf16 v[120:123], a[236:239], a[16:19], v[120:123]
  buffer_load_dwordx4 a[216:219], v6, s[12:15], s28 offen offset:0 sc1
  s_waitcnt vmcnt(11) lgkmcnt(0)
  v_mfma_f32_16x16x32_bf16 v[32:35], a[240:243], a[20:23], v[32:35]
  v_mfma_f32_16x16x32_bf16 v[36:39], a[244:247], a[20:23], v[36:39]
  v_sub_f32 v16, 1.0, v10
  v_mfma_f32_16x16x32_bf16 v[40:43], a[248:251], a[20:23], v[40:43]
  v_mfma_f32_16x16x32_bf16 v[44:47], a[252:255], a[20:23], v[44:47]
  buffer_load_dwordx4 a[220:223], v7, s[12:15], s27 offen offset:0 sc1
  v_mfma_f32_16x16x32_bf16 v[48:51], a[240:243], a[24:27], v[48:51]
  v_mfma_f32_16x16x32_bf16 v[52:55], a[244:247], a[24:27], v[52:55]
  v_sub_f32 v17, 1.0, v11
  v_mfma_f32_16x16x32_bf16 v[56:59], a[248:251], a[24:27], v[56:59]
  v_mfma_f32_16x16x32_bf16 v[60:63], a[252:255], a[24:27], v[60:63]
  buffer_load_dwordx4 a[40:43], v7, s[12:15], s27 offen offset:1024 sc1
  v_mfma_f32_16x16x32_bf16 v[64:67], a[240:243], a[28:31], v[64:67]
  v_mfma_f32_16x16x32_bf16 v[68:71], a[244:247], a[28:31], v[68:71]
  v_sub_f32 v18, 1.0, v12
  v_mfma_f32_16x16x32_bf16 v[72:75], a[248:251], a[28:31], v[72:75]
  v_mfma_f32_16x16x32_bf16 v[76:79], a[252:255], a[28:31], v[76:79]
  buffer_load_dwordx4 a[44:47], v7, s[12:15], s27 offen offset:2048 sc1
  v_mfma_f32_16x16x32_bf16 v[80:83], a[240:243], a[32:35], v[80:83]
  v_mfma_f32_16x16x32_bf16 v[84:87], a[244:247], a[32:35], v[84:87]
  v_sub_f32 v19, 1.0, v13
  v_mfma_f32_16x16x32_bf16 v[88:91], a[248:251], a[32:35], v[88:91]
  v_mfma_f32_16x16x32_bf16 v[92:95], a[252:255], a[32:35], v[92:95]
  buffer_load_dwordx4 a[48:51], v7, s[12:15], s27 offen offset:3072 sc1
  v_mfma_f32_16x16x32_bf16 v[108:111], a[240:243], a[36:39], v[108:111]
  v_mfma_f32_16x16x32_bf16 v[112:115], a[244:247], a[36:39], v[112:115]
  v_sub_f32 v20, 1.0, v14
  v_mfma_f32_16x16x32_bf16 v[116:119], a[248:251], a[36:39], v[116:119]
  v_mfma_f32_16x16x32_bf16 v[120:123], a[252:255], a[36:39], v[120:123]
  buffer_load_dwordx4 a[52:55], v7, s[12:15], s28 offen offset:0 sc1
  s_waitcnt vmcnt(15) lgkmcnt(0)
  v_mfma_f32_16x16x32_bf16 v[140:143], a[80:83], a[160:163], 0
  buffer_load_dwordx4 a[56:59], v8, s[12:15], s27 offen offset:0 sc1
  v_mfma_f32_16x16x32_bf16 v[144:147], a[84:87], a[160:163], 0
  v_mfma_f32_16x16x32_bf16 v[148:151], a[88:91], a[160:163], 0
  buffer_load_dwordx4 a[60:63], v8, s[12:15], s27 offen offset:1024 sc1
  v_mfma_f32_16x16x32_bf16 v[152:155], a[92:95], a[160:163], 0
  v_mfma_f32_16x16x32_bf16 v[140:143], a[96:99], a[164:167], v[140:143]
  buffer_load_dwordx4 a[64:67], v8, s[12:15], s27 offen offset:2048 sc1
  v_mul_f32 v32, v16, v32
  v_mfma_f32_16x16x32_bf16 v[144:147], a[100:103], a[164:167], v[144:147]
  v_mul_f32 v33, v16, v33
  v_mfma_f32_16x16x32_bf16 v[148:151], a[104:107], a[164:167], v[148:151]
  buffer_load_dwordx4 a[68:71], v8, s[12:15], s27 offen offset:3072 sc1
  v_mul_f32 v34, v16, v34
  v_mfma_f32_16x16x32_bf16 v[152:155], a[108:111], a[164:167], v[152:155]
  v_mul_f32 v35, v16, v35
  v_mfma_f32_16x16x32_bf16 v[140:143], a[112:115], a[168:171], v[140:143]
  buffer_load_dwordx4 a[72:75], v8, s[12:15], s28 offen offset:0 sc1
  v_mul_f32 v36, v16, v36
  v_mfma_f32_16x16x32_bf16 v[144:147], a[116:119], a[168:171], v[144:147]
  v_mul_f32 v37, v16, v37
  v_mfma_f32_16x16x32_bf16 v[148:151], a[120:123], a[168:171], v[148:151]
  v_mul_f32 v38, v16, v38
  v_mfma_f32_16x16x32_bf16 v[152:155], a[124:127], a[168:171], v[152:155]
  v_mul_f32 v39, v16, v39
  v_mfma_f32_16x16x32_bf16 v[140:143], a[128:131], a[172:175], v[140:143]
  v_mul_f32 v40, v16, v40
  v_mfma_f32_16x16x32_bf16 v[144:147], a[132:135], a[172:175], v[144:147]
  v_mul_f32 v41, v16, v41
  v_mfma_f32_16x16x32_bf16 v[148:151], a[136:139], a[172:175], v[148:151]
  v_mul_f32 v42, v16, v42
  v_mfma_f32_16x16x32_bf16 v[152:155], a[140:143], a[172:175], v[152:155]
  v_mul_f32 v43, v16, v43
  v_mfma_f32_16x16x32_bf16 v[140:143], a[144:147], a[176:179], v[140:143]
  v_mul_f32 v44, v16, v44
  v_mfma_f32_16x16x32_bf16 v[144:147], a[148:151], a[176:179], v[144:147]
  v_mul_f32 v45, v16, v45
  v_mfma_f32_16x16x32_bf16 v[148:151], a[152:155], a[176:179], v[148:151]
  v_mul_f32 v46, v16, v46
  v_mfma_f32_16x16x32_bf16 v[152:155], a[156:159], a[176:179], v[152:155]
  v_mul_f32 v47, v16, v47
  s_waitcnt vmcnt(15)
  v_mfma_f32_16x16x32_bf16 v[156:159], a[80:83], a[180:183], 0
  v_mul_f32 v48, v17, v48
  v_mul_f32 v49, v17, v49
  v_mfma_f32_16x16x32_bf16 v[160:163], a[84:87], a[180:183], 0
  v_mul_f32 v50, v17, v50
  v_mul_f32 v51, v17, v51
  v_mfma_f32_16x16x32_bf16 v[164:167], a[88:91], a[180:183], 0
  v_mul_f32 v52, v17, v52
  v_mul_f32 v53, v17, v53
  v_mfma_f32_16x16x32_bf16 v[168:171], a[92:95], a[180:183], 0
  v_fmac_f32 v32, v10, v140
  v_fmac_f32 v33, v10, v141
  v_mfma_f32_16x16x32_bf16 v[156:159], a[96:99], a[184:187], v[156:159]
  v_fmac_f32 v34, v10, v142
  v_fmac_f32 v35, v10, v143
  v_mfma_f32_16x16x32_bf16 v[160:163], a[100:103], a[184:187], v[160:163]
  ds_write_b128 v172, v[32:35] offset:0
  v_fmac_f32 v36, v10, v144
  v_mfma_f32_16x16x32_bf16 v[164:167], a[104:107], a[184:187], v[164:167]
  v_fmac_f32 v37, v10, v145
  v_fmac_f32 v38, v10, v146
  v_mfma_f32_16x16x32_bf16 v[168:171], a[108:111], a[184:187], v[168:171]
  v_fmac_f32 v39, v10, v147
  v_mfma_f32_16x16x32_bf16 v[156:159], a[112:115], a[188:191], v[156:159]
  ds_write_b128 v173, v[36:39] offset:0
  v_fmac_f32 v40, v10, v148
  v_mfma_f32_16x16x32_bf16 v[160:163], a[116:119], a[188:191], v[160:163]
  v_fmac_f32 v41, v10, v149
  v_fmac_f32 v42, v10, v150
  v_mfma_f32_16x16x32_bf16 v[164:167], a[120:123], a[188:191], v[164:167]
  v_fmac_f32 v43, v10, v151
  ds_write_b128 v174, v[40:43] offset:0
  v_mfma_f32_16x16x32_bf16 v[168:171], a[124:127], a[188:191], v[168:171]
  v_fmac_f32 v44, v10, v152
  v_mfma_f32_16x16x32_bf16 v[156:159], a[128:131], a[192:195], v[156:159]
  v_fmac_f32 v45, v10, v153
  v_fmac_f32 v46, v10, v154
  v_mfma_f32_16x16x32_bf16 v[160:163], a[132:135], a[192:195], v[160:163]
  v_fmac_f32 v47, v10, v155
  ds_write_b128 v175, v[44:47] offset:0
  v_mfma_f32_16x16x32_bf16 v[164:167], a[136:139], a[192:195], v[164:167]
  v_mul_f32 v54, v17, v54
  v_mul_f32 v55, v17, v55
  v_mfma_f32_16x16x32_bf16 v[168:171], a[140:143], a[192:195], v[168:171]
  v_mul_f32 v56, v17, v56
  v_mfma_f32_16x16x32_bf16 v[156:159], a[144:147], a[196:199], v[156:159]
  v_mul_f32 v57, v17, v57
  v_mul_f32 v58, v17, v58
  v_mfma_f32_16x16x32_bf16 v[160:163], a[148:151], a[196:199], v[160:163]
  v_mul_f32 v59, v17, v59
  v_mul_f32 v60, v17, v60
  v_mfma_f32_16x16x32_bf16 v[164:167], a[152:155], a[196:199], v[164:167]
  v_mul_f32 v61, v17, v61
  v_mul_f32 v62, v17, v62
  v_mfma_f32_16x16x32_bf16 v[168:171], a[156:159], a[196:199], v[168:171]
  v_mul_f32 v63, v17, v63
  s_waitcnt vmcnt(10)
  v_mfma_f32_16x16x32_bf16 v[140:143], a[80:83], a[200:203], 0
  v_mul_f32 v64, v18, v64
  v_mul_f32 v65, v18, v65
  v_mfma_f32_16x16x32_bf16 v[144:147], a[84:87], a[200:203], 0
  v_mul_f32 v66, v18, v66
  v_mul_f32 v67, v18, v67
  v_mfma_f32_16x16x32_bf16 v[148:151], a[88:91], a[200:203], 0
  v_mul_f32 v68, v18, v68
  v_mul_f32 v69, v18, v69
  v_mfma_f32_16x16x32_bf16 v[152:155], a[92:95], a[200:203], 0
  v_fmac_f32 v48, v11, v156
  v_fmac_f32 v49, v11, v157
  v_mfma_f32_16x16x32_bf16 v[140:143], a[96:99], a[204:207], v[140:143]
  v_fmac_f32 v50, v11, v158
  v_fmac_f32 v51, v11, v159
  v_mfma_f32_16x16x32_bf16 v[144:147], a[100:103], a[204:207], v[144:147]
  ds_write_b128 v172, v[48:51] offset:4096
  v_fmac_f32 v52, v11, v160
  v_mfma_f32_16x16x32_bf16 v[148:151], a[104:107], a[204:207], v[148:151]
  v_fmac_f32 v53, v11, v161
  v_fmac_f32 v54, v11, v162
  v_mfma_f32_16x16x32_bf16 v[152:155], a[108:111], a[204:207], v[152:155]
  v_fmac_f32 v55, v11, v163
  v_mfma_f32_16x16x32_bf16 v[140:143], a[112:115], a[208:211], v[140:143]
  ds_write_b128 v173, v[52:55] offset:4096
  v_fmac_f32 v56, v11, v164
  v_mfma_f32_16x16x32_bf16 v[144:147], a[116:119], a[208:211], v[144:147]
  v_fmac_f32 v57, v11, v165
  v_fmac_f32 v58, v11, v166
  v_mfma_f32_16x16x32_bf16 v[148:151], a[120:123], a[208:211], v[148:151]
  v_fmac_f32 v59, v11, v167
  ds_write_b128 v174, v[56:59] offset:4096
  v_mfma_f32_16x16x32_bf16 v[152:155], a[124:127], a[208:211], v[152:155]
  v_fmac_f32 v60, v11, v168
  v_mfma_f32_16x16x32_bf16 v[140:143], a[128:131], a[212:215], v[140:143]
  v_fmac_f32 v61, v11, v169
  v_fmac_f32 v62, v11, v170
  v_mfma_f32_16x16x32_bf16 v[144:147], a[132:135], a[212:215], v[144:147]
  v_fmac_f32 v63, v11, v171
  ds_write_b128 v175, v[60:63] offset:4096
  v_mfma_f32_16x16x32_bf16 v[148:151], a[136:139], a[212:215], v[148:151]
  v_mul_f32 v70, v18, v70
  v_mul_f32 v71, v18, v71
  v_mfma_f32_16x16x32_bf16 v[152:155], a[140:143], a[212:215], v[152:155]
  v_mul_f32 v72, v18, v72
  v_mfma_f32_16x16x32_bf16 v[140:143], a[144:147], a[216:219], v[140:143]
  v_mul_f32 v73, v18, v73
  v_mul_f32 v74, v18, v74
  v_mfma_f32_16x16x32_bf16 v[144:147], a[148:151], a[216:219], v[144:147]
  v_mul_f32 v75, v18, v75
  v_mul_f32 v76, v18, v76
  v_mfma_f32_16x16x32_bf16 v[148:151], a[152:155], a[216:219], v[148:151]
  v_mul_f32 v77, v18, v77
  v_mul_f32 v78, v18, v78
  v_mfma_f32_16x16x32_bf16 v[152:155], a[156:159], a[216:219], v[152:155]
  v_mul_f32 v79, v18, v79
  s_waitcnt vmcnt(5)
  v_mfma_f32_16x16x32_bf16 v[156:159], a[80:83], a[220:223], 0
  v_mul_f32 v80, v19, v80
  v_mul_f32 v81, v19, v81
  v_mfma_f32_16x16x32_bf16 v[160:163], a[84:87], a[220:223], 0
  v_mul_f32 v82, v19, v82
  v_mul_f32 v83, v19, v83
  v_mfma_f32_16x16x32_bf16 v[164:167], a[88:91], a[220:223], 0
  v_mul_f32 v84, v19, v84
  v_mul_f32 v85, v19, v85
  v_mfma_f32_16x16x32_bf16 v[168:171], a[92:95], a[220:223], 0
  v_fmac_f32 v64, v12, v140
  v_fmac_f32 v65, v12, v141
  v_mfma_f32_16x16x32_bf16 v[156:159], a[96:99], a[40:43], v[156:159]
  v_fmac_f32 v66, v12, v142
  v_fmac_f32 v67, v12, v143
  v_mfma_f32_16x16x32_bf16 v[160:163], a[100:103], a[40:43], v[160:163]
  ds_write_b128 v172, v[64:67] offset:8192
  v_fmac_f32 v68, v12, v144
  v_mfma_f32_16x16x32_bf16 v[164:167], a[104:107], a[40:43], v[164:167]
  v_fmac_f32 v69, v12, v145
  v_fmac_f32 v70, v12, v146
  v_mfma_f32_16x16x32_bf16 v[168:171], a[108:111], a[40:43], v[168:171]
  v_fmac_f32 v71, v12, v147
  v_mfma_f32_16x16x32_bf16 v[156:159], a[112:115], a[44:47], v[156:159]
  ds_write_b128 v173, v[68:71] offset:8192
  v_fmac_f32 v72, v12, v148
  v_mfma_f32_16x16x32_bf16 v[160:163], a[116:119], a[44:47], v[160:163]
  v_fmac_f32 v73, v12, v149
  v_fmac_f32 v74, v12, v150
  v_mfma_f32_16x16x32_bf16 v[164:167], a[120:123], a[44:47], v[164:167]
  v_fmac_f32 v75, v12, v151
  ds_write_b128 v174, v[72:75] offset:8192
  v_mfma_f32_16x16x32_bf16 v[168:171], a[124:127], a[44:47], v[168:171]
  v_fmac_f32 v76, v12, v152
  v_mfma_f32_16x16x32_bf16 v[156:159], a[128:131], a[48:51], v[156:159]
  v_fmac_f32 v77, v12, v153
  v_fmac_f32 v78, v12, v154
  v_mfma_f32_16x16x32_bf16 v[160:163], a[132:135], a[48:51], v[160:163]
  v_fmac_f32 v79, v12, v155
  ds_write_b128 v175, v[76:79] offset:8192
  v_mfma_f32_16x16x32_bf16 v[164:167], a[136:139], a[48:51], v[164:167]
  v_mul_f32 v86, v19, v86
  v_mul_f32 v87, v19, v87
  v_mfma_f32_16x16x32_bf16 v[168:171], a[140:143], a[48:51], v[168:171]
  v_mul_f32 v88, v19, v88
  v_mfma_f32_16x16x32_bf16 v[156:159], a[144:147], a[52:55], v[156:159]
  v_mul_f32 v89, v19, v89
  v_mul_f32 v90, v19, v90
  v_mfma_f32_16x16x32_bf16 v[160:163], a[148:151], a[52:55], v[160:163]
  v_mul_f32 v91, v19, v91
  v_mul_f32 v92, v19, v92
  v_mfma_f32_16x16x32_bf16 v[164:167], a[152:155], a[52:55], v[164:167]
  v_mul_f32 v93, v19, v93
  v_mul_f32 v94, v19, v94
  v_mfma_f32_16x16x32_bf16 v[168:171], a[156:159], a[52:55], v[168:171]
  v_mul_f32 v95, v19, v95
  s_waitcnt vmcnt(0)
  v_mfma_f32_16x16x32_bf16 v[140:143], a[80:83], a[56:59], 0
  v_mul_f32 v108, v20, v108
  v_mul_f32 v109, v20, v109
  v_mfma_f32_16x16x32_bf16 v[144:147], a[84:87], a[56:59], 0
  v_mul_f32 v110, v20, v110
  v_mul_f32 v111, v20, v111
  v_mfma_f32_16x16x32_bf16 v[148:151], a[88:91], a[56:59], 0
  v_mul_f32 v112, v20, v112
  v_mul_f32 v113, v20, v113
  v_mfma_f32_16x16x32_bf16 v[152:155], a[92:95], a[56:59], 0
  v_fmac_f32 v80, v13, v156
  v_fmac_f32 v81, v13, v157
  v_mfma_f32_16x16x32_bf16 v[140:143], a[96:99], a[60:63], v[140:143]
  v_fmac_f32 v82, v13, v158
  v_fmac_f32 v83, v13, v159
  v_mfma_f32_16x16x32_bf16 v[144:147], a[100:103], a[60:63], v[144:147]
  ds_write_b128 v172, v[80:83] offset:12288
  v_fmac_f32 v84, v13, v160
  v_mfma_f32_16x16x32_bf16 v[148:151], a[104:107], a[60:63], v[148:151]
  v_fmac_f32 v85, v13, v161
  v_fmac_f32 v86, v13, v162
  v_mfma_f32_16x16x32_bf16 v[152:155], a[108:111], a[60:63], v[152:155]
  v_fmac_f32 v87, v13, v163
  v_mfma_f32_16x16x32_bf16 v[140:143], a[112:115], a[64:67], v[140:143]
  ds_write_b128 v173, v[84:87] offset:12288
  v_fmac_f32 v88, v13, v164
  v_mfma_f32_16x16x32_bf16 v[144:147], a[116:119], a[64:67], v[144:147]
  v_fmac_f32 v89, v13, v165
  v_fmac_f32 v90, v13, v166
  v_mfma_f32_16x16x32_bf16 v[148:151], a[120:123], a[64:67], v[148:151]
  v_fmac_f32 v91, v13, v167
  ds_write_b128 v174, v[88:91] offset:12288
  v_mfma_f32_16x16x32_bf16 v[152:155], a[124:127], a[64:67], v[152:155]
  v_fmac_f32 v92, v13, v168
  v_mfma_f32_16x16x32_bf16 v[140:143], a[128:131], a[68:71], v[140:143]
  v_fmac_f32 v93, v13, v169
  v_fmac_f32 v94, v13, v170
  v_mfma_f32_16x16x32_bf16 v[144:147], a[132:135], a[68:71], v[144:147]
  v_fmac_f32 v95, v13, v171
  ds_write_b128 v175, v[92:95] offset:12288
  v_mfma_f32_16x16x32_bf16 v[148:151], a[136:139], a[68:71], v[148:151]
  v_mul_f32 v114, v20, v114
  v_mul_f32 v115, v20, v115
  v_mfma_f32_16x16x32_bf16 v[152:155], a[140:143], a[68:71], v[152:155]
  v_mul_f32 v116, v20, v116
  v_mfma_f32_16x16x32_bf16 v[140:143], a[144:147], a[72:75], v[140:143]
  v_mul_f32 v117, v20, v117
  v_mul_f32 v118, v20, v118
  v_mfma_f32_16x16x32_bf16 v[144:147], a[148:151], a[72:75], v[144:147]
  v_mul_f32 v119, v20, v119
  v_mul_f32 v120, v20, v120
  v_mfma_f32_16x16x32_bf16 v[148:151], a[152:155], a[72:75], v[148:151]
  v_mul_f32 v121, v20, v121
  v_mul_f32 v122, v20, v122
  v_mfma_f32_16x16x32_bf16 v[152:155], a[156:159], a[72:75], v[152:155]
  v_mul_f32 v123, v20, v123
  v_fmac_f32 v108, v14, v140
  v_fmac_f32 v109, v14, v141
  v_fmac_f32 v110, v14, v142
  v_fmac_f32 v111, v14, v143
  ds_write_b128 v172, v[108:111] offset:16384
  v_fmac_f32 v112, v14, v144
  v_fmac_f32 v113, v14, v145
  v_fmac_f32 v114, v14, v146
  v_fmac_f32 v115, v14, v147
  ds_write_b128 v173, v[112:115] offset:16384
  v_fmac_f32 v116, v14, v148
  v_fmac_f32 v117, v14, v149
  v_fmac_f32 v118, v14, v150
  v_fmac_f32 v119, v14, v151
  ds_write_b128 v174, v[116:119] offset:16384
  v_fmac_f32 v120, v14, v152
  v_fmac_f32 v121, v14, v153
  v_fmac_f32 v122, v14, v154
  v_fmac_f32 v123, v14, v155
  ds_write_b128 v175, v[120:123] offset:16384
  s_waitcnt lgkmcnt(0)
  s_barrier
  ds_read_b128 v[184:187], v176 offset:0
  ds_read_b128 v[188:191], v177 offset:0
  ds_read_b128 v[192:195], v176 offset:40960
  ds_read_b128 v[196:199], v177 offset:40960
  ds_read_b128 v[200:203], v178 offset:0
  ds_read_b128 v[204:207], v179 offset:0
  ds_read_b128 v[208:211], v178 offset:40960
  ds_read_b128 v[212:215], v179 offset:40960
  ds_read_b128 v[216:219], v176 offset:8192
  ds_read_b128 v[220:223], v177 offset:8192
  ds_read_b128 v[224:227], v176 offset:49152
  ds_read_b128 v[228:231], v177 offset:49152
  ds_read_b128 v[232:235], v178 offset:8192
  ds_read_b128 v[236:239], v179 offset:8192
  ds_read_b128 v[240:243], v178 offset:49152
  ds_read_b128 v[244:247], v179 offset:49152
  s_waitcnt lgkmcnt(8)
  v_pk_add_f32 v[184:185], v[184:185], v[192:193]
  v_pk_add_f32 v[200:201], v[200:201], v[208:209]
  v_pk_add_f32 v[186:187], v[186:187], v[194:195]
  v_pk_add_f32 v[202:203], v[202:203], v[210:211]
  v_pk_add_f32 v[188:189], v[188:189], v[196:197]
  v_pk_add_f32 v[204:205], v[204:205], v[212:213]
  v_pk_add_f32 v[190:191], v[190:191], v[198:199]
  v_pk_add_f32 v[206:207], v[206:207], v[214:215]
  v_pk_add_f32 v[184:185], v[184:185], v[200:201]
  v_pk_add_f32 v[186:187], v[186:187], v[202:203]
  v_pk_add_f32 v[188:189], v[188:189], v[204:205]
  v_pk_add_f32 v[190:191], v[190:191], v[206:207]
  v_cvt_pk_bf16_f32 v32, v184, v185
  v_cvt_pk_bf16_f32 v33, v186, v187
  v_cvt_pk_bf16_f32 v34, v188, v189
  v_cvt_pk_bf16_f32 v35, v190, v191
  s_mov_b32 s58, 0
  buffer_store_dwordx4 v[32:35], v180, s[72:75], s58 offen sc1 nt
  s_cmp_ge_u32 s20, 2
  s_cbranch_scc1 LfA5
  ds_read_b128 v[184:187], v176 offset:16384
  ds_read_b128 v[188:191], v177 offset:16384
  ds_read_b128 v[192:195], v176 offset:57344
  ds_read_b128 v[196:199], v177 offset:57344
  ds_read_b128 v[200:203], v178 offset:16384
  ds_read_b128 v[204:207], v179 offset:16384
  ds_read_b128 v[208:211], v178 offset:57344
  ds_read_b128 v[212:215], v179 offset:57344
  s_waitcnt lgkmcnt(8)
  v_pk_add_f32 v[216:217], v[216:217], v[224:225]
  v_pk_add_f32 v[232:233], v[232:233], v[240:241]
  v_pk_add_f32 v[218:219], v[218:219], v[226:227]
  v_pk_add_f32 v[234:235], v[234:235], v[242:243]
  v_pk_add_f32 v[220:221], v[220:221], v[228:229]
  v_pk_add_f32 v[236:237], v[236:237], v[244:245]
  v_pk_add_f32 v[222:223], v[222:223], v[230:231]
  v_pk_add_f32 v[238:239], v[238:239], v[246:247]
  v_pk_add_f32 v[216:217], v[216:217], v[232:233]
  v_pk_add_f32 v[218:219], v[218:219], v[234:235]
  v_pk_add_f32 v[220:221], v[220:221], v[236:237]
  v_pk_add_f32 v[222:223], v[222:223], v[238:239]
  v_cvt_pk_bf16_f32 v36, v216, v217
  v_cvt_pk_bf16_f32 v37, v218, v219
  v_cvt_pk_bf16_f32 v38, v220, v221
  v_cvt_pk_bf16_f32 v39, v222, v223
  s_mov_b32 s58, 40960
  buffer_store_dwordx4 v[36:39], v180, s[72:75], s58 offen sc1 nt
  s_waitcnt lgkmcnt(0)
  v_pk_add_f32 v[184:185], v[184:185], v[192:193]
  v_pk_add_f32 v[200:201], v[200:201], v[208:209]
  v_pk_add_f32 v[186:187], v[186:187], v[194:195]
  v_pk_add_f32 v[202:203], v[202:203], v[210:211]
  v_pk_add_f32 v[188:189], v[188:189], v[196:197]
  v_pk_add_f32 v[204:205], v[204:205], v[212:213]
  v_pk_add_f32 v[190:191], v[190:191], v[198:199]
  v_pk_add_f32 v[206:207], v[206:207], v[214:215]
  v_pk_add_f32 v[184:185], v[184:185], v[200:201]
  v_pk_add_f32 v[186:187], v[186:187], v[202:203]
  v_pk_add_f32 v[188:189], v[188:189], v[204:205]
  v_pk_add_f32 v[190:191], v[190:191], v[206:207]
  v_cvt_pk_bf16_f32 v40, v184, v185
  v_cvt_pk_bf16_f32 v41, v186, v187
  v_cvt_pk_bf16_f32 v42, v188, v189
  v_cvt_pk_bf16_f32 v43, v190, v191
  s_mov_b32 s58, 81920
  buffer_store_dwordx4 v[40:43], v180, s[72:75], s58 offen sc1 nt
  s_branch Lfin
LfA5:
  s_waitcnt lgkmcnt(0)
  v_pk_add_f32 v[216:217], v[216:217], v[224:225]
  v_pk_add_f32 v[232:233], v[232:233], v[240:241]
  v_pk_add_f32 v[218:219], v[218:219], v[226:227]
  v_pk_add_f32 v[234:235], v[234:235], v[242:243]
  v_pk_add_f32 v[220:221], v[220:221], v[228:229]
  v_pk_add_f32 v[236:237], v[236:237], v[244:245]
  v_pk_add_f32 v[222:223], v[222:223], v[230:231]
  v_pk_add_f32 v[238:239], v[238:239], v[246:247]
  v_pk_add_f32 v[216:217], v[216:217], v[232:233]
  v_pk_add_f32 v[218:219], v[218:219], v[234:235]
  v_pk_add_f32 v[220:221], v[220:221], v[236:237]
  v_pk_add_f32 v[222:223], v[222:223], v[238:239]
  v_cvt_pk_bf16_f32 v36, v216, v217
  v_cvt_pk_bf16_f32 v37, v218, v219
  v_cvt_pk_bf16_f32 v38, v220, v221
  v_cvt_pk_bf16_f32 v39, v222, v223
  s_mov_b32 s58, 40960
  buffer_store_dwordx4 v[36:39], v180, s[72:75], s58 offen sc1 nt
  s_branch Lfin
LvA4:
  s_waitcnt vmcnt(15)
  v_mfma_f32_16x16x32_bf16 v[32:35], a[80:83], a[0:3], 0
  v_mfma_f32_16x16x32_bf16 v[36:39], a[84:87], a[0:3], 0
  v_mfma_f32_16x16x32_bf16 v[40:43], a[88:91], a[0:3], 0
  v_mfma_f32_16x16x32_bf16 v[44:47], a[92:95], a[0:3], 0
  buffer_load_dwordx4 a[0:3], v4, s[4:7], s24 offen sc1
  v_mfma_f32_16x16x32_bf16 v[48:51], a[80:83], a[4:7], 0
  v_mfma_f32_16x16x32_bf16 v[52:55], a[84:87], a[4:7], 0
  v_mfma_f32_16x16x32_bf16 v[56:59], a[88:91], a[4:7], 0
  v_mfma_f32_16x16x32_bf16 v[60:63], a[92:95], a[4:7], 0
  buffer_load_dwordx4 a[4:7], v5, s[4:7], s24 offen sc1
  v_mfma_f32_16x16x32_bf16 v[64:67], a[80:83], a[8:11], 0
  v_mfma_f32_16x16x32_bf16 v[68:71], a[84:87], a[8:11], 0
  v_mfma_f32_16x16x32_bf16 v[72:75], a[88:91], a[8:11], 0
  v_mfma_f32_16x16x32_bf16 v[76:79], a[92:95], a[8:11], 0
  buffer_load_dwordx4 a[8:11], v6, s[4:7], s24 offen sc1
  v_mfma_f32_16x16x32_bf16 v[80:83], a[80:83], a[12:15], 0
  v_mfma_f32_16x16x32_bf16 v[84:87], a[84:87], a[12:15], 0
  v_mfma_f32_16x16x32_bf16 v[88:91], a[88:91], a[12:15], 0
  v_mfma_f32_16x16x32_bf16 v[92:95], a[92:95], a[12:15], 0
  buffer_load_dwordx4 a[12:15], v7, s[4:7], s24 offen sc1
  s_waitcnt vmcnt(14)
  v_mfma_f32_16x16x32_bf16 v[32:35], a[96:99], a[20:23], v[32:35]
  s_add_u32 s24, s24, 1024
  v_mfma_f32_16x16x32_bf16 v[36:39], a[100:103], a[20:23], v[36:39]
  v_mfma_f32_16x16x32_bf16 v[40:43], a[104:107], a[20:23], v[40:43]
  s_cmp_eq_u32 s24, s19
  s_cselect_b32 s24, s18, s24
  s_cselect_b32 s6, s68, s14
  v_mfma_f32_16x16x32_bf16 v[44:47], a[108:111], a[20:23], v[44:47]
  buffer_load_dwordx4 a[20:23], v4, s[4:7], s24 offen sc1
  v_mfma_f32_16x16x32_bf16 v[48:51], a[96:99], a[24:27], v[48:51]
  v_mfma_f32_16x16x32_bf16 v[52:55], a[100:103], a[24:27], v[52:55]
  v_mfma_f32_16x16x32_bf16 v[56:59], a[104:107], a[24:27], v[56:59]
  v_mfma_f32_16x16x32_bf16 v[60:63], a[108:111], a[24:27], v[60:63]
  buffer_load_dwordx4 a[24:27], v5, s[4:7], s24 offen sc1
  v_mfma_f32_16x16x32_bf16 v[64:67], a[96:99], a[28:31], v[64:67]
  v_mfma_f32_16x16x32_bf16 v[68:71], a[100:103], a[28:31], v[68:71]
  v_mfma_f32_16x16x32_bf16 v[72:75], a[104:107], a[28:31], v[72:75]
  v_mfma_f32_16x16x32_bf16 v[76:79], a[108:111], a[28:31], v[76:79]
  buffer_load_dwordx4 a[28:31], v6, s[4:7], s24 offen sc1
  v_mfma_f32_16x16x32_bf16 v[80:83], a[96:99], a[32:35], v[80:83]
  v_mfma_f32_16x16x32_bf16 v[84:87], a[100:103], a[32:35], v[84:87]
  v_mfma_f32_16x16x32_bf16 v[88:91], a[104:107], a[32:35], v[88:91]
  v_mfma_f32_16x16x32_bf16 v[92:95], a[108:111], a[32:35], v[92:95]
  buffer_load_dwordx4 a[32:35], v7, s[4:7], s24 offen sc1
  s_waitcnt vmcnt(13)
  s_waitcnt vmcnt(8)
  s_barrier
  s_cmp_lg_u32 s20, 0
  s_cbranch_scc1 LsigA4
  s_mov_b32 exec_lo, 0
  s_mov_b32 exec_hi, 0x10000
  buffer_store_dword v105, v104, s[12:15], 0 offen sc1
  s_mov_b64 exec, -1
LsigA4:
  v_mfma_f32_16x16x32_bf16 v[32:35], a[112:115], a[40:43], v[32:35]
  v_xor_b32 v24, v2, v3
  s_add_u32 s24, s24, 1024
  v_mfma_f32_16x16x32_bf16 v[36:39], a[116:119], a[40:43], v[36:39]
  v_lshlrev_b32 v24, 4, v24
  v_mfma_f32_16x16x32_bf16 v[40:43], a[120:123], a[40:43], v[40:43]
  v_lshl_add_u32 v24, v3, 8, v24
  s_cmp_eq_u32 s24, s19
  s_cselect_b32 s24, s18, s24
  s_cselect_b32 s6, s68, s14
  v_mfma_f32_16x16x32_bf16 v[44:47], a[124:127], a[40:43], v[44:47]
  buffer_load_dwordx4 a[40:43], v4, s[4:7], s24 offen sc1
  v_mfma_f32_16x16x32_bf16 v[48:51], a[112:115], a[44:47], v[48:51]
  v_add_u32 v172, s33, v24
  v_mfma_f32_16x16x32_bf16 v[52:55], a[116:119], a[44:47], v[52:55]
  v_xor_b32 v173, 64, v172
  v_mfma_f32_16x16x32_bf16 v[56:59], a[120:123], a[44:47], v[56:59]
  v_xor_b32 v174, 128, v172
  v_mfma_f32_16x16x32_bf16 v[60:63], a[124:127], a[44:47], v[60:63]
  buffer_load_dwordx4 a[44:47], v5, s[4:7], s24 offen sc1
  v_mfma_f32_16x16x32_bf16 v[64:67], a[112:115], a[48:51], v[64:67]
  v_xor_b32 v175, 192, v172
  v_mfma_f32_16x16x32_bf16 v[68:71], a[116:119], a[48:51], v[68:71]
  v_bfe_u32 v24, v0, 3, 4
  v_mfma_f32_16x16x32_bf16 v[72:75], a[120:123], a[48:51], v[72:75]
  v_and_b32 v25, 7, v0
  v_mfma_f32_16x16x32_bf16 v[76:79], a[124:127], a[48:51], v[76:79]
  buffer_load_dwordx4 a[48:51], v6, s[4:7], s24 offen sc1
  v_mfma_f32_16x16x32_bf16 v[80:83], a[112:115], a[52:55], v[80:83]
  v_lshlrev_b32 v26, 1, v25
  v_mfma_f32_16x16x32_bf16 v[84:87], a[116:119], a[52:55], v[84:87]
  v_xor_b32 v26, v26, v24
  v_mfma_f32_16x16x32_bf16 v[88:91], a[120:123], a[52:55], v[88:91]
  v_mfma_f32_16x16x32_bf16 v[92:95], a[124:127], a[52:55], v[92:95]
  buffer_load_dwordx4 a[52:55], v7, s[4:7], s24 offen sc1
  s_waitcnt vmcnt(12)
  v_mfma_f32_16x16x32_bf16 v[32:35], a[128:131], a[60:63], v[32:35]
  v_lshlrev_b32 v26, 4, v26
  s_add_u32 s24, s24, 1024
  v_mfma_f32_16x16x32_bf16 v[36:39], a[132:135], a[60:63], v[36:39]
  v_lshl_add_u32 v26, v24, 8, v26
  v_mfma_f32_16x16x32_bf16 v[40:43], a[136:139], a[60:63], v[40:43]
  s_lshr_b32 s59, s20, 1
  s_cmp_eq_u32 s24, s19
  s_cselect_b32 s24, s18, s24
  s_cselect_b32 s6, s68, s14
  v_mfma_f32_16x16x32_bf16 v[44:47], a[140:143], a[60:63], v[44:47]
  buffer_load_dwordx4 a[60:63], v4, s[4:7], s24 offen sc1
  v_mfma_f32_16x16x32_bf16 v[48:51], a[128:131], a[64:67], v[48:51]
  s_lshl_b32 s58, s59, 12
  v_mfma_f32_16x16x32_bf16 v[52:55], a[132:135], a[64:67], v[52:55]
  v_add_u32 v176, s58, v26
  v_mfma_f32_16x16x32_bf16 v[56:59], a[136:139], a[64:67], v[56:59]
  v_xor_b32 v177, 16, v176
  v_mfma_f32_16x16x32_bf16 v[60:63], a[140:143], a[64:67], v[60:63]
  buffer_load_dwordx4 a[64:67], v5, s[4:7], s24 offen sc1
  v_mfma_f32_16x16x32_bf16 v[64:67], a[128:131], a[68:71], v[64:67]
  v_add_u32 v178, 81920, v176
  v_mfma_f32_16x16x32_bf16 v[68:71], a[132:135], a[68:71], v[68:71]
  v_add_u32 v179, 81920, v177
  v_mfma_f32_16x16x32_bf16 v[72:75], a[136:139], a[68:71], v[72:75]
  s_mov_b32 s72, s50
  v_mfma_f32_16x16x32_bf16 v[76:79], a[140:143], a[68:71], v[76:79]
  buffer_load_dwordx4 a[68:71], v6, s[4:7], s24 offen sc1
  v_mfma_f32_16x16x32_bf16 v[80:83], a[128:131], a[72:75], v[80:83]
  s_mov_b32 s73, s51
  v_mfma_f32_16x16x32_bf16 v[84:87], a[132:135], a[72:75], v[84:87]
  s_mov_b32 s74, 2621440
  v_mfma_f32_16x16x32_bf16 v[88:91], a[136:139], a[72:75], v[88:91]
  s_lshl_b32 s23, s23, 7
  v_mfma_f32_16x16x32_bf16 v[92:95], a[140:143], a[72:75], v[92:95]
  buffer_load_dwordx4 a[72:75], v7, s[4:7], s24 offen sc1
  s_waitcnt vmcnt(12)
  v_mfma_f32_16x16x32_bf16 v[32:35], a[144:147], a[0:3], v[32:35]
  v_lshl_add_u32 v25, v25, 4, s23
  s_add_u32 s24, s24, 1024
  v_mfma_f32_16x16x32_bf16 v[36:39], a[148:151], a[0:3], v[36:39]
  v_mul_u32_u24 v24, 2560, v24
  v_mfma_f32_16x16x32_bf16 v[40:43], a[152:155], a[0:3], v[40:43]
  s_add_u32 s58, s59, s21
  s_cmp_eq_u32 s24, s19
  s_cselect_b32 s24, s18, s24
  s_cselect_b32 s6, s68, s14
  v_mfma_f32_16x16x32_bf16 v[44:47], a[156:159], a[0:3], v[44:47]
  buffer_load_dwordx4 a[0:3], v4, s[4:7], s24 offen sc1
  v_mfma_f32_16x16x32_bf16 v[48:51], a[144:147], a[4:7], v[48:51]
  s_and_b32 s59, s58, 1
  v_mfma_f32_16x16x32_bf16 v[52:55], a[148:151], a[4:7], v[52:55]
  s_lshr_b32 s58, s58, 1
  v_mfma_f32_16x16x32_bf16 v[56:59], a[152:155], a[4:7], v[56:59]
  s_lshl_b32 s58, s58, 5
  v_mfma_f32_16x16x32_bf16 v[60:63], a[156:159], a[4:7], v[60:63]
  buffer_load_dwordx4 a[4:7], v5, s[4:7], s24 offen sc1
  v_mfma_f32_16x16x32_bf16 v[64:67], a[144:147], a[8:11], v[64:67]
  s_add_u32 s58, s58, s59
  v_mfma_f32_16x16x32_bf16 v[68:71], a[148:151], a[8:11], v[68:71]
  s_mul_i32 s58, s58, 1280
  v_mfma_f32_16x16x32_bf16 v[72:75], a[152:155], a[8:11], v[72:75]
  v_add3_u32 v180, v24, v25, s58
  v_mfma_f32_16x16x32_bf16 v[76:79], a[156:159], a[8:11], v[76:79]
  buffer_load_dwordx4 a[8:11], v6, s[4:7], s24 offen sc1
  v_mfma_f32_16x16x32_bf16 v[80:83], a[144:147], a[12:15], v[80:83]
  s_lshl_b32 s63, s21, 6
  v_mfma_f32_16x16x32_bf16 v[84:87], a[148:151], a[12:15], v[84:87]
  s_add_u32 s63, s63, 10485760
  v_mfma_f32_16x16x32_bf16 v[88:91], a[152:155], a[12:15], v[88:91]
  v_lshlrev_b32 v22, 2, v3
  v_mfma_f32_16x16x32_bf16 v[92:95], a[156:159], a[12:15], v[92:95]
  buffer_load_dwordx4 a[12:15], v7, s[4:7], s24 offen sc1
  s_waitcnt vmcnt(12)
  v_mfma_f32_16x16x32_bf16 v[32:35], a[160:163], a[20:23], v[32:35]
  ds_read_b64_tr_b16 a[80:81], v96 offset:28672
  s_add_u32 s24, s24, 1024
  v_mfma_f32_16x16x32_bf16 v[36:39], a[164:167], a[20:23], v[36:39]
  ds_read_b64_tr_b16 a[82:83], v96 offset:30720
  v_mfma_f32_16x16x32_bf16 v[40:43], a[168:171], a[20:23], v[40:43]
  ds_read_b64_tr_b16 a[84:85], v97 offset:28672
  s_cmp_eq_u32 s24, s19
  s_cselect_b32 s24, s18, s24
  s_cselect_b32 s6, s68, s14
  v_mfma_f32_16x16x32_bf16 v[44:47], a[172:175], a[20:23], v[44:47]
  buffer_load_dwordx4 a[20:23], v4, s[4:7], s24 offen sc1
  v_mfma_f32_16x16x32_bf16 v[48:51], a[160:163], a[24:27], v[48:51]
  ds_read_b64_tr_b16 a[86:87], v97 offset:30720
  v_mfma_f32_16x16x32_bf16 v[52:55], a[164:167], a[24:27], v[52:55]
  ds_read_b64_tr_b16 a[88:89], v98 offset:28672
  v_mfma_f32_16x16x32_bf16 v[56:59], a[168:171], a[24:27], v[56:59]
  ds_read_b64_tr_b16 a[90:91], v98 offset:30720
  v_mfma_f32_16x16x32_bf16 v[60:63], a[172:175], a[24:27], v[60:63]
  buffer_load_dwordx4 a[24:27], v5, s[4:7], s24 offen sc1
  v_mfma_f32_16x16x32_bf16 v[64:67], a[160:163], a[28:31], v[64:67]
  ds_read_b64_tr_b16 a[92:93], v99 offset:28672
  v_mfma_f32_16x16x32_bf16 v[68:71], a[164:167], a[28:31], v[68:71]
  ds_read_b64_tr_b16 a[94:95], v99 offset:30720
  v_mfma_f32_16x16x32_bf16 v[72:75], a[168:171], a[28:31], v[72:75]
  v_mfma_f32_16x16x32_bf16 v[76:79], a[172:175], a[28:31], v[76:79]
  buffer_load_dwordx4 a[28:31], v6, s[4:7], s24 offen sc1
  v_mfma_f32_16x16x32_bf16 v[80:83], a[160:163], a[32:35], v[80:83]
  v_mfma_f32_16x16x32_bf16 v[84:87], a[164:167], a[32:35], v[84:87]
  v_mfma_f32_16x16x32_bf16 v[88:91], a[168:171], a[32:35], v[88:91]
  v_mfma_f32_16x16x32_bf16 v[92:95], a[172:175], a[32:35], v[92:95]
  buffer_load_dwordx4 a[32:35], v7, s[4:7], s24 offen sc1
  s_waitcnt vmcnt(12)
  v_mfma_f32_16x16x32_bf16 v[32:35], a[176:179], a[40:43], v[32:35]
  ds_read_b64_tr_b16 a[96:97], v96 offset:32768
  s_add_u32 s24, s24, 1024
  v_mfma_f32_16x16x32_bf16 v[36:39], a[180:183], a[40:43], v[36:39]
  ds_read_b64_tr_b16 a[98:99], v96 offset:34816
  v_mfma_f32_16x16x32_bf16 v[40:43], a[184:187], a[40:43], v[40:43]
  ds_read_b64_tr_b16 a[100:101], v97 offset:32768
  s_cmp_eq_u32 s24, s19
  s_cselect_b32 s24, s18, s24
  s_cselect_b32 s6, s68, s14
  v_mfma_f32_16x16x32_bf16 v[44:47], a[188:191], a[40:43], v[44:47]
  buffer_load_dwordx4 a[40:43], v4, s[4:7], s24 offen sc1
  v_mfma_f32_16x16x32_bf16 v[48:51], a[176:179], a[44:47], v[48:51]
  ds_read_b64_tr_b16 a[102:103], v97 offset:34816
  v_mfma_f32_16x16x32_bf16 v[52:55], a[180:183], a[44:47], v[52:55]
  ds_read_b64_tr_b16 a[104:105], v98 offset:32768
  v_mfma_f32_16x16x32_bf16 v[56:59], a[184:187], a[44:47], v[56:59]
  ds_read_b64_tr_b16 a[106:107], v98 offset:34816
  v_mfma_f32_16x16x32_bf16 v[60:63], a[188:191], a[44:47], v[60:63]
  buffer_load_dwordx4 a[44:47], v5, s[4:7], s24 offen sc1
  v_mfma_f32_16x16x32_bf16 v[64:67], a[176:179], a[48:51], v[64:67]
  ds_read_b64_tr_b16 a[108:109], v99 offset:32768
  v_mfma_f32_16x16x32_bf16 v[68:71], a[180:183], a[48:51], v[68:71]
  ds_read_b64_tr_b16 a[110:111], v99 offset:34816
  v_mfma_f32_16x16x32_bf16 v[72:75], a[184:187], a[48:51], v[72:75]
  v_mfma_f32_16x16x32_bf16 v[76:79], a[188:191], a[48:51], v[76:79]
  buffer_load_dwordx4 a[48:51], v6, s[4:7], s24 offen sc1
  v_mfma_f32_16x16x32_bf16 v[80:83], a[176:179], a[52:55], v[80:83]
  v_mfma_f32_16x16x32_bf16 v[84:87], a[180:183], a[52:55], v[84:87]
  v_mfma_f32_16x16x32_bf16 v[88:91], a[184:187], a[52:55], v[88:91]
  v_mfma_f32_16x16x32_bf16 v[92:95], a[188:191], a[52:55], v[92:95]
  buffer_load_dwordx4 a[52:55], v7, s[4:7], s24 offen sc1
  s_waitcnt vmcnt(12)
  v_mfma_f32_16x16x32_bf16 v[32:35], a[192:195], a[60:63], v[32:35]
  ds_read_b64_tr_b16 a[112:113], v96 offset:0
  s_add_u32 s24, s24, 1024
  v_mfma_f32_16x16x32_bf16 v[36:39], a[196:199], a[60:63], v[36:39]
  ds_read_b64_tr_b16 a[114:115], v96 offset:2048
  v_mfma_f32_16x16x32_bf16 v[40:43], a[200:203], a[60:63], v[40:43]
  ds_read_b64_tr_b16 a[116:117], v97 offset:0
  s_cmp_eq_u32 s24, s19
  s_cselect_b32 s24, s18, s24
  s_cselect_b32 s6, s68, s14
  v_mfma_f32_16x16x32_bf16 v[44:47], a[204:207], a[60:63], v[44:47]
  buffer_load_dwordx4 a[60:63], v4, s[4:7], s24 offen sc1
  v_mfma_f32_16x16x32_bf16 v[48:51], a[192:195], a[64:67], v[48:51]
  ds_read_b64_tr_b16 a[118:119], v97 offset:2048
  v_mfma_f32_16x16x32_bf16 v[52:55], a[196:199], a[64:67], v[52:55]
  ds_read_b64_tr_b16 a[120:121], v98 offset:0
  v_mfma_f32_16x16x32_bf16 v[56:59], a[200:203], a[64:67], v[56:59]
  ds_read_b64_tr_b16 a[122:123], v98 offset:2048
  v_mfma_f32_16x16x32_bf16 v[60:63], a[204:207], a[64:67], v[60:63]
  buffer_load_dwordx4 a[64:67], v5, s[4:7], s24 offen sc1
  v_mfma_f32_16x16x32_bf16 v[64:67], a[192:195], a[68:71], v[64:67]
  ds_read_b64_tr_b16 a[124:125], v99 offset:0
  v_mfma_f32_16x16x32_bf16 v[68:71], a[196:199], a[68:71], v[68:71]
  ds_read_b64_tr_b16 a[126:127], v99 offset:2048
  v_mfma_f32_16x16x32_bf16 v[72:75], a[200:203], a[68:71], v[72:75]
  v_mfma_f32_16x16x32_bf16 v[76:79], a[204:207], a[68:71], v[76:79]
  buffer_load_dwordx4 a[68:71], v6, s[4:7], s24 offen sc1
  v_mfma_f32_16x16x32_bf16 v[80:83], a[192:195], a[72:75], v[80:83]
  v_mfma_f32_16x16x32_bf16 v[84:87], a[196:199], a[72:75], v[84:87]
  v_mfma_f32_16x16x32_bf16 v[88:91], a[200:203], a[72:75], v[88:91]
  v_mfma_f32_16x16x32_bf16 v[92:95], a[204:207], a[72:75], v[92:95]
  buffer_load_dwordx4 a[72:75], v7, s[4:7], s24 offen sc1
  s_waitcnt vmcnt(12)
  v_mfma_f32_16x16x32_bf16 v[32:35], a[208:211], a[0:3], v[32:35]
  ds_read_b64_tr_b16 a[240:241], v96 offset:36864
  ds_read_b64_tr_b16 a[242:243], v96 offset:38912
  s_add_u32 s24, s24, 1024
  v_mfma_f32_16x16x32_bf16 v[36:39], a[212:215], a[0:3], v[36:39]
  ds_read_b64_tr_b16 a[244:245], v97 offset:36864
  s_mov_b32 exec_lo, 4294901760
  s_mov_b32 exec_hi, 65535
  buffer_load_dword v23, v104, s[12:15], 0 offen sc1
  s_mov_b64 exec, -1
  v_mfma_f32_16x16x32_bf16 v[40:43], a[216:219], a[0:3], v[40:43]
  ds_read_b64_tr_b16 a[246:247], v97 offset:38912
  s_cmp_eq_u32 s24, s19
  s_cselect_b32 s24, s18, s24
  s_cselect_b32 s6, s68, s14
  v_mfma_f32_16x16x32_bf16 v[44:47], a[220:223], a[0:3], v[44:47]
  buffer_load_dwordx4 a[0:3], v4, s[4:7], s24 offen sc1
  v_mfma_f32_16x16x32_bf16 v[48:51], a[208:211], a[4:7], v[48:51]
  ds_read_b64_tr_b16 a[248:249], v98 offset:36864
  ds_read_b64_tr_b16 a[250:251], v98 offset:38912
  v_mfma_f32_16x16x32_bf16 v[52:55], a[212:215], a[4:7], v[52:55]
  ds_read_b64_tr_b16 a[252:253], v99 offset:36864
  v_mfma_f32_16x16x32_bf16 v[56:59], a[216:219], a[4:7], v[56:59]
  ds_read_b64_tr_b16 a[254:255], v99 offset:38912
  v_mfma_f32_16x16x32_bf16 v[60:63], a[220:223], a[4:7], v[60:63]
  buffer_load_dwordx4 a[4:7], v5, s[4:7], s24 offen sc1
  v_mfma_f32_16x16x32_bf16 v[64:67], a[208:211], a[8:11], v[64:67]
  ds_read_b64_tr_b16 a[128:129], v96 offset:4096
  ds_read_b64_tr_b16 a[130:131], v96 offset:6144
  v_mfma_f32_16x16x32_bf16 v[68:71], a[212:215], a[8:11], v[68:71]
  ds_read_b64_tr_b16 a[132:133], v97 offset:4096
  v_mfma_f32_16x16x32_bf16 v[72:75], a[216:219], a[8:11], v[72:75]
  ds_read_b64_tr_b16 a[134:135], v97 offset:6144
  v_mfma_f32_16x16x32_bf16 v[76:79], a[220:223], a[8:11], v[76:79]
  buffer_load_dwordx4 a[8:11], v6, s[4:7], s24 offen sc1
  v_mfma_f32_16x16x32_bf16 v[80:83], a[208:211], a[12:15], v[80:83]
  ds_read_b64_tr_b16 a[136:137], v98 offset:4096
  ds_read_b64_tr_b16 a[138:139], v98 offset:6144
  v_mfma_f32_16x16x32_bf16 v[84:87], a[212:215], a[12:15], v[84:87]
  ds_read_b64_tr_b16 a[140:141], v99 offset:4096
  v_mfma_f32_16x16x32_bf16 v[88:91], a[216:219], a[12:15], v[88:91]
  ds_read_b64_tr_b16 a[142:143], v99 offset:6144
  v_mfma_f32_16x16x32_bf16 v[92:95], a[220:223], a[12:15], v[92:95]
  buffer_load_dwordx4 a[12:15], v7, s[4:7], s24 offen sc1
  s_waitcnt vmcnt(13) lgkmcnt(0)
  v_mfma_f32_16x16x32_bf16 v[32:35], a[240:243], a[20:23], v[32:35]
  ds_read_b64_tr_b16 a[224:225], v96 offset:12288
  ds_read_b64_tr_b16 a[226:227], v96 offset:14336
  s_add_u32 s24, s24, 1024
  v_mfma_f32_16x16x32_bf16 v[36:39], a[244:247], a[20:23], v[36:39]
  ds_read_b64_tr_b16 a[228:229], v97 offset:12288
  v_mfma_f32_16x16x32_bf16 v[40:43], a[248:251], a[20:23], v[40:43]
  ds_read_b64_tr_b16 a[230:231], v97 offset:14336
  s_cmp_eq_u32 s24, s19
  s_cselect_b32 s24, s18, s24
  s_cselect_b32 s6, s68, s14
  v_mfma_f32_16x16x32_bf16 v[44:47], a[252:255], a[20:23], v[44:47]
  buffer_load_dwordx4 a[20:23], v4, s[4:7], s24 offen sc1
  v_mfma_f32_16x16x32_bf16 v[48:51], a[240:243], a[24:27], v[48:51]
  ds_read_b64_tr_b16 a[232:233], v98 offset:12288
  ds_read_b64_tr_b16 a[234:235], v98 offset:14336
  v_mfma_f32_16x16x32_bf16 v[52:55], a[244:247], a[24:27], v[52:55]
  ds_read_b64_tr_b16 a[236:237], v99 offset:12288
  v_mfma_f32_16x16x32_bf16 v[56:59], a[248:251], a[24:27], v[56:59]
  ds_read_b64_tr_b16 a[238:239], v99 offset:14336
  v_mfma_f32_16x16x32_bf16 v[60:63], a[252:255], a[24:27], v[60:63]
  buffer_load_dwordx4 a[24:27], v5, s[4:7], s24 offen sc1
  v_mfma_f32_16x16x32_bf16 v[64:67], a[240:243], a[28:31], v[64:67]
  ds_read_b64_tr_b16 a[144:145], v96 offset:8192
  ds_read_b64_tr_b16 a[146:147], v96 offset:10240
  v_mfma_f32_16x16x32_bf16 v[68:71], a[244:247], a[28:31], v[68:71]
  ds_read_b64_tr_b16 a[148:149], v97 offset:8192
  v_mfma_f32_16x16x32_bf16 v[72:75], a[248:251], a[28:31], v[72:75]
  ds_read_b64_tr_b16 a[150:151], v97 offset:10240
  v_mfma_f32_16x16x32_bf16 v[76:79], a[252:255], a[28:31], v[76:79]
  buffer_load_dwordx4 a[28:31], v6, s[4:7], s24 offen sc1
  v_mfma_f32_16x16x32_bf16 v[80:83], a[240:243], a[32:35], v[80:83]
  ds_read_b64_tr_b16 a[152:153], v98 offset:8192
  ds_read_b64_tr_b16 a[154:155], v98 offset:10240
  v_mfma_f32_16x16x32_bf16 v[84:87], a[244:247], a[32:35], v[84:87]
  ds_read_b64_tr_b16 a[156:157], v99 offset:8192
  v_mfma_f32_16x16x32_bf16 v[88:91], a[248:251], a[32:35], v[88:91]
  ds_read_b64_tr_b16 a[158:159], v99 offset:10240
  v_mfma_f32_16x16x32_bf16 v[92:95], a[252:255], a[32:35], v[92:95]
  buffer_load_dwordx4 a[32:35], v7, s[4:7], s24 offen sc1
  s_waitcnt vmcnt(8) lgkmcnt(0)
  v_and_b32 v23, 1, v23
  v_cmp_ne_u32 vcc, v23, v105
  s_nop 0
  s_and_b32 vcc_lo, vcc_lo, 4294901760
  s_and_b32 vcc_hi, vcc_hi, 65535
  s_cbranch_vccz LpoA4ok
  s_mov_b32 exec_lo, 4294901760
  s_mov_b32 exec_hi, 65535
  s_mov_b32 s35, 0x20000
LpoA4:
  buffer_load_dword v23, v104, s[12:15], 0 offen sc1
  s_sub_u32 s35, s35, 1
  s_waitcnt vmcnt(0)
  v_and_b32 v23, 1, v23
  v_cmp_ne_u32 vcc, v23, v105
  s_cmp_eq_u32 s35, 0
  s_cbranch_scc1 LpoA4x
  s_cbranch_vccnz LpoA4
LpoA4x:
  s_mov_b64 exec, -1
LpoA4ok:
  v_mfma_f32_16x16x32_bf16 v[32:35], a[224:227], a[40:43], v[32:35]
  ds_read_b64_tr_b16 a[240:241], v96 offset:16384
  v_mfma_f32_16x16x32_bf16 v[36:39], a[228:231], a[40:43], v[36:39]
  ds_read_b64_tr_b16 a[242:243], v96 offset:18432
  buffer_load_dword v10, v22, s[12:15], s63 offen offset:0 sc1
  v_mfma_f32_16x16x32_bf16 v[40:43], a[232:235], a[40:43], v[40:43]
  ds_read_b64_tr_b16 a[244:245], v97 offset:16384
  v_mfma_f32_16x16x32_bf16 v[44:47], a[236:239], a[40:43], v[44:47]
  buffer_load_dwordx4 a[160:163], v4, s[12:15], s27 offen offset:0 sc1
  v_mfma_f32_16x16x32_bf16 v[48:51], a[224:227], a[44:47], v[48:51]
  ds_read_b64_tr_b16 a[246:247], v97 offset:18432
  v_mfma_f32_16x16x32_bf16 v[52:55], a[228:231], a[44:47], v[52:55]
  ds_read_b64_tr_b16 a[248:249], v98 offset:16384
  buffer_load_dword v11, v22, s[12:15], s63 offen offset:64 sc1
  v_mfma_f32_16x16x32_bf16 v[56:59], a[232:235], a[44:47], v[56:59]
  ds_read_b64_tr_b16 a[250:251], v98 offset:18432
  v_mfma_f32_16x16x32_bf16 v[60:63], a[236:239], a[44:47], v[60:63]
  buffer_load_dwordx4 a[164:167], v4, s[12:15], s27 offen offset:1024 sc1
  v_mfma_f32_16x16x32_bf16 v[64:67], a[224:227], a[48:51], v[64:67]
  ds_read_b64_tr_b16 a[252:253], v99 offset:16384
  v_mfma_f32_16x16x32_bf16 v[68:71], a[228:231], a[48:51], v[68:71]
  ds_read_b64_tr_b16 a[254:255], v99 offset:18432
  buffer_load_dword v12, v22, s[12:15], s63 offen offset:128 sc1
  v_mfma_f32_16x16x32_bf16 v[72:75], a[232:235], a[48:51], v[72:75]
  v_mfma_f32_16x16x32_bf16 v[76:79], a[236:239], a[48:51], v[76:79]
  buffer_load_dwordx4 a[168:171], v4, s[12:15], s27 offen offset:2048 sc1
  v_mfma_f32_16x16x32_bf16 v[80:83], a[224:227], a[52:55], v[80:83]
  v_mfma_f32_16x16x32_bf16 v[84:87], a[228:231], a[52:55], v[84:87]
  buffer_load_dword v13, v22, s[12:15], s63 offen offset:192 sc1
  v_mfma_f32_16x16x32_bf16 v[88:91], a[232:235], a[52:55], v[88:91]
  v_mfma_f32_16x16x32_bf16 v[92:95], a[236:239], a[52:55], v[92:95]
  buffer_load_dwordx4 a[172:175], v4, s[12:15], s27 offen offset:3072 sc1
  s_waitcnt vmcnt(17) lgkmcnt(0)
  v_mfma_f32_16x16x32_bf16 v[32:35], a[240:243], a[60:63], v[32:35]
  ds_read_b64_tr_b16 a[224:225], v96 offset:20480
  v_mfma_f32_16x16x32_bf16 v[36:39], a[244:247], a[60:63], v[36:39]
  ds_read_b64_tr_b16 a[226:227], v96 offset:22528
  v_mfma_f32_16x16x32_bf16 v[40:43], a[248:251], a[60:63], v[40:43]
  ds_read_b64_tr_b16 a[228:229], v97 offset:20480
  v_mfma_f32_16x16x32_bf16 v[44:47], a[252:255], a[60:63], v[44:47]
  buffer_load_dwordx4 a[176:179], v4, s[12:15], s28 offen offset:0 sc1
  v_mfma_f32_16x16x32_bf16 v[48:51], a[240:243], a[64:67], v[48:51]
  ds_read_b64_tr_b16 a[230:231], v97 offset:22528
  v_mfma_f32_16x16x32_bf16 v[52:55], a[244:247], a[64:67], v[52:55]
  ds_read_b64_tr_b16 a[232:233], v98 offset:20480
  v_mfma_f32_16x16x32_bf16 v[56:59], a[248:251], a[64:67], v[56:59]
  ds_read_b64_tr_b16 a[234:235], v98 offset:22528
  v_mfma_f32_16x16x32_bf16 v[60:63], a[252:255], a[64:67], v[60:63]
  buffer_load_dwordx4 a[180:183], v5, s[12:15], s27 offen offset:0 sc1
  v_mfma_f32_16x16x32_bf16 v[64:67], a[240:243], a[68:71], v[64:67]
  ds_read_b64_tr_b16 a[236:237], v99 offset:20480
  v_mfma_f32_16x16x32_bf16 v[68:71], a[244:247], a[68:71], v[68:71]
  ds_read_b64_tr_b16 a[238:239], v99 offset:22528
  v_mfma_f32_16x16x32_bf16 v[72:75], a[248:251], a[68:71], v[72:75]
  v_mfma_f32_16x16x32_bf16 v[76:79], a[252:255], a[68:71], v[76:79]
  buffer_load_dwordx4 a[184:187], v5, s[12:15], s27 offen offset:1024 sc1
  v_mfma_f32_16x16x32_bf16 v[80:83], a[240:243], a[72:75], v[80:83]
  v_mfma_f32_16x16x32_bf16 v[84:87], a[244:247], a[72:75], v[84:87]
  v_mfma_f32_16x16x32_bf16 v[88:91], a[248:251], a[72:75], v[88:91]
  v_mfma_f32_16x16x32_bf16 v[92:95], a[252:255], a[72:75], v[92:95]
  buffer_load_dwordx4 a[188:191], v5, s[12:15], s27 offen offset:2048 sc1
  s_waitcnt vmcnt(16) lgkmcnt(0)
  v_mfma_f32_16x16x32_bf16 v[32:35], a[224:227], a[0:3], v[32:35]
  ds_read_b64_tr_b16 a[240:241], v96 offset:24576
  v_mfma_f32_16x16x32_bf16 v[36:39], a[228:231], a[0:3], v[36:39]
  ds_read_b64_tr_b16 a[242:243], v96 offset:26624
  v_mfma_f32_16x16x32_bf16 v[40:43], a[232:235], a[0:3], v[40:43]
  ds_read_b64_tr_b16 a[244:245], v97 offset:24576
  v_mfma_f32_16x16x32_bf16 v[44:47], a[236:239], a[0:3], v[44:47]
  buffer_load_dwordx4 a[192:195], v5, s[12:15], s27 offen offset:3072 sc1
  v_mfma_f32_16x16x32_bf16 v[48:51], a[224:227], a[4:7], v[48:51]
  ds_read_b64_tr_b16 a[246:247], v97 offset:26624
  v_mfma_f32_16x16x32_bf16 v[52:55], a[228:231], a[4:7], v[52:55]
  ds_read_b64_tr_b16 a[248:249], v98 offset:24576
  v_mfma_f32_16x16x32_bf16 v[56:59], a[232:235], a[4:7], v[56:59]
  ds_read_b64_tr_b16 a[250:251], v98 offset:26624
  v_mfma_f32_16x16x32_bf16 v[60:63], a[236:239], a[4:7], v[60:63]
  buffer_load_dwordx4 a[196:199], v5, s[12:15], s28 offen offset:0 sc1
  v_mfma_f32_16x16x32_bf16 v[64:67], a[224:227], a[8:11], v[64:67]
  ds_read_b64_tr_b16 a[252:253], v99 offset:24576
  v_mfma_f32_16x16x32_bf16 v[68:71], a[228:231], a[8:11], v[68:71]
  ds_read_b64_tr_b16 a[254:255], v99 offset:26624
  v_mfma_f32_16x16x32_bf16 v[72:75], a[232:235], a[8:11], v[72:75]
  v_mfma_f32_16x16x32_bf16 v[76:79], a[236:239], a[8:11], v[76:79]
  buffer_load_dwordx4 a[200:203], v6, s[12:15], s27 offen offset:0 sc1
  v_mfma_f32_16x16x32_bf16 v[80:83], a[224:227], a[12:15], v[80:83]
  v_mfma_f32_16x16x32_bf16 v[84:87], a[228:231], a[12:15], v[84:87]
  v_mfma_f32_16x16x32_bf16 v[88:91], a[232:235], a[12:15], v[88:91]
  v_mfma_f32_16x16x32_bf16 v[92:95], a[236:239], a[12:15], v[92:95]
  buffer_load_dwordx4 a[204:207], v6, s[12:15], s27 offen offset:1024 sc1
  s_waitcnt vmcnt(9) lgkmcnt(0)
  v_mfma_f32_16x16x32_bf16 v[32:35], a[240:243], a[20:23], v[32:35]
  v_mfma_f32_16x16x32_bf16 v[36:39], a[244:247], a[20:23], v[36:39]
  v_sub_f32 v16, 1.0, v10
  v_mfma_f32_16x16x32_bf16 v[40:43], a[248:251], a[20:23], v[40:43]
  v_mfma_f32_16x16x32_bf16 v[44:47], a[252:255], a[20:23], v[44:47]
  buffer_load_dwordx4 a[208:211], v6, s[12:15], s27 offen offset:2048 sc1
  v_mfma_f32_16x16x32_bf16 v[48:51], a[240:243], a[24:27], v[48:51]
  v_mfma_f32_16x16x32_bf16 v[52:55], a[244:247], a[24:27], v[52:55]
  v_sub_f32 v17, 1.0, v11
  v_mfma_f32_16x16x32_bf16 v[56:59], a[248:251], a[24:27], v[56:59]
  v_mfma_f32_16x16x32_bf16 v[60:63], a[252:255], a[24:27], v[60:63]
  buffer_load_dwordx4 a[212:215], v6, s[12:15], s27 offen offset:3072 sc1
  v_mfma_f32_16x16x32_bf16 v[64:67], a[240:243], a[28:31], v[64:67]
  v_mfma_f32_16x16x32_bf16 v[68:71], a[244:247], a[28:31], v[68:71]
  v_sub_f32 v18, 1.0, v12
  v_mfma_f32_16x16x32_bf16 v[72:75], a[248:251], a[28:31], v[72:75]
  v_mfma_f32_16x16x32_bf16 v[76:79], a[252:255], a[28:31], v[76:79]
  buffer_load_dwordx4 a[216:219], v6, s[12:15], s28 offen offset:0 sc1
  v_mfma_f32_16x16x32_bf16 v[80:83], a[240:243], a[32:35], v[80:83]
  v_mfma_f32_16x16x32_bf16 v[84:87], a[244:247], a[32:35], v[84:87]
  v_sub_f32 v19, 1.0, v13
  v_mfma_f32_16x16x32_bf16 v[88:91], a[248:251], a[32:35], v[88:91]
  v_mfma_f32_16x16x32_bf16 v[92:95], a[252:255], a[32:35], v[92:95]
  buffer_load_dwordx4 a[220:223], v7, s[12:15], s27 offen offset:0 sc1
  s_waitcnt vmcnt(11) lgkmcnt(0)
  v_mfma_f32_16x16x32_bf16 v[140:143], a[80:83], a[160:163], 0
  buffer_load_dwordx4 a[40:43], v7, s[12:15], s27 offen offset:1024 sc1
  v_mfma_f32_16x16x32_bf16 v[144:147], a[84:87], a[160:163], 0
  v_mfma_f32_16x16x32_bf16 v[148:151], a[88:91], a[160:163], 0
  buffer_load_dwordx4 a[44:47], v7, s[12:15], s27 offen offset:2048 sc1
  v_mfma_f32_16x16x32_bf16 v[152:155], a[92:95], a[160:163], 0
  v_mfma_f32_16x16x32_bf16 v[140:143], a[96:99], a[164:167], v[140:143]
  buffer_load_dwordx4 a[48:51], v7, s[12:15], s27 offen offset:3072 sc1
  v_mul_f32 v32, v16, v32
  v_mfma_f32_16x16x32_bf16 v[144:147], a[100:103], a[164:167], v[144:147]
  v_mul_f32 v33, v16, v33
  v_mfma_f32_16x16x32_bf16 v[148:151], a[104:107], a[164:167], v[148:151]
  buffer_load_dwordx4 a[52:55], v7, s[12:15], s28 offen offset:0 sc1
  v_mul_f32 v34, v16, v34
  v_mfma_f32_16x16x32_bf16 v[152:155], a[108:111], a[164:167], v[152:155]
  v_mul_f32 v35, v16, v35
  v_mfma_f32_16x16x32_bf16 v[140:143], a[112:115], a[168:171], v[140:143]
  v_mul_f32 v36, v16, v36
  v_mfma_f32_16x16x32_bf16 v[144:147], a[116:119], a[168:171], v[144:147]
  v_mul_f32 v37, v16, v37
  v_mfma_f32_16x16x32_bf16 v[148:151], a[120:123], a[168:171], v[148:151]
  v_mul_f32 v38, v16, v38
  v_mfma_f32_16x16x32_bf16 v[152:155], a[124:127], a[168:171], v[152:155]
  v_mul_f32 v39, v16, v39
  v_mfma_f32_16x16x32_bf16 v[140:143], a[128:131], a[172:175], v[140:143]
  v_mul_f32 v40, v16, v40
  v_mfma_f32_16x16x32_bf16 v[144:147], a[132:135], a[172:175], v[144:147]
  v_mul_f32 v41, v16, v41
  v_mfma_f32_16x16x32_bf16 v[148:151], a[136:139], a[172:175], v[148:151]
  v_mul_f32 v42, v16, v42
  v_mfma_f32_16x16x32_bf16 v[152:155], a[140:143], a[172:175], v[152:155]
  v_mul_f32 v43, v16, v43
  v_mfma_f32_16x16x32_bf16 v[140:143], a[144:147], a[176:179], v[140:143]
  v_mul_f32 v44, v16, v44
  v_mfma_f32_16x16x32_bf16 v[144:147], a[148:151], a[176:179], v[144:147]
  v_mul_f32 v45, v16, v45
  v_mfma_f32_16x16x32_bf16 v[148:151], a[152:155], a[176:179], v[148:151]
  v_mul_f32 v46, v16, v46
  v_mfma_f32_16x16x32_bf16 v[152:155], a[156:159], a[176:179], v[152:155]
  v_mul_f32 v47, v16, v47
  s_waitcnt vmcnt(10)
  v_mfma_f32_16x16x32_bf16 v[156:159], a[80:83], a[180:183], 0
  v_mul_f32 v48, v17, v48
  v_mul_f32 v49, v17, v49
  v_mfma_f32_16x16x32_bf16 v[160:163], a[84:87], a[180:183], 0
  v_mul_f32 v50, v17, v50
  v_mul_f32 v51, v17, v51
  v_mfma_f32_16x16x32_bf16 v[164:167], a[88:91], a[180:183], 0
  v_mul_f32 v52, v17, v52
  v_mul_f32 v53, v17, v53
  v_mfma_f32_16x16x32_bf16 v[168:171], a[92:95], a[180:183], 0
  v_fmac_f32 v32, v10, v140
  v_fmac_f32 v33, v10, v141
  v_mfma_f32_16x16x32_bf16 v[156:159], a[96:99], a[184:187], v[156:159]
  v_fmac_f32 v34, v10, v142
  v_fmac_f32 v35, v10, v143
  v_mfma_f32_16x16x32_bf16 v[160:163], a[100:103], a[184:187], v[160:163]
  ds_write_b128 v172, v[32:35] offset:0
  v_fmac_f32 v36, v10, v144
  v_mfma_f32_16x16x32_bf16 v[164:167], a[104:107], a[184:187], v[164:167]
  v_fmac_f32 v37, v10, v145
  v_fmac_f32 v38, v10, v146
  v_mfma_f32_16x16x32_bf16 v[168:171], a[108:111], a[184:187], v[168:171]
  v_fmac_f32 v39, v10, v147
  v_mfma_f32_16x16x32_bf16 v[156:159], a[112:115], a[188:191], v[156:159]
  ds_write_b128 v173, v[36:39] offset:0
  v_fmac_f32 v40, v10, v148
  v_mfma_f32_16x16x32_bf16 v[160:163], a[116:119], a[188:191], v[160:163]
  v_fmac_f32 v41, v10, v149
  v_fmac_f32 v42, v10, v150
  v_mfma_f32_16x16x32_bf16 v[164:167], a[120:123], a[188:191], v[164:167]
  v_fmac_f32 v43, v10, v151
  ds_write_b128 v174, v[40:43] offset:0
  v_mfma_f32_16x16x32_bf16 v[168:171], a[124:127], a[188:191], v[168:171]
  v_fmac_f32 v44, v10, v152
  v_mfma_f32_16x16x32_bf16 v[156:159], a[128:131], a[192:195], v[156:159]
  v_fmac_f32 v45, v10, v153
  v_fmac_f32 v46, v10, v154
  v_mfma_f32_16x16x32_bf16 v[160:163], a[132:135], a[192:195], v[160:163]
  v_fmac_f32 v47, v10, v155
  ds_write_b128 v175, v[44:47] offset:0
  v_mfma_f32_16x16x32_bf16 v[164:167], a[136:139], a[192:195], v[164:167]
  v_mul_f32 v54, v17, v54
  v_mul_f32 v55, v17, v55
  v_mfma_f32_16x16x32_bf16 v[168:171], a[140:143], a[192:195], v[168:171]
  v_mul_f32 v56, v17, v56
  v_mfma_f32_16x16x32_bf16 v[156:159], a[144:147], a[196:199], v[156:159]
  v_mul_f32 v57, v17, v57
  v_mul_f32 v58, v17, v58
  v_mfma_f32_16x16x32_bf16 v[160:163], a[148:151], a[196:199], v[160:163]
  v_mul_f32 v59, v17, v59
  v_mul_f32 v60, v17, v60
  v_mfma_f32_16x16x32_bf16 v[164:167], a[152:155], a[196:199], v[164:167]
  v_mul_f32 v61, v17, v61
  v_mul_f32 v62, v17, v62
  v_mfma_f32_16x16x32_bf16 v[168:171], a[156:159], a[196:199], v[168:171]
  v_mul_f32 v63, v17, v63
  s_waitcnt vmcnt(5)
  v_mfma_f32_16x16x32_bf16 v[140:143], a[80:83], a[200:203], 0
  v_mul_f32 v64, v18, v64
  v_mul_f32 v65, v18, v65
  v_mfma_f32_16x16x32_bf16 v[144:147], a[84:87], a[200:203], 0
  v_mul_f32 v66, v18, v66
  v_mul_f32 v67, v18, v67
  v_mfma_f32_16x16x32_bf16 v[148:151], a[88:91], a[200:203], 0
  v_mul_f32 v68, v18, v68
  v_mul_f32 v69, v18, v69
  v_mfma_f32_16x16x32_bf16 v[152:155], a[92:95], a[200:203], 0
  v_fmac_f32 v48, v11, v156
  v_fmac_f32 v49, v11, v157
  v_mfma_f32_16x16x32_bf16 v[140:143], a[96:99], a[204:207], v[140:143]
  v_fmac_f32 v50, v11, v158
  v_fmac_f32 v51, v11, v159
  v_mfma_f32_16x16x32_bf16 v[144:147], a[100:103], a[204:207], v[144:147]
  ds_write_b128 v172, v[48:51] offset:4096
  v_fmac_f32 v52, v11, v160
  v_mfma_f32_16x16x32_bf16 v[148:151], a[104:107], a[204:207], v[148:151]
  v_fmac_f32 v53, v11, v161
  v_fmac_f32 v54, v11, v162
  v_mfma_f32_16x16x32_bf16 v[152:155], a[108:111], a[204:207], v[152:155]
  v_fmac_f32 v55, v11, v163
  v_mfma_f32_16x16x32_bf16 v[140:143], a[112:115], a[208:211], v[140:143]
  ds_write_b128 v173, v[52:55] offset:4096
  v_fmac_f32 v56, v11, v164
  v_mfma_f32_16x16x32_bf16 v[144:147], a[116:119], a[208:211], v[144:147]
  v_fmac_f32 v57, v11, v165
  v_fmac_f32 v58, v11, v166
  v_mfma_f32_16x16x32_bf16 v[148:151], a[120:123], a[208:211], v[148:151]
  v_fmac_f32 v59, v11, v167
  ds_write_b128 v174, v[56:59] offset:4096
  v_mfma_f32_16x16x32_bf16 v[152:155], a[124:127], a[208:211], v[152:155]
  v_fmac_f32 v60, v11, v168
  v_mfma_f32_16x16x32_bf16 v[140:143], a[128:131], a[212:215], v[140:143]
  v_fmac_f32 v61, v11, v169
  v_fmac_f32 v62, v11, v170
  v_mfma_f32_16x16x32_bf16 v[144:147], a[132:135], a[212:215], v[144:147]
  v_fmac_f32 v63, v11, v171
  ds_write_b128 v175, v[60:63] offset:4096
  v_mfma_f32_16x16x32_bf16 v[148:151], a[136:139], a[212:215], v[148:151]
  v_mul_f32 v70, v18, v70
  v_mul_f32 v71, v18, v71
  v_mfma_f32_16x16x32_bf16 v[152:155], a[140:143], a[212:215], v[152:155]
  v_mul_f32 v72, v18, v72
  v_mfma_f32_16x16x32_bf16 v[140:143], a[144:147], a[216:219], v[140:143]
  v_mul_f32 v73, v18, v73
  v_mul_f32 v74, v18, v74
  v_mfma_f32_16x16x32_bf16 v[144:147], a[148:151], a[216:219], v[144:147]
  v_mul_f32 v75, v18, v75
  v_mul_f32 v76, v18, v76
  v_mfma_f32_16x16x32_bf16 v[148:151], a[152:155], a[216:219], v[148:151]
  v_mul_f32 v77, v18, v77
  v_mul_f32 v78, v18, v78
  v_mfma_f32_16x16x32_bf16 v[152:155], a[156:159], a[216:219], v[152:155]
  v_mul_f32 v79, v18, v79
  s_waitcnt vmcnt(0)
  v_mfma_f32_16x16x32_bf16 v[156:159], a[80:83], a[220:223], 0
  v_mul_f32 v80, v19, v80
  v_mul_f32 v81, v19, v81
  v_mfma_f32_16x16x32_bf16 v[160:163], a[84:87], a[220:223], 0
  v_mul_f32 v82, v19, v82
  v_mul_f32 v83, v19, v83
  v_mfma_f32_16x16x32_bf16 v[164:167], a[88:91], a[220:223], 0
  v_mul_f32 v84, v19, v84
  v_mul_f32 v85, v19, v85
  v_mfma_f32_16x16x32_bf16 v[168:171], a[92:95], a[220:223], 0
  v_fmac_f32 v64, v12, v140
  v_fmac_f32 v65, v12, v141
  v_mfma_f32_16x16x32_bf16 v[156:159], a[96:99], a[40:43], v[156:159]
  v_fmac_f32 v66, v12, v142
  v_fmac_f32 v67, v12, v143
  v_mfma_f32_16x16x32_bf16 v[160:163], a[100:103], a[40:43], v[160:163]
  ds_write_b128 v172, v[64:67] offset:8192
  v_fmac_f32 v68, v12, v144
  v_mfma_f32_16x16x32_bf16 v[164:167], a[104:107], a[40:43], v[164:167]
  v_fmac_f32 v69, v12, v145
  v_fmac_f32 v70, v12, v146
  v_mfma_f32_16x16x32_bf16 v[168:171], a[108:111], a[40:43], v[168:171]
  v_fmac_f32 v71, v12, v147
  v_mfma_f32_16x16x32_bf16 v[156:159], a[112:115], a[44:47], v[156:159]
  ds_write_b128 v173, v[68:71] offset:8192
  v_fmac_f32 v72, v12, v148
  v_mfma_f32_16x16x32_bf16 v[160:163], a[116:119], a[44:47], v[160:163]
  v_fmac_f32 v73, v12, v149
  v_fmac_f32 v74, v12, v150
  v_mfma_f32_16x16x32_bf16 v[164:167], a[120:123], a[44:47], v[164:167]
  v_fmac_f32 v75, v12, v151
  ds_write_b128 v174, v[72:75] offset:8192
  v_mfma_f32_16x16x32_bf16 v[168:171], a[124:127], a[44:47], v[168:171]
  v_fmac_f32 v76, v12, v152
  v_mfma_f32_16x16x32_bf16 v[156:159], a[128:131], a[48:51], v[156:159]
  v_fmac_f32 v77, v12, v153
  v_fmac_f32 v78, v12, v154
  v_mfma_f32_16x16x32_bf16 v[160:163], a[132:135], a[48:51], v[160:163]
  v_fmac_f32 v79, v12, v155
  ds_write_b128 v175, v[76:79] offset:8192
  v_mfma_f32_16x16x32_bf16 v[164:167], a[136:139], a[48:51], v[164:167]
  v_mul_f32 v86, v19, v86
  v_mul_f32 v87, v19, v87
  v_mfma_f32_16x16x32_bf16 v[168:171], a[140:143], a[48:51], v[168:171]
  v_mul_f32 v88, v19, v88
  v_mfma_f32_16x16x32_bf16 v[156:159], a[144:147], a[52:55], v[156:159]
  v_mul_f32 v89, v19, v89
  v_mul_f32 v90, v19, v90
  v_mfma_f32_16x16x32_bf16 v[160:163], a[148:151], a[52:55], v[160:163]
  v_mul_f32 v91, v19, v91
  v_mul_f32 v92, v19, v92
  v_mfma_f32_16x16x32_bf16 v[164:167], a[152:155], a[52:55], v[164:167]
  v_mul_f32 v93, v19, v93
  v_mul_f32 v94, v19, v94
  v_mfma_f32_16x16x32_bf16 v[168:171], a[156:159], a[52:55], v[168:171]
  v_mul_f32 v95, v19, v95
  v_fmac_f32 v80, v13, v156
  v_fmac_f32 v81, v13, v157
  v_fmac_f32 v82, v13, v158
  v_fmac_f32 v83, v13, v159
  ds_write_b128 v172, v[80:83] offset:12288
  v_fmac_f32 v84, v13, v160
  v_fmac_f32 v85, v13, v161
  v_fmac_f32 v86, v13, v162
  v_fmac_f32 v87, v13, v163
  ds_write_b128 v173, v[84:87] offset:12288
  v_fmac_f32 v88, v13, v164
  v_fmac_f32 v89, v13, v165
  v_fmac_f32 v90, v13, v166
  v_fmac_f32 v91, v13, v167
  ds_write_b128 v174, v[88:91] offset:12288
  v_fmac_f32 v92, v13, v168
  v_fmac_f32 v93, v13, v169
  v_fmac_f32 v94, v13, v170
  v_fmac_f32 v95, v13, v171
  ds_write_b128 v175, v[92:95] offset:12288
  s_waitcnt lgkmcnt(0)
  s_barrier
  ds_read_b128 v[184:187], v176 offset:0
  ds_read_b128 v[188:191], v177 offset:0
  ds_read_b128 v[192:195], v176 offset:40960
  ds_read_b128 v[196:199], v177 offset:40960
  ds_read_b128 v[200:203], v178 offset:0
  ds_read_b128 v[204:207], v179 offset:0
  ds_read_b128 v[208:211], v178 offset:40960
  ds_read_b128 v[212:215], v179 offset:40960
  ds_read_b128 v[216:219], v176 offset:8192
  ds_read_b128 v[220:223], v177 offset:8192
  ds_read_b128 v[224:227], v176 offset:49152
  ds_read_b128 v[228:231], v177 offset:49152
  ds_read_b128 v[232:235], v178 offset:8192
  ds_read_b128 v[236:239], v179 offset:8192
  ds_read_b128 v[240:243], v178 offset:49152
  ds_read_b128 v[244:247], v179 offset:49152
  s_waitcnt lgkmcnt(8)
  v_pk_add_f32 v[184:185], v[184:185], v[192:193]
  v_pk_add_f32 v[200:201], v[200:201], v[208:209]
  v_pk_add_f32 v[186:187], v[186:187], v[194:195]
  v_pk_add_f32 v[202:203], v[202:203], v[210:211]
  v_pk_add_f32 v[188:189], v[188:189], v[196:197]
  v_pk_add_f32 v[204:205], v[204:205], v[212:213]
  v_pk_add_f32 v[190:191], v[190:191], v[198:199]
  v_pk_add_f32 v[206:207], v[206:207], v[214:215]
  v_pk_add_f32 v[184:185], v[184:185], v[200:201]
  v_pk_add_f32 v[186:187], v[186:187], v[202:203]
  v_pk_add_f32 v[188:189], v[188:189], v[204:205]
  v_pk_add_f32 v[190:191], v[190:191], v[206:207]
  v_cvt_pk_bf16_f32 v32, v184, v185
  v_cvt_pk_bf16_f32 v33, v186, v187
  v_cvt_pk_bf16_f32 v34, v188, v189
  v_cvt_pk_bf16_f32 v35, v190, v191
  s_mov_b32 s58, 0
  buffer_store_dwordx4 v[32:35], v180, s[72:75], s58 offen sc1 nt
  s_waitcnt lgkmcnt(0)
  v_pk_add_f32 v[216:217], v[216:217], v[224:225]
  v_pk_add_f32 v[232:233], v[232:233], v[240:241]
  v_pk_add_f32 v[218:219], v[218:219], v[226:227]
  v_pk_add_f32 v[234:235], v[234:235], v[242:243]
  v_pk_add_f32 v[220:221], v[220:221], v[228:229]
  v_pk_add_f32 v[236:237], v[236:237], v[244:245]
  v_pk_add_f32 v[222:223], v[222:223], v[230:231]
  v_pk_add_f32 v[238:239], v[238:239], v[246:247]
  v_pk_add_f32 v[216:217], v[216:217], v[232:233]
  v_pk_add_f32 v[218:219], v[218:219], v[234:235]
  v_pk_add_f32 v[220:221], v[220:221], v[236:237]
  v_pk_add_f32 v[222:223], v[222:223], v[238:239]
  v_cvt_pk_bf16_f32 v36, v216, v217
  v_cvt_pk_bf16_f32 v37, v218, v219
  v_cvt_pk_bf16_f32 v38, v220, v221
  v_cvt_pk_bf16_f32 v39, v222, v223
  s_mov_b32 s58, 40960
  buffer_store_dwordx4 v[36:39], v180, s[72:75], s58 offen sc1 nt
  s_branch Lfin
LvF5:
  s_waitcnt vmcnt(15)
  v_mfma_f32_16x16x32_bf16 v[32:35], a[80:83], a[0:3], 0
  v_mfma_f32_16x16x32_bf16 v[36:39], a[84:87], a[0:3], 0
  v_mfma_f32_16x16x32_bf16 v[40:43], a[88:91], a[0:3], 0
  v_mfma_f32_16x16x32_bf16 v[44:47], a[92:95], a[0:3], 0
  buffer_load_dwordx4 a[0:3], v4, s[4:7], s24 offen sc1
  v_mfma_f32_16x16x32_bf16 v[48:51], a[80:83], a[4:7], 0
  v_mfma_f32_16x16x32_bf16 v[52:55], a[84:87], a[4:7], 0
  v_mfma_f32_16x16x32_bf16 v[56:59], a[88:91], a[4:7], 0
  v_mfma_f32_16x16x32_bf16 v[60:63], a[92:95], a[4:7], 0
  buffer_load_dwordx4 a[4:7], v5, s[4:7], s24 offen sc1
  v_mfma_f32_16x16x32_bf16 v[64:67], a[80:83], a[8:11], 0
  v_mfma_f32_16x16x32_bf16 v[68:71], a[84:87], a[8:11], 0
  v_mfma_f32_16x16x32_bf16 v[72:75], a[88:91], a[8:11], 0
  v_mfma_f32_16x16x32_bf16 v[76:79], a[92:95], a[8:11], 0
  buffer_load_dwordx4 a[8:11], v6, s[4:7], s24 offen sc1
  v_mfma_f32_16x16x32_bf16 v[80:83], a[80:83], a[12:15], 0
  v_mfma_f32_16x16x32_bf16 v[84:87], a[84:87], a[12:15], 0
  v_mfma_f32_16x16x32_bf16 v[88:91], a[88:91], a[12:15], 0
  v_mfma_f32_16x16x32_bf16 v[92:95], a[92:95], a[12:15], 0
  buffer_load_dwordx4 a[12:15], v7, s[4:7], s24 offen sc1
  v_mfma_f32_16x16x32_bf16 v[108:111], a[80:83], a[16:19], 0
  v_mfma_f32_16x16x32_bf16 v[112:115], a[84:87], a[16:19], 0
  v_mfma_f32_16x16x32_bf16 v[116:119], a[88:91], a[16:19], 0
  v_mfma_f32_16x16x32_bf16 v[120:123], a[92:95], a[16:19], 0
  buffer_load_dwordx4 a[16:19], v8, s[4:7], s24 offen sc1
  s_waitcnt vmcnt(15)
  v_mfma_f32_16x16x32_bf16 v[32:35], a[96:99], a[20:23], v[32:35]
  s_add_u32 s24, s24, 1024
  v_mfma_f32_16x16x32_bf16 v[36:39], a[100:103], a[20:23], v[36:39]
  v_mfma_f32_16x16x32_bf16 v[40:43], a[104:107], a[20:23], v[40:43]
  s_cmp_eq_u32 s24, s19
  s_cselect_b32 s24, s18, s24
  s_cselect_b32 s6, s68, s14
  v_mfma_f32_16x16x32_bf16 v[44:47], a[108:111], a[20:23], v[44:47]
  buffer_load_dwordx4 a[20:23], v4, s[4:7], s24 offen sc1
  v_mfma_f32_16x16x32_bf16 v[48:51], a[96:99], a[24:27], v[48:51]
  v_mfma_f32_16x16x32_bf16 v[52:55], a[100:103], a[24:27], v[52:55]
  v_mfma_f32_16x16x32_bf16 v[56:59], a[104:107], a[24:27], v[56:59]
  v_mfma_f32_16x16x32_bf16 v[60:63], a[108:111], a[24:27], v[60:63]
  buffer_load_dwordx4 a[24:27], v5, s[4:7], s24 offen sc1
  v_mfma_f32_16x16x32_bf16 v[64:67], a[96:99], a[28:31], v[64:67]
  v_mfma_f32_16x16x32_bf16 v[68:71], a[100:103], a[28:31], v[68:71]
  v_mfma_f32_16x16x32_bf16 v[72:75], a[104:107], a[28:31], v[72:75]
  v_mfma_f32_16x16x32_bf16 v[76:79], a[108:111], a[28:31], v[76:79]
  buffer_load_dwordx4 a[28:31], v6, s[4:7], s24 offen sc1
  v_mfma_f32_16x16x32_bf16 v[80:83], a[96:99], a[32:35], v[80:83]
  v_mfma_f32_16x16x32_bf16 v[84:87], a[100:103], a[32:35], v[84:87]
  v_mfma_f32_16x16x32_bf16 v[88:91], a[104:107], a[32:35], v[88:91]
  v_mfma_f32_16x16x32_bf16 v[92:95], a[108:111], a[32:35], v[92:95]
  buffer_load_dwordx4 a[32:35], v7, s[4:7], s24 offen sc1
  v_mfma_f32_16x16x32_bf16 v[108:111], a[96:99], a[36:39], v[108:111]
  v_mfma_f32_16x16x32_bf16 v[112:115], a[100:103], a[36:39], v[112:115]
  v_mfma_f32_16x16x32_bf16 v[116:119], a[104:107], a[36:39], v[116:119]
  v_mfma_f32_16x16x32_bf16 v[120:123], a[108:111], a[36:39], v[120:123]
  buffer_load_dwordx4 a[36:39], v8, s[4:7], s24 offen sc1
  s_waitcnt vmcnt(15)
  v_mfma_f32_16x16x32_bf16 v[32:35], a[112:115], a[40:43], v[32:35]
  v_xor_b32 v24, v2, v3
  s_add_u32 s24, s24, 1024
  v_mfma_f32_16x16x32_bf16 v[36:39], a[116:119], a[40:43], v[36:39]
  v_lshlrev_b32 v24, 4, v24
  v_mfma_f32_16x16x32_bf16 v[40:43], a[120:123], a[40:43], v[40:43]
  v_lshl_add_u32 v24, v3, 8, v24
  s_cmp_eq_u32 s24, s19
  s_cselect_b32 s24, s18, s24
  s_cselect_b32 s6, s68, s14
  v_mfma_f32_16x16x32_bf16 v[44:47], a[124:127], a[40:43], v[44:47]
  buffer_load_dwordx4 a[40:43], v4, s[4:7], s24 offen sc1
  v_mfma_f32_16x16x32_bf16 v[48:51], a[112:115], a[44:47], v[48:51]
  v_mfma_f32_16x16x32_bf16 v[52:55], a[116:119], a[44:47], v[52:55]
  v_add_u32 v172, s33, v24
  v_mfma_f32_16x16x32_bf16 v[56:59], a[120:123], a[44:47], v[56:59]
  v_xor_b32 v173, 64, v172
  v_mfma_f32_16x16x32_bf16 v[60:63], a[124:127], a[44:47], v[60:63]
  buffer_load_dwordx4 a[44:47], v5, s[4:7], s24 offen sc1
  v_mfma_f32_16x16x32_bf16 v[64:67], a[112:115], a[48:51], v[64:67]
  v_xor_b32 v174, 128, v172
  v_mfma_f32_16x16x32_bf16 v[68:71], a[116:119], a[48:51], v[68:71]
  v_mfma_f32_16x16x32_bf16 v[72:75], a[120:123], a[48:51], v[72:75]
  v_xor_b32 v175, 192, v172
  v_mfma_f32_16x16x32_bf16 v[76:79], a[124:127], a[48:51], v[76:79]
  buffer_load_dwordx4 a[48:51], v6, s[4:7], s24 offen sc1
  v_mfma_f32_16x16x32_bf16 v[80:83], a[112:115], a[52:55], v[80:83]
  v_bfe_u32 v24, v0, 3, 4
  v_mfma_f32_16x16x32_bf16 v[84:87], a[116:119], a[52:55], v[84:87]
  v_and_b32 v25, 7, v0
  v_mfma_f32_16x16x32_bf16 v[88:91], a[120:123], a[52:55], v[88:91]
  v_mfma_f32_16x16x32_bf16 v[92:95], a[124:127], a[52:55], v[92:95]
  buffer_load_dwordx4 a[52:55], v7, s[4:7], s24 offen sc1
  v_mfma_f32_16x16x32_bf16 v[108:111], a[112:115], a[56:59], v[108:111]
  v_lshlrev_b32 v26, 1, v25
  v_mfma_f32_16x16x32_bf16 v[112:115], a[116:119], a[56:59], v[112:115]
  v_xor_b32 v26, v26, v24
  v_mfma_f32_16x16x32_bf16 v[116:119], a[120:123], a[56:59], v[116:119]
  v_mfma_f32_16x16x32_bf16 v[120:123], a[124:127], a[56:59], v[120:123]
  buffer_load_dwordx4 a[56:59], v8, s[4:7], s24 offen sc1
  s_waitcnt vmcnt(15)
  v_mfma_f32_16x16x32_bf16 v[32:35], a[128:131], a[60:63], v[32:35]
  v_lshlrev_b32 v26, 4, v26
  s_add_u32 s24, s24, 1024
  v_mfma_f32_16x16x32_bf16 v[36:39], a[132:135], a[60:63], v[36:39]
  v_lshl_add_u32 v26, v24, 8, v26
  v_mfma_f32_16x16x32_bf16 v[40:43], a[136:139], a[60:63], v[40:43]
  s_lshr_b32 s59, s20, 1
  s_cmp_eq_u32 s24, s19
  s_cselect_b32 s24, s18, s24
  s_cselect_b32 s6, s68, s14
  v_mfma_f32_16x16x32_bf16 v[44:47], a[140:143], a[60:63], v[44:47]
  buffer_load_dwordx4 a[60:63], v4, s[4:7], s24 offen sc1
  v_mfma_f32_16x16x32_bf16 v[48:51], a[128:131], a[64:67], v[48:51]
  s_lshl_b32 s58, s59, 12
  v_mfma_f32_16x16x32_bf16 v[52:55], a[132:135], a[64:67], v[52:55]
  v_mfma_f32_16x16x32_bf16 v[56:59], a[136:139], a[64:67], v[56:59]
  v_add_u32 v176, s58, v26
  v_mfma_f32_16x16x32_bf16 v[60:63], a[140:143], a[64:67], v[60:63]
  buffer_load_dwordx4 a[64:67], v5, s[4:7], s24 offen sc1
  v_mfma_f32_16x16x32_bf16 v[64:67], a[128:131], a[68:71], v[64:67]
  v_xor_b32 v177, 16, v176
  v_mfma_f32_16x16x32_bf16 v[68:71], a[132:135], a[68:71], v[68:71]
  v_add_u32 v178, 81920, v176
  v_mfma_f32_16x16x32_bf16 v[72:75], a[136:139], a[68:71], v[72:75]
  v_add_u32 v179, 81920, v177
  v_mfma_f32_16x16x32_bf16 v[76:79], a[140:143], a[68:71], v[76:79]
  buffer_load_dwordx4 a[68:71], v6, s[4:7], s24 offen sc1
  v_mfma_f32_16x16x32_bf16 v[80:83], a[128:131], a[72:75], v[80:83]
  v_mfma_f32_16x16x32_bf16 v[84:87], a[132:135], a[72:75], v[84:87]
  s_mov_b32 s72, s50
  v_mfma_f32_16x16x32_bf16 v[88:91], a[136:139], a[72:75], v[88:91]
  s_mov_b32 s73, s51
  v_mfma_f32_16x16x32_bf16 v[92:95], a[140:143], a[72:75], v[92:95]
  buffer_load_dwordx4 a[72:75], v7, s[4:7], s24 offen sc1
  v_mfma_f32_16x16x32_bf16 v[108:111], a[128:131], a[76:79], v[108:111]
  s_mov_b32 s74, 2621440
  v_mfma_f32_16x16x32_bf16 v[112:115], a[132:135], a[76:79], v[112:115]
  s_lshl_b32 s23, s23, 7
  v_mfma_f32_16x16x32_bf16 v[116:119], a[136:139], a[76:79], v[116:119]
  v_mfma_f32_16x16x32_bf16 v[120:123], a[140:143], a[76:79], v[120:123]
  buffer_load_dwordx4 a[76:79], v8, s[4:7], s24 offen sc1
  s_waitcnt vmcnt(15)
  v_mfma_f32_16x16x32_bf16 v[32:35], a[144:147], a[0:3], v[32:35]
  v_lshl_add_u32 v25, v25, 4, s23
  s_add_u32 s24, s24, 1024
  v_mfma_f32_16x16x32_bf16 v[36:39], a[148:151], a[0:3], v[36:39]
  v_mul_u32_u24 v24, 2560, v24
  v_mfma_f32_16x16x32_bf16 v[40:43], a[152:155], a[0:3], v[40:43]
  s_add_u32 s58, s59, s21
  s_cmp_eq_u32 s24, s19
  s_cselect_b32 s24, s18, s24
  s_cselect_b32 s6, s68, s14
  v_mfma_f32_16x16x32_bf16 v[44:47], a[156:159], a[0:3], v[44:47]
  buffer_load_dwordx4 a[0:3], v4, s[4:7], s24 offen sc1
  v_mfma_f32_16x16x32_bf16 v[48:51], a[144:147], a[4:7], v[48:51]
  s_and_b32 s59, s58, 1
  v_mfma_f32_16x16x32_bf16 v[52:55], a[148:151], a[4:7], v[52:55]
  v_mfma_f32_16x16x32_bf16 v[56:59], a[152:155], a[4:7], v[56:59]
  s_lshr_b32 s58, s58, 1
  v_mfma_f32_16x16x32_bf16 v[60:63], a[156:159], a[4:7], v[60:63]
  buffer_load_dwordx4 a[4:7], v5, s[4:7], s24 offen sc1
  v_mfma_f32_16x16x32_bf16 v[64:67], a[144:147], a[8:11], v[64:67]
  s_lshl_b32 s58, s58, 5
  v_mfma_f32_16x16x32_bf16 v[68:71], a[148:151], a[8:11], v[68:71]
  s_add_u32 s58, s58, s59
  v_mfma_f32_16x16x32_bf16 v[72:75], a[152:155], a[8:11], v[72:75]
  s_mul_i32 s58, s58, 1280
  v_mfma_f32_16x16x32_bf16 v[76:79], a[156:159], a[8:11], v[76:79]
  buffer_load_dwordx4 a[8:11], v6, s[4:7], s24 offen sc1
  v_mfma_f32_16x16x32_bf16 v[80:83], a[144:147], a[12:15], v[80:83]
  v_mfma_f32_16x16x32_bf16 v[84:87], a[148:151], a[12:15], v[84:87]
  v_add3_u32 v180, v24, v25, s58
  v_mfma_f32_16x16x32_bf16 v[88:91], a[152:155], a[12:15], v[88:91]
  s_lshl_b32 s63, s21, 6
  v_mfma_f32_16x16x32_bf16 v[92:95], a[156:159], a[12:15], v[92:95]
  buffer_load_dwordx4 a[12:15], v7, s[4:7], s24 offen sc1
  v_mfma_f32_16x16x32_bf16 v[108:111], a[144:147], a[16:19], v[108:111]
  s_add_u32 s63, s63, 10485760
  v_mfma_f32_16x16x32_bf16 v[112:115], a[148:151], a[16:19], v[112:115]
  v_lshlrev_b32 v22, 2, v3
  v_mfma_f32_16x16x32_bf16 v[116:119], a[152:155], a[16:19], v[116:119]
  v_mfma_f32_16x16x32_bf16 v[120:123], a[156:159], a[16:19], v[120:123]
  buffer_load_dwordx4 a[16:19], v8, s[4:7], s24 offen sc1
  s_waitcnt vmcnt(15)
  v_mfma_f32_16x16x32_bf16 v[32:35], a[160:163], a[20:23], v[32:35]
  ds_read_b64_tr_b16 a[80:81], v96 offset:28672
  s_add_u32 s24, s24, 1024
  v_mfma_f32_16x16x32_bf16 v[36:39], a[164:167], a[20:23], v[36:39]
  ds_read_b64_tr_b16 a[82:83], v96 offset:30720
  v_mfma_f32_16x16x32_bf16 v[40:43], a[168:171], a[20:23], v[40:43]
  ds_read_b64_tr_b16 a[84:85], v97 offset:28672
  s_cmp_eq_u32 s24, s19
  s_cselect_b32 s24, s18, s24
  s_cselect_b32 s6, s68, s14
  v_mfma_f32_16x16x32_bf16 v[44:47], a[172:175], a[20:23], v[44:47]
  buffer_load_dwordx4 a[20:23], v4, s[4:7], s24 offen sc1
  v_mfma_f32_16x16x32_bf16 v[48:51], a[160:163], a[24:27], v[48:51]
  ds_read_b64_tr_b16 a[86:87], v97 offset:30720
  v_mfma_f32_16x16x32_bf16 v[52:55], a[164:167], a[24:27], v[52:55]
  v_mfma_f32_16x16x32_bf16 v[56:59], a[168:171], a[24:27], v[56:59]
  ds_read_b64_tr_b16 a[88:89], v98 offset:28672
  v_mfma_f32_16x16x32_bf16 v[60:63], a[172:175], a[24:27], v[60:63]
  buffer_load_dwordx4 a[24:27], v5, s[4:7], s24 offen sc1
  v_mfma_f32_16x16x32_bf16 v[64:67], a[160:163], a[28:31], v[64:67]
  ds_read_b64_tr_b16 a[90:91], v98 offset:30720
  v_mfma_f32_16x16x32_bf16 v[68:71], a[164:167], a[28:31], v[68:71]
  ds_read_b64_tr_b16 a[92:93], v99 offset:28672
  v_mfma_f32_16x16x32_bf16 v[72:75], a[168:171], a[28:31], v[72:75]
  ds_read_b64_tr_b16 a[94:95], v99 offset:30720
  v_mfma_f32_16x16x32_bf16 v[76:79], a[172:175], a[28:31], v[76:79]
  buffer_load_dwordx4 a[28:31], v6, s[4:7], s24 offen sc1
  v_mfma_f32_16x16x32_bf16 v[80:83], a[160:163], a[32:35], v[80:83]
  v_mfma_f32_16x16x32_bf16 v[84:87], a[164:167], a[32:35], v[84:87]
  v_mfma_f32_16x16x32_bf16 v[88:91], a[168:171], a[32:35], v[88:91]
  v_mfma_f32_16x16x32_bf16 v[92:95], a[172:175], a[32:35], v[92:95]
  buffer_load_dwordx4 a[32:35], v7, s[4:7], s24 offen sc1
  v_mfma_f32_16x16x32_bf16 v[108:111], a[160:163], a[36:39], v[108:111]
  v_mfma_f32_16x16x32_bf16 v[112:115], a[164:167], a[36:39], v[112:115]
  v_mfma_f32_16x16x32_bf16 v[116:119], a[168:171], a[36:39], v[116:119]
  v_mfma_f32_16x16x32_bf16 v[120:123], a[172:175], a[36:39], v[120:123]
  buffer_load_dwordx4 a[36:39], v8, s[4:7], s24 offen sc1
  s_waitcnt vmcnt(15)
  v_mfma_f32_16x16x32_bf16 v[32:35], a[176:179], a[40:43], v[32:35]
  ds_read_b64_tr_b16 a[96:97], v96 offset:32768
  s_add_u32 s24, s24, 1024
  v_mfma_f32_16x16x32_bf16 v[36:39], a[180:183], a[40:43], v[36:39]
  ds_read_b64_tr_b16 a[98:99], v96 offset:34816
  v_mfma_f32_16x16x32_bf16 v[40:43], a[184:187], a[40:43], v[40:43]
  ds_read_b64_tr_b16 a[100:101], v97 offset:32768
  s_cmp_eq_u32 s24, s19
  s_cselect_b32 s24, s18, s24
  s_cselect_b32 s6, s68, s14
  v_mfma_f32_16x16x32_bf16 v[44:47], a[188:191], a[40:43], v[44:47]
  buffer_load_dwordx4 a[40:43], v4, s[4:7], s24 offen sc1
  v_mfma_f32_16x16x32_bf16 v[48:51], a[176:179], a[44:47], v[48:51]
  ds_read_b64_tr_b16 a[102:103], v97 offset:34816
  v_mfma_f32_16x16x32_bf16 v[52:55], a[180:183], a[44:47], v[52:55]
  v_mfma_f32_16x16x32_bf16 v[56:59], a[184:187], a[44:47], v[56:59]
  ds_read_b64_tr_b16 a[104:105], v98 offset:32768
  v_mfma_f32_16x16x32_bf16 v[60:63], a[188:191], a[44:47], v[60:63]
  buffer_load_dwordx4 a[44:47], v5, s[4:7], s24 offen sc1
  v_mfma_f32_16x16x32_bf16 v[64:67], a[176:179], a[48:51], v[64:67]
  ds_read_b64_tr_b16 a[106:107], v98 offset:34816
  v_mfma_f32_16x16x32_bf16 v[68:71], a[180:183], a[48:51], v[68:71]
  ds_read_b64_tr_b16 a[108:109], v99 offset:32768
  v_mfma_f32_16x16x32_bf16 v[72:75], a[184:187], a[48:51], v[72:75]
  ds_read_b64_tr_b16 a[110:111], v99 offset:34816
  v_mfma_f32_16x16x32_bf16 v[76:79], a[188:191], a[48:51], v[76:79]
  buffer_load_dwordx4 a[48:51], v6, s[4:7], s24 offen sc1
  v_mfma_f32_16x16x32_bf16 v[80:83], a[176:179], a[52:55], v[80:83]
  v_mfma_f32_16x16x32_bf16 v[84:87], a[180:183], a[52:55], v[84:87]
  v_mfma_f32_16x16x32_bf16 v[88:91], a[184:187], a[52:55], v[88:91]
  v_mfma_f32_16x16x32_bf16 v[92:95], a[188:191], a[52:55], v[92:95]
  buffer_load_dwordx4 a[52:55], v7, s[4:7], s24 offen sc1
  v_mfma_f32_16x16x32_bf16 v[108:111], a[176:179], a[56:59], v[108:111]
  v_mfma_f32_16x16x32_bf16 v[112:115], a[180:183], a[56:59], v[112:115]
  v_mfma_f32_16x16x32_bf16 v[116:119], a[184:187], a[56:59], v[116:119]
  v_mfma_f32_16x16x32_bf16 v[120:123], a[188:191], a[56:59], v[120:123]
  buffer_load_dwordx4 a[56:59], v8, s[4:7], s24 offen sc1
  s_waitcnt vmcnt(15)
  v_mfma_f32_16x16x32_bf16 v[32:35], a[192:195], a[60:63], v[32:35]
  ds_read_b64_tr_b16 a[112:113], v96 offset:0
  s_add_u32 s24, s24, 1024
  v_mfma_f32_16x16x32_bf16 v[36:39], a[196:199], a[60:63], v[36:39]
  ds_read_b64_tr_b16 a[114:115], v96 offset:2048
  v_mfma_f32_16x16x32_bf16 v[40:43], a[200:203], a[60:63], v[40:43]
  ds_read_b64_tr_b16 a[116:117], v97 offset:0
  s_cmp_eq_u32 s24, s19
  s_cselect_b32 s24, s18, s24
  s_cselect_b32 s6, s68, s14
  v_mfma_f32_16x16x32_bf16 v[44:47], a[204:207], a[60:63], v[44:47]
  buffer_load_dwordx4 a[60:63], v4, s[4:7], s24 offen sc1
  v_mfma_f32_16x16x32_bf16 v[48:51], a[192:195], a[64:67], v[48:51]
  ds_read_b64_tr_b16 a[118:119], v97 offset:2048
  v_mfma_f32_16x16x32_bf16 v[52:55], a[196:199], a[64:67], v[52:55]
  v_mfma_f32_16x16x32_bf16 v[56:59], a[200:203], a[64:67], v[56:59]
  ds_read_b64_tr_b16 a[120:121], v98 offset:0
  v_mfma_f32_16x16x32_bf16 v[60:63], a[204:207], a[64:67], v[60:63]
  buffer_load_dwordx4 a[64:67], v5, s[4:7], s24 offen sc1
  v_mfma_f32_16x16x32_bf16 v[64:67], a[192:195], a[68:71], v[64:67]
  ds_read_b64_tr_b16 a[122:123], v98 offset:2048
  v_mfma_f32_16x16x32_bf16 v[68:71], a[196:199], a[68:71], v[68:71]
  ds_read_b64_tr_b16 a[124:125], v99 offset:0
  v_mfma_f32_16x16x32_bf16 v[72:75], a[200:203], a[68:71], v[72:75]
  ds_read_b64_tr_b16 a[126:127], v99 offset:2048
  v_mfma_f32_16x16x32_bf16 v[76:79], a[204:207], a[68:71], v[76:79]
  buffer_load_dwordx4 a[68:71], v6, s[4:7], s24 offen sc1
  v_mfma_f32_16x16x32_bf16 v[80:83], a[192:195], a[72:75], v[80:83]
  v_mfma_f32_16x16x32_bf16 v[84:87], a[196:199], a[72:75], v[84:87]
  v_mfma_f32_16x16x32_bf16 v[88:91], a[200:203], a[72:75], v[88:91]
  v_mfma_f32_16x16x32_bf16 v[92:95], a[204:207], a[72:75], v[92:95]
  buffer_load_dwordx4 a[72:75], v7, s[4:7], s24 offen sc1
  v_mfma_f32_16x16x32_bf16 v[108:111], a[192:195], a[76:79], v[108:111]
  v_mfma_f32_16x16x32_bf16 v[112:115], a[196:199], a[76:79], v[112:115]
  v_mfma_f32_16x16x32_bf16 v[116:119], a[200:203], a[76:79], v[116:119]
  v_mfma_f32_16x16x32_bf16 v[120:123], a[204:207], a[76:79], v[120:123]
  buffer_load_dwordx4 a[76:79], v8, s[4:7], s24 offen sc1
  s_waitcnt vmcnt(15)
  v_mfma_f32_16x16x32_bf16 v[32:35], a[208:211], a[0:3], v[32:35]
  ds_read_b64_tr_b16 a[240:241], v96 offset:36864
  ds_read_b64_tr_b16 a[242:243], v96 offset:38912
  s_add_u32 s24, s24, 1024
  v_mfma_f32_16x16x32_bf16 v[36:39], a[212:215], a[0:3], v[36:39]
  ds_read_b64_tr_b16 a[244:245], v97 offset:36864
  s_mov_b32 exec_lo, 4294901760
  s_mov_b32 exec_hi, 65535
  buffer_load_dword v23, v104, s[12:15], 0 offen sc1
  s_mov_b64 exec, -1
  v_mfma_f32_16x16x32_bf16 v[40:43], a[216:219], a[0:3], v[40:43]
  ds_read_b64_tr_b16 a[246:247], v97 offset:38912
  s_cmp_eq_u32 s24, s19
  s_cselect_b32 s24, s18, s24
  s_cselect_b32 s6, s68, s14
  v_mfma_f32_16x16x32_bf16 v[44:47], a[220:223], a[0:3], v[44:47]
  buffer_load_dwordx4 a[0:3], v4, s[4:7], s24 offen sc1
  v_mfma_f32_16x16x32_bf16 v[48:51], a[208:211], a[4:7], v[48:51]
  ds_read_b64_tr_b16 a[248:249], v98 offset:36864
  v_mfma_f32_16x16x32_bf16 v[52:55], a[212:215], a[4:7], v[52:55]
  ds_read_b64_tr_b16 a[250:251], v98 offset:38912
  v_mfma_f32_16x16x32_bf16 v[56:59], a[216:219], a[4:7], v[56:59]
  ds_read_b64_tr_b16 a[252:253], v99 offset:36864
  v_mfma_f32_16x16x32_bf16 v[60:63], a[220:223], a[4:7], v[60:63]
  buffer_load_dwordx4 a[4:7], v5, s[4:7], s24 offen sc1
  v_mfma_f32_16x16x32_bf16 v[64:67], a[208:211], a[8:11], v[64:67]
  ds_read_b64_tr_b16 a[254:255], v99 offset:38912
  v_mfma_f32_16x16x32_bf16 v[68:71], a[212:215], a[8:11], v[68:71]
  ds_read_b64_tr_b16 a[128:129], v96 offset:4096
  v_mfma_f32_16x16x32_bf16 v[72:75], a[216:219], a[8:11], v[72:75]
  ds_read_b64_tr_b16 a[130:131], v96 offset:6144
  v_mfma_f32_16x16x32_bf16 v[76:79], a[220:223], a[8:11], v[76:79]
  buffer_load_dwordx4 a[8:11], v6, s[4:7], s24 offen sc1
  v_mfma_f32_16x16x32_bf16 v[80:83], a[208:211], a[12:15], v[80:83]
  ds_read_b64_tr_b16 a[132:133], v97 offset:4096
  v_mfma_f32_16x16x32_bf16 v[84:87], a[212:215], a[12:15], v[84:87]
  ds_read_b64_tr_b16 a[134:135], v97 offset:6144
  v_mfma_f32_16x16x32_bf16 v[88:91], a[216:219], a[12:15], v[88:91]
  ds_read_b64_tr_b16 a[136:137], v98 offset:4096
  v_mfma_f32_16x16x32_bf16 v[92:95], a[220:223], a[12:15], v[92:95]
  buffer_load_dwordx4 a[12:15], v7, s[4:7], s24 offen sc1
  v_mfma_f32_16x16x32_bf16 v[108:111], a[208:211], a[16:19], v[108:111]
  ds_read_b64_tr_b16 a[138:139], v98 offset:6144
  v_mfma_f32_16x16x32_bf16 v[112:115], a[212:215], a[16:19], v[112:115]
  ds_read_b64_tr_b16 a[140:141], v99 offset:4096
  v_mfma_f32_16x16x32_bf16 v[116:119], a[216:219], a[16:19], v[116:119]
  ds_read_b64_tr_b16 a[142:143], v99 offset:6144
  v_mfma_f32_16x16x32_bf16 v[120:123], a[220:223], a[16:19], v[120:123]
  buffer_load_dwordx4 a[16:19], v8, s[4:7], s24 offen sc1
  s_waitcnt vmcnt(16) lgkmcnt(0)
  v_mfma_f32_16x16x32_bf16 v[32:35], a[240:243], a[20:23], v[32:35]
  ds_read_b64_tr_b16 a[224:225], v96 offset:12288
  ds_read_b64_tr_b16 a[226:227], v96 offset:14336
  s_add_u32 s24, s24, 1024
  v_mfma_f32_16x16x32_bf16 v[36:39], a[244:247], a[20:23], v[36:39]
  ds_read_b64_tr_b16 a[228:229], v97 offset:12288
  v_mfma_f32_16x16x32_bf16 v[40:43], a[248:251], a[20:23], v[40:43]
  ds_read_b64_tr_b16 a[230:231], v97 offset:14336
  s_cmp_eq_u32 s24, s19
  s_cselect_b32 s24, s18, s24
  s_cselect_b32 s6, s68, s14
  v_mfma_f32_16x16x32_bf16 v[44:47], a[252:255], a[20:23], v[44:47]
  buffer_load_dwordx4 a[20:23], v4, s[4:7], s24 offen sc1
  v_mfma_f32_16x16x32_bf16 v[48:51], a[240:243], a[24:27], v[48:51]
  ds_read_b64_tr_b16 a[232:233], v98 offset:12288
  v_mfma_f32_16x16x32_bf16 v[52:55], a[244:247], a[24:27], v[52:55]
  ds_read_b64_tr_b16 a[234:235], v98 offset:14336
  v_mfma_f32_16x16x32_bf16 v[56:59], a[248:251], a[24:27], v[56:59]
  ds_read_b64_tr_b16 a[236:237], v99 offset:12288
  v_mfma_f32_16x16x32_bf16 v[60:63], a[252:255], a[24:27], v[60:63]
  buffer_load_dwordx4 a[24:27], v5, s[4:7], s24 offen sc1
  v_mfma_f32_16x16x32_bf16 v[64:67], a[240:243], a[28:31], v[64:67]
  ds_read_b64_tr_b16 a[238:239], v99 offset:14336
  v_mfma_f32_16x16x32_bf16 v[68:71], a[244:247], a[28:31], v[68:71]
  ds_read_b64_tr_b16 a[144:145], v96 offset:8192
  v_mfma_f32_16x16x32_bf16 v[72:75], a[248:251], a[28:31], v[72:75]
  ds_read_b64_tr_b16 a[146:147], v96 offset:10240
  v_mfma_f32_16x16x32_bf16 v[76:79], a[252:255], a[28:31], v[76:79]
  buffer_load_dwordx4 a[28:31], v6, s[4:7], s24 offen sc1
  v_mfma_f32_16x16x32_bf16 v[80:83], a[240:243], a[32:35], v[80:83]
  ds_read_b64_tr_b16 a[148:149], v97 offset:8192
  v_mfma_f32_16x16x32_bf16 v[84:87], a[244:247], a[32:35], v[84:87]
  ds_read_b64_tr_b16 a[150:151], v97 offset:10240
  v_mfma_f32_16x16x32_bf16 v[88:91], a[248:251], a[32:35], v[88:91]
  ds_read_b64_tr_b16 a[152:153], v98 offset:8192
  v_mfma_f32_16x16x32_bf16 v[92:95], a[252:255], a[32:35], v[92:95]
  buffer_load_dwordx4 a[32:35], v7, s[4:7], s24 offen sc1
  v_mfma_f32_16x16x32_bf16 v[108:111], a[240:243], a[36:39], v[108:111]
  ds_read_b64_tr_b16 a[154:155], v98 offset:10240
  v_mfma_f32_16x16x32_bf16 v[112:115], a[244:247], a[36:39], v[112:115]
  ds_read_b64_tr_b16 a[156:157], v99 offset:8192
  v_mfma_f32_16x16x32_bf16 v[116:119], a[248:251], a[36:39], v[116:119]
  ds_read_b64_tr_b16 a[158:159], v99 offset:10240
  v_mfma_f32_16x16x32_bf16 v[120:123], a[252:255], a[36:39], v[120:123]
  buffer_load_dwordx4 a[36:39], v8, s[4:7], s24 offen sc1
  s_waitcnt vmcnt(10) lgkmcnt(0)
  v_and_b32 v23, 1, v23
  v_cmp_ne_u32 vcc, v23, v105
  s_nop 0
  s_and_b32 vcc_lo, vcc_lo, 4294901760
  s_and_b32 vcc_hi, vcc_hi, 65535
  s_cbranch_vccz LpoF5ok
  s_mov_b32 exec_lo, 4294901760
  s_mov_b32 exec_hi, 65535
  s_mov_b32 s35, 0x20000
LpoF5:
  buffer_load_dword v23, v104, s[12:15], 0 offen sc1
  s_sub_u32 s35, s35, 1
  s_waitcnt vmcnt(0)
  v_and_b32 v23, 1, v23
  v_cmp_ne_u32 vcc, v23, v105
  s_cmp_eq_u32 s35, 0
  s_cbranch_scc1 LpoF5x
  s_cbranch_vccnz LpoF5
LpoF5x:
  s_mov_b64 exec, -1
LpoF5ok:
  v_mfma_f32_16x16x32_bf16 v[32:35], a[224:227], a[40:43], v[32:35]
  ds_read_b64_tr_b16 a[240:241], v96 offset:16384
  v_mfma_f32_16x16x32_bf16 v[36:39], a[228:231], a[40:43], v[36:39]
  ds_read_b64_tr_b16 a[242:243], v96 offset:18432
  buffer_load_dword v10, v22, s[12:15], s63 offen offset:0 sc1
  v_mfma_f32_16x16x32_bf16 v[40:43], a[232:235], a[40:43], v[40:43]
  ds_read_b64_tr_b16 a[244:245], v97 offset:16384
  v_mfma_f32_16x16x32_bf16 v[44:47], a[236:239], a[40:43], v[44:47]
  buffer_load_dwordx4 a[160:163], v4, s[12:15], s27 offen offset:0 sc1
  v_mfma_f32_16x16x32_bf16 v[48:51], a[224:227], a[44:47], v[48:51]
  ds_read_b64_tr_b16 a[246:247], v97 offset:18432
  v_mfma_f32_16x16x32_bf16 v[52:55], a[228:231], a[44:47], v[52:55]
  buffer_load_dword v11, v22, s[12:15], s63 offen offset:64 sc1
  v_mfma_f32_16x16x32_bf16 v[56:59], a[232:235], a[44:47], v[56:59]
  ds_read_b64_tr_b16 a[248:249], v98 offset:16384
  v_mfma_f32_16x16x32_bf16 v[60:63], a[236:239], a[44:47], v[60:63]
  buffer_load_dwordx4 a[164:167], v4, s[12:15], s27 offen offset:1024 sc1
  v_mfma_f32_16x16x32_bf16 v[64:67], a[224:227], a[48:51], v[64:67]
  ds_read_b64_tr_b16 a[250:251], v98 offset:18432
  v_mfma_f32_16x16x32_bf16 v[68:71], a[228:231], a[48:51], v[68:71]
  ds_read_b64_tr_b16 a[252:253], v99 offset:16384
  buffer_load_dword v12, v22, s[12:15], s63 offen offset:128 sc1
  v_mfma_f32_16x16x32_bf16 v[72:75], a[232:235], a[48:51], v[72:75]
  ds_read_b64_tr_b16 a[254:255], v99 offset:18432
  v_mfma_f32_16x16x32_bf16 v[76:79], a[236:239], a[48:51], v[76:79]
  buffer_load_dwordx4 a[168:171], v4, s[12:15], s27 offen offset:2048 sc1
  v_mfma_f32_16x16x32_bf16 v[80:83], a[224:227], a[52:55], v[80:83]
  v_mfma_f32_16x16x32_bf16 v[84:87], a[228:231], a[52:55], v[84:87]
  buffer_load_dword v13, v22, s[12:15], s63 offen offset:192 sc1
  v_mfma_f32_16x16x32_bf16 v[88:91], a[232:235], a[52:55], v[88:91]
  v_mfma_f32_16x16x32_bf16 v[92:95], a[236:239], a[52:55], v[92:95]
  buffer_load_dwordx4 a[172:175], v4, s[12:15], s27 offen offset:3072 sc1
  v_mfma_f32_16x16x32_bf16 v[108:111], a[224:227], a[56:59], v[108:111]
  v_mfma_f32_16x16x32_bf16 v[112:115], a[228:231], a[56:59], v[112:115]
  buffer_load_dword v14, v22, s[12:15], s63 offen offset:256 sc1
  v_mfma_f32_16x16x32_bf16 v[116:119], a[232:235], a[56:59], v[116:119]
  v_mfma_f32_16x16x32_bf16 v[120:123], a[236:239], a[56:59], v[120:123]
  buffer_load_dwordx4 a[176:179], v4, s[12:15], s28 offen offset:0 sc1
  s_waitcnt vmcnt(21) lgkmcnt(0)
  v_mfma_f32_16x16x32_bf16 v[32:35], a[240:243], a[60:63], v[32:35]
  ds_read_b64_tr_b16 a[224:225], v96 offset:20480
  v_mfma_f32_16x16x32_bf16 v[36:39], a[244:247], a[60:63], v[36:39]
  ds_read_b64_tr_b16 a[226:227], v96 offset:22528
  v_mfma_f32_16x16x32_bf16 v[40:43], a[248:251], a[60:63], v[40:43]
  ds_read_b64_tr_b16 a[228:229], v97 offset:20480
  v_mfma_f32_16x16x32_bf16 v[44:47], a[252:255], a[60:63], v[44:47]
  buffer_load_dwordx4 a[180:183], v5, s[12:15], s27 offen offset:0 sc1
  v_mfma_f32_16x16x32_bf16 v[48:51], a[240:243], a[64:67], v[48:51]
  ds_read_b64_tr_b16 a[230:231], v97 offset:22528
  v_mfma_f32_16x16x32_bf16 v[52:55], a[244:247], a[64:67], v[52:55]
  v_mfma_f32_16x16x32_bf16 v[56:59], a[248:251], a[64:67], v[56:59]
  ds_read_b64_tr_b16 a[232:233], v98 offset:20480
  v_mfma_f32_16x16x32_bf16 v[60:63], a[252:255], a[64:67], v[60:63]
  buffer_load_dwordx4 a[184:187], v5, s[12:15], s27 offen offset:1024 sc1
  v_mfma_f32_16x16x32_bf16 v[64:67], a[240:243], a[68:71], v[64:67]
  ds_read_b64_tr_b16 a[234:235], v98 offset:22528
  v_mfma_f32_16x16x32_bf16 v[68:71], a[244:247], a[68:71], v[68:71]
  ds_read_b64_tr_b16 a[236:237], v99 offset:20480
  v_mfma_f32_16x16x32_bf16 v[72:75], a[248:251], a[68:71], v[72:75]
  ds_read_b64_tr_b16 a[238:239], v99 offset:22528
  v_mfma_f32_16x16x32_bf16 v[76:79], a[252:255], a[68:71], v[76:79]
  buffer_load_dwordx4 a[188:191], v5, s[12:15], s27 offen offset:2048 sc1
  v_mfma_f32_16x16x32_bf16 v[80:83], a[240:243], a[72:75], v[80:83]
  v_mfma_f32_16x16x32_bf16 v[84:87], a[244:247], a[72:75], v[84:87]
  v_mfma_f32_16x16x32_bf16 v[88:91], a[248:251], a[72:75], v[88:91]
  v_mfma_f32_16x16x32_bf16 v[92:95], a[252:255], a[72:75], v[92:95]
  buffer_load_dwordx4 a[192:195], v5, s[12:15], s27 offen offset:3072 sc1
  v_mfma_f32_16x16x32_bf16 v[108:111], a[240:243], a[76:79], v[108:111]
  v_mfma_f32_16x16x32_bf16 v[112:115], a[244:247], a[76:79], v[112:115]
  v_mfma_f32_16x16x32_bf16 v[116:119], a[248:251], a[76:79], v[116:119]
  v_mfma_f32_16x16x32_bf16 v[120:123], a[252:255], a[76:79], v[120:123]
  buffer_load_dwordx4 a[196:199], v5, s[12:15], s28 offen offset:0 sc1
  s_waitcnt vmcnt(20) lgkmcnt(0)
  v_mfma_f32_16x16x32_bf16 v[32:35], a[224:227], a[0:3], v[32:35]
  ds_read_b64_tr_b16 a[240:241], v96 offset:24576
  v_mfma_f32_16x16x32_bf16 v[36:39], a[228:231], a[0:3], v[36:39]
  ds_read_b64_tr_b16 a[242:243], v96 offset:26624
  v_mfma_f32_16x16x32_bf16 v[40:43], a[232:235], a[0:3], v[40:43]
  ds_read_b64_tr_b16 a[244:245], v97 offset:24576
  v_mfma_f32_16x16x32_bf16 v[44:47], a[236:239], a[0:3], v[44:47]
  buffer_load_dwordx4 a[200:203], v6, s[12:15], s27 offen offset:0 sc1
  v_mfma_f32_16x16x32_bf16 v[48:51], a[224:227], a[4:7], v[48:51]
  ds_read_b64_tr_b16 a[246:247], v97 offset:26624
  v_mfma_f32_16x16x32_bf16 v[52:55], a[228:231], a[4:7], v[52:55]
  v_mfma_f32_16x16x32_bf16 v[56:59], a[232:235], a[4:7], v[56:59]
  ds_read_b64_tr_b16 a[248:249], v98 offset:24576
  v_mfma_f32_16x16x32_bf16 v[60:63], a[236:239], a[4:7], v[60:63]
  buffer_load_dwordx4 a[204:207], v6, s[12:15], s27 offen offset:1024 sc1
  v_mfma_f32_16x16x32_bf16 v[64:67], a[224:227], a[8:11], v[64:67]
  ds_read_b64_tr_b16 a[250:251], v98 offset:26624
  v_mfma_f32_16x16x32_bf16 v[68:71], a[228:231], a[8:11], v[68:71]
  ds_read_b64_tr_b16 a[252:253], v99 offset:24576
  v_mfma_f32_16x16x32_bf16 v[72:75], a[232:235], a[8:11], v[72:75]
  ds_read_b64_tr_b16 a[254:255], v99 offset:26624
  v_mfma_f32_16x16x32_bf16 v[76:79], a[236:239], a[8:11], v[76:79]
  buffer_load_dwordx4 a[208:211], v6, s[12:15], s27 offen offset:2048 sc1
  v_mfma_f32_16x16x32_bf16 v[80:83], a[224:227], a[12:15], v[80:83]
  v_mfma_f32_16x16x32_bf16 v[84:87], a[228:231], a[12:15], v[84:87]
  v_mfma_f32_16x16x32_bf16 v[88:91], a[232:235], a[12:15], v[88:91]
  v_mfma_f32_16x16x32_bf16 v[92:95], a[236:239], a[12:15], v[92:95]
  buffer_load_dwordx4 a[212:215], v6, s[12:15], s27 offen offset:3072 sc1
  v_mfma_f32_16x16x32_bf16 v[108:111], a[224:227], a[16:19], v[108:111]
  v_mfma_f32_16x16x32_bf16 v[112:115], a[228:231], a[16:19], v[112:115]
  v_mfma_f32_16x16x32_bf16 v[116:119], a[232:235], a[16:19], v[116:119]
  v_mfma_f32_16x16x32_bf16 v[120:123], a[236:239], a[16:19], v[120:123]
  buffer_load_dwordx4 a[216:219], v6, s[12:15], s28 offen offset:0 sc1
  s_waitcnt vmcnt(11) lgkmcnt(0)
  v_mfma_f32_16x16x32_bf16 v[32:35], a[240:243], a[20:23], v[32:35]
  v_mfma_f32_16x16x32_bf16 v[36:39], a[244:247], a[20:23], v[36:39]
  v_sub_f32 v16, 1.0, v10
  v_mfma_f32_16x16x32_bf16 v[40:43], a[248:251], a[20:23], v[40:43]
  v_mfma_f32_16x16x32_bf16 v[44:47], a[252:255], a[20:23], v[44:47]
  buffer_load_dwordx4 a[220:223], v7, s[12:15], s27 offen offset:0 sc1
  v_mfma_f32_16x16x32_bf16 v[48:51], a[240:243], a[24:27], v[48:51]
  v_mfma_f32_16x16x32_bf16 v[52:55], a[244:247], a[24:27], v[52:55]
  v_sub_f32 v17, 1.0, v11
  v_mfma_f32_16x16x32_bf16 v[56:59], a[248:251], a[24:27], v[56:59]
  v_mfma_f32_16x16x32_bf16 v[60:63], a[252:255], a[24:27], v[60:63]
  buffer_load_dwordx4 a[40:43], v7, s[12:15], s27 offen offset:1024 sc1
  v_mfma_f32_16x16x32_bf16 v[64:67], a[240:243], a[28:31], v[64:67]
  v_mfma_f32_16x16x32_bf16 v[68:71], a[244:247], a[28:31], v[68:71]
  v_sub_f32 v18, 1.0, v12
  v_mfma_f32_16x16x32_bf16 v[72:75], a[248:251], a[28:31], v[72:75]
  v_mfma_f32_16x16x32_bf16 v[76:79], a[252:255], a[28:31], v[76:79]
  buffer_load_dwordx4 a[44:47], v7, s[12:15], s27 offen offset:2048 sc1
  v_mfma_f32_16x16x32_bf16 v[80:83], a[240:243], a[32:35], v[80:83]
  v_mfma_f32_16x16x32_bf16 v[84:87], a[244:247], a[32:35], v[84:87]
  v_sub_f32 v19, 1.0, v13
  v_mfma_f32_16x16x32_bf16 v[88:91], a[248:251], a[32:35], v[88:91]
  v_mfma_f32_16x16x32_bf16 v[92:95], a[252:255], a[32:35], v[92:95]
  buffer_load_dwordx4 a[48:51], v7, s[12:15], s27 offen offset:3072 sc1
  v_mfma_f32_16x16x32_bf16 v[108:111], a[240:243], a[36:39], v[108:111]
  v_mfma_f32_16x16x32_bf16 v[112:115], a[244:247], a[36:39], v[112:115]
  v_sub_f32 v20, 1.0, v14
  v_mfma_f32_16x16x32_bf16 v[116:119], a[248:251], a[36:39], v[116:119]
  v_mfma_f32_16x16x32_bf16 v[120:123], a[252:255], a[36:39], v[120:123]
  buffer_load_dwordx4 a[52:55], v7, s[12:15], s28 offen offset:0 sc1
  s_waitcnt vmcnt(15) lgkmcnt(0)
  v_mfma_f32_16x16x32_bf16 v[140:143], a[80:83], a[160:163], 0
  buffer_load_dwordx4 a[56:59], v8, s[12:15], s27 offen offset:0 sc1
  v_mfma_f32_16x16x32_bf16 v[144:147], a[84:87], a[160:163], 0
  v_mfma_f32_16x16x32_bf16 v[148:151], a[88:91], a[160:163], 0
  buffer_load_dwordx4 a[60:63], v8, s[12:15], s27 offen offset:1024 sc1
  v_mfma_f32_16x16x32_bf16 v[152:155], a[92:95], a[160:163], 0
  v_mfma_f32_16x16x32_bf16 v[140:143], a[96:99], a[164:167], v[140:143]
  buffer_load_dwordx4 a[64:67], v8, s[12:15], s27 offen offset:2048 sc1
  v_mul_f32 v32, v16, v32
  v_mfma_f32_16x16x32_bf16 v[144:147], a[100:103], a[164:167], v[144:147]
  v_mul_f32 v33, v16, v33
  v_mfma_f32_16x16x32_bf16 v[148:151], a[104:107], a[164:167], v[148:151]
  buffer_load_dwordx4 a[68:71], v8, s[12:15], s27 offen offset:3072 sc1
  v_mul_f32 v34, v16, v34
  v_mfma_f32_16x16x32_bf16 v[152:155], a[108:111], a[164:167], v[152:155]
  v_mul_f32 v35, v16, v35
  v_mfma_f32_16x16x32_bf16 v[140:143], a[112:115], a[168:171], v[140:143]
  buffer_load_dwordx4 a[72:75], v8, s[12:15], s28 offen offset:0 sc1
  v_mul_f32 v36, v16, v36
  v_mfma_f32_16x16x32_bf16 v[144:147], a[116:119], a[168:171], v[144:147]
  v_mul_f32 v37, v16, v37
  v_mfma_f32_16x16x32_bf16 v[148:151], a[120:123], a[168:171], v[148:151]
  v_mul_f32 v38, v16, v38
  v_mfma_f32_16x16x32_bf16 v[152:155], a[124:127], a[168:171], v[152:155]
  v_mul_f32 v39, v16, v39
  v_mfma_f32_16x16x32_bf16 v[140:143], a[128:131], a[172:175], v[140:143]
  v_mul_f32 v40, v16, v40
  v_mfma_f32_16x16x32_bf16 v[144:147], a[132:135], a[172:175], v[144:147]
  v_mul_f32 v41, v16, v41
  v_mfma_f32_16x16x32_bf16 v[148:151], a[136:139], a[172:175], v[148:151]
  v_mul_f32 v42, v16, v42
  v_mfma_f32_16x16x32_bf16 v[152:155], a[140:143], a[172:175], v[152:155]
  v_mul_f32 v43, v16, v43
  v_mfma_f32_16x16x32_bf16 v[140:143], a[144:147], a[176:179], v[140:143]
  v_mul_f32 v44, v16, v44
  v_mfma_f32_16x16x32_bf16 v[144:147], a[148:151], a[176:179], v[144:147]
  v_mul_f32 v45, v16, v45
  v_mfma_f32_16x16x32_bf16 v[148:151], a[152:155], a[176:179], v[148:151]
  v_mul_f32 v46, v16, v46
  v_mfma_f32_16x16x32_bf16 v[152:155], a[156:159], a[176:179], v[152:155]
  v_mul_f32 v47, v16, v47
  s_waitcnt vmcnt(15)
  v_mfma_f32_16x16x32_bf16 v[156:159], a[80:83], a[180:183], 0
  v_mul_f32 v48, v17, v48
  v_mul_f32 v49, v17, v49
  v_mfma_f32_16x16x32_bf16 v[160:163], a[84:87], a[180:183], 0
  v_mul_f32 v50, v17, v50
  v_mul_f32 v51, v17, v51
  v_mfma_f32_16x16x32_bf16 v[164:167], a[88:91], a[180:183], 0
  v_mul_f32 v52, v17, v52
  v_mul_f32 v53, v17, v53
  v_mfma_f32_16x16x32_bf16 v[168:171], a[92:95], a[180:183], 0
  v_fmac_f32 v32, v10, v140
  v_fmac_f32 v33, v10, v141
  v_mfma_f32_16x16x32_bf16 v[156:159], a[96:99], a[184:187], v[156:159]
  v_fmac_f32 v34, v10, v142
  v_fmac_f32 v35, v10, v143
  v_mfma_f32_16x16x32_bf16 v[160:163], a[100:103], a[184:187], v[160:163]
  ds_write_b128 v172, v[32:35] offset:0
  v_fmac_f32 v36, v10, v144
  v_mfma_f32_16x16x32_bf16 v[164:167], a[104:107], a[184:187], v[164:167]
  v_fmac_f32 v37, v10, v145
  v_fmac_f32 v38, v10, v146
  v_mfma_f32_16x16x32_bf16 v[168:171], a[108:111], a[184:187], v[168:171]
  v_fmac_f32 v39, v10, v147
  v_mfma_f32_16x16x32_bf16 v[156:159], a[112:115], a[188:191], v[156:159]
  ds_write_b128 v173, v[36:39] offset:0
  v_fmac_f32 v40, v10, v148
  v_mfma_f32_16x16x32_bf16 v[160:163], a[116:119], a[188:191], v[160:163]
  v_fmac_f32 v41, v10, v149
  v_fmac_f32 v42, v10, v150
  v_mfma_f32_16x16x32_bf16 v[164:167], a[120:123], a[188:191], v[164:167]
  v_fmac_f32 v43, v10, v151
  ds_write_b128 v174, v[40:43] offset:0
  v_mfma_f32_16x16x32_bf16 v[168:171], a[124:127], a[188:191], v[168:171]
  v_fmac_f32 v44, v10, v152
  v_mfma_f32_16x16x32_bf16 v[156:159], a[128:131], a[192:195], v[156:159]
  v_fmac_f32 v45, v10, v153
  v_fmac_f32 v46, v10, v154
  v_mfma_f32_16x16x32_bf16 v[160:163], a[132:135], a[192:195], v[160:163]
  v_fmac_f32 v47, v10, v155
  ds_write_b128 v175, v[44:47] offset:0
  v_mfma_f32_16x16x32_bf16 v[164:167], a[136:139], a[192:195], v[164:167]
  v_mul_f32 v54, v17, v54
  v_mul_f32 v55, v17, v55
  v_mfma_f32_16x16x32_bf16 v[168:171], a[140:143], a[192:195], v[168:171]
  v_mul_f32 v56, v17, v56
  v_mfma_f32_16x16x32_bf16 v[156:159], a[144:147], a[196:199], v[156:159]
  v_mul_f32 v57, v17, v57
  v_mul_f32 v58, v17, v58
  v_mfma_f32_16x16x32_bf16 v[160:163], a[148:151], a[196:199], v[160:163]
  v_mul_f32 v59, v17, v59
  v_mul_f32 v60, v17, v60
  v_mfma_f32_16x16x32_bf16 v[164:167], a[152:155], a[196:199], v[164:167]
  v_mul_f32 v61, v17, v61
  v_mul_f32 v62, v17, v62
  v_mfma_f32_16x16x32_bf16 v[168:171], a[156:159], a[196:199], v[168:171]
  v_mul_f32 v63, v17, v63
  s_waitcnt vmcnt(10)
  v_mfma_f32_16x16x32_bf16 v[140:143], a[80:83], a[200:203], 0
  v_mul_f32 v64, v18, v64
  v_mul_f32 v65, v18, v65
  v_mfma_f32_16x16x32_bf16 v[144:147], a[84:87], a[200:203], 0
  v_mul_f32 v66, v18, v66
  v_mul_f32 v67, v18, v67
  v_mfma_f32_16x16x32_bf16 v[148:151], a[88:91], a[200:203], 0
  v_mul_f32 v68, v18, v68
  v_mul_f32 v69, v18, v69
  v_mfma_f32_16x16x32_bf16 v[152:155], a[92:95], a[200:203], 0
  v_fmac_f32 v48, v11, v156
  v_fmac_f32 v49, v11, v157
  v_mfma_f32_16x16x32_bf16 v[140:143], a[96:99], a[204:207], v[140:143]
  v_fmac_f32 v50, v11, v158
  v_fmac_f32 v51, v11, v159
  v_mfma_f32_16x16x32_bf16 v[144:147], a[100:103], a[204:207], v[144:147]
  ds_write_b128 v172, v[48:51] offset:4096
  v_fmac_f32 v52, v11, v160
  v_mfma_f32_16x16x32_bf16 v[148:151], a[104:107], a[204:207], v[148:151]
  v_fmac_f32 v53, v11, v161
  v_fmac_f32 v54, v11, v162
  v_mfma_f32_16x16x32_bf16 v[152:155], a[108:111], a[204:207], v[152:155]
  v_fmac_f32 v55, v11, v163
  v_mfma_f32_16x16x32_bf16 v[140:143], a[112:115], a[208:211], v[140:143]
  ds_write_b128 v173, v[52:55] offset:4096
  v_fmac_f32 v56, v11, v164
  v_mfma_f32_16x16x32_bf16 v[144:147], a[116:119], a[208:211], v[144:147]
  v_fmac_f32 v57, v11, v165
  v_fmac_f32 v58, v11, v166
  v_mfma_f32_16x16x32_bf16 v[148:151], a[120:123], a[208:211], v[148:151]
  v_fmac_f32 v59, v11, v167
  ds_write_b128 v174, v[56:59] offset:4096
  v_mfma_f32_16x16x32_bf16 v[152:155], a[124:127], a[208:211], v[152:155]
  v_fmac_f32 v60, v11, v168
  v_mfma_f32_16x16x32_bf16 v[140:143], a[128:131], a[212:215], v[140:143]
  v_fmac_f32 v61, v11, v169
  v_fmac_f32 v62, v11, v170
  v_mfma_f32_16x16x32_bf16 v[144:147], a[132:135], a[212:215], v[144:147]
  v_fmac_f32 v63, v11, v171
  ds_write_b128 v175, v[60:63] offset:4096
  v_mfma_f32_16x16x32_bf16 v[148:151], a[136:139], a[212:215], v[148:151]
  v_mul_f32 v70, v18, v70
  v_mul_f32 v71, v18, v71
  v_mfma_f32_16x16x32_bf16 v[152:155], a[140:143], a[212:215], v[152:155]
  v_mul_f32 v72, v18, v72
  v_mfma_f32_16x16x32_bf16 v[140:143], a[144:147], a[216:219], v[140:143]
  v_mul_f32 v73, v18, v73
  v_mul_f32 v74, v18, v74
  v_mfma_f32_16x16x32_bf16 v[144:147], a[148:151], a[216:219], v[144:147]
  v_mul_f32 v75, v18, v75
  v_mul_f32 v76, v18, v76
  v_mfma_f32_16x16x32_bf16 v[148:151], a[152:155], a[216:219], v[148:151]
  v_mul_f32 v77, v18, v77
  v_mul_f32 v78, v18, v78
  v_mfma_f32_16x16x32_bf16 v[152:155], a[156:159], a[216:219], v[152:155]
  v_mul_f32 v79, v18, v79
  s_waitcnt vmcnt(5)
  v_mfma_f32_16x16x32_bf16 v[156:159], a[80:83], a[220:223], 0
  v_mul_f32 v80, v19, v80
  v_mul_f32 v81, v19, v81
  v_mfma_f32_16x16x32_bf16 v[160:163], a[84:87], a[220:223], 0
  v_mul_f32 v82, v19, v82
  v_mul_f32 v83, v19, v83
  v_mfma_f32_16x16x32_bf16 v[164:167], a[88:91], a[220:223], 0
  v_mul_f32 v84, v19, v84
  v_mul_f32 v85, v19, v85
  v_mfma_f32_16x16x32_bf16 v[168:171], a[92:95], a[220:223], 0
  v_fmac_f32 v64, v12, v140
  v_fmac_f32 v65, v12, v141
  v_mfma_f32_16x16x32_bf16 v[156:159], a[96:99], a[40:43], v[156:159]
  v_fmac_f32 v66, v12, v142
  v_fmac_f32 v67, v12, v143
  v_mfma_f32_16x16x32_bf16 v[160:163], a[100:103], a[40:43], v[160:163]
  ds_write_b128 v172, v[64:67] offset:8192
  v_fmac_f32 v68, v12, v144
  v_mfma_f32_16x16x32_bf16 v[164:167], a[104:107], a[40:43], v[164:167]
  v_fmac_f32 v69, v12, v145
  v_fmac_f32 v70, v12, v146
  v_mfma_f32_16x16x32_bf16 v[168:171], a[108:111], a[40:43], v[168:171]
  v_fmac_f32 v71, v12, v147
  v_mfma_f32_16x16x32_bf16 v[156:159], a[112:115], a[44:47], v[156:159]
  ds_write_b128 v173, v[68:71] offset:8192
  v_fmac_f32 v72, v12, v148
  v_mfma_f32_16x16x32_bf16 v[160:163], a[116:119], a[44:47], v[160:163]
  v_fmac_f32 v73, v12, v149
  v_fmac_f32 v74, v12, v150
  v_mfma_f32_16x16x32_bf16 v[164:167], a[120:123], a[44:47], v[164:167]
  v_fmac_f32 v75, v12, v151
  ds_write_b128 v174, v[72:75] offset:8192
  v_mfma_f32_16x16x32_bf16 v[168:171], a[124:127], a[44:47], v[168:171]
  v_fmac_f32 v76, v12, v152
  v_mfma_f32_16x16x32_bf16 v[156:159], a[128:131], a[48:51], v[156:159]
  v_fmac_f32 v77, v12, v153
  v_fmac_f32 v78, v12, v154
  v_mfma_f32_16x16x32_bf16 v[160:163], a[132:135], a[48:51], v[160:163]
  v_fmac_f32 v79, v12, v155
  ds_write_b128 v175, v[76:79] offset:8192
  v_mfma_f32_16x16x32_bf16 v[164:167], a[136:139], a[48:51], v[164:167]
  v_mul_f32 v86, v19, v86
  v_mul_f32 v87, v19, v87
  v_mfma_f32_16x16x32_bf16 v[168:171], a[140:143], a[48:51], v[168:171]
  v_mul_f32 v88, v19, v88
  v_mfma_f32_16x16x32_bf16 v[156:159], a[144:147], a[52:55], v[156:159]
  v_mul_f32 v89, v19, v89
  v_mul_f32 v90, v19, v90
  v_mfma_f32_16x16x32_bf16 v[160:163], a[148:151], a[52:55], v[160:163]
  v_mul_f32 v91, v19, v91
  v_mul_f32 v92, v19, v92
  v_mfma_f32_16x16x32_bf16 v[164:167], a[152:155], a[52:55], v[164:167]
  v_mul_f32 v93, v19, v93
  v_mul_f32 v94, v19, v94
  v_mfma_f32_16x16x32_bf16 v[168:171], a[156:159], a[52:55], v[168:171]
  v_mul_f32 v95, v19, v95
  s_waitcnt vmcnt(0)
  v_mfma_f32_16x16x32_bf16 v[140:143], a[80:83], a[56:59], 0
  v_mul_f32 v108, v20, v108
  v_mul_f32 v109, v20, v109
  v_mfma_f32_16x16x32_bf16 v[144:147], a[84:87], a[56:59], 0
  v_mul_f32 v110, v20, v110
  v_mul_f32 v111, v20, v111
  v_mfma_f32_16x16x32_bf16 v[148:151], a[88:91], a[56:59], 0
  v_mul_f32 v112, v20, v112
  v_mul_f32 v113, v20, v113
  v_mfma_f32_16x16x32_bf16 v[152:155], a[92:95], a[56:59], 0
  v_fmac_f32 v80, v13, v156
  v_fmac_f32 v81, v13, v157
  v_mfma_f32_16x16x32_bf16 v[140:143], a[96:99], a[60:63], v[140:143]
  v_fmac_f32 v82, v13, v158
  v_fmac_f32 v83, v13, v159
  v_mfma_f32_16x16x32_bf16 v[144:147], a[100:103], a[60:63], v[144:147]
  ds_write_b128 v172, v[80:83] offset:12288
  v_fmac_f32 v84, v13, v160
  v_mfma_f32_16x16x32_bf16 v[148:151], a[104:107], a[60:63], v[148:151]
  v_fmac_f32 v85, v13, v161
  v_fmac_f32 v86, v13, v162
  v_mfma_f32_16x16x32_bf16 v[152:155], a[108:111], a[60:63], v[152:155]
  v_fmac_f32 v87, v13, v163
  v_mfma_f32_16x16x32_bf16 v[140:143], a[112:115], a[64:67], v[140:143]
  ds_write_b128 v173, v[84:87] offset:12288
  v_fmac_f32 v88, v13, v164
  v_mfma_f32_16x16x32_bf16 v[144:147], a[116:119], a[64:67], v[144:147]
  v_fmac_f32 v89, v13, v165
  v_fmac_f32 v90, v13, v166
  v_mfma_f32_16x16x32_bf16 v[148:151], a[120:123], a[64:67], v[148:151]
  v_fmac_f32 v91, v13, v167
  ds_write_b128 v174, v[88:91] offset:12288
  v_mfma_f32_16x16x32_bf16 v[152:155], a[124:127], a[64:67], v[152:155]
  v_fmac_f32 v92, v13, v168
  v_mfma_f32_16x16x32_bf16 v[140:143], a[128:131], a[68:71], v[140:143]
  v_fmac_f32 v93, v13, v169
  v_fmac_f32 v94, v13, v170
  v_mfma_f32_16x16x32_bf16 v[144:147], a[132:135], a[68:71], v[144:147]
  v_fmac_f32 v95, v13, v171
  ds_write_b128 v175, v[92:95] offset:12288
  v_mfma_f32_16x16x32_bf16 v[148:151], a[136:139], a[68:71], v[148:151]
  v_mul_f32 v114, v20, v114
  v_mul_f32 v115, v20, v115
  v_mfma_f32_16x16x32_bf16 v[152:155], a[140:143], a[68:71], v[152:155]
  v_mul_f32 v116, v20, v116
  v_mfma_f32_16x16x32_bf16 v[140:143], a[144:147], a[72:75], v[140:143]
  v_mul_f32 v117, v20, v117
  v_mul_f32 v118, v20, v118
  v_mfma_f32_16x16x32_bf16 v[144:147], a[148:151], a[72:75], v[144:147]
  v_mul_f32 v119, v20, v119
  v_mul_f32 v120, v20, v120
  v_mfma_f32_16x16x32_bf16 v[148:151], a[152:155], a[72:75], v[148:151]
  v_mul_f32 v121, v20, v121
  v_mul_f32 v122, v20, v122
  v_mfma_f32_16x16x32_bf16 v[152:155], a[156:159], a[72:75], v[152:155]
  v_mul_f32 v123, v20, v123
  v_fmac_f32 v108, v14, v140
  v_fmac_f32 v109, v14, v141
  v_fmac_f32 v110, v14, v142
  v_fmac_f32 v111, v14, v143
  ds_write_b128 v172, v[108:111] offset:16384
  v_fmac_f32 v112, v14, v144
  v_fmac_f32 v113, v14, v145
  v_fmac_f32 v114, v14, v146
  v_fmac_f32 v115, v14, v147
  ds_write_b128 v173, v[112:115] offset:16384
  v_fmac_f32 v116, v14, v148
  v_fmac_f32 v117, v14, v149
  v_fmac_f32 v118, v14, v150
  v_fmac_f32 v119, v14, v151
  ds_write_b128 v174, v[116:119] offset:16384
  v_fmac_f32 v120, v14, v152
  v_fmac_f32 v121, v14, v153
  v_fmac_f32 v122, v14, v154
  v_fmac_f32 v123, v14, v155
  ds_write_b128 v175, v[120:123] offset:16384
  s_waitcnt lgkmcnt(0)
  s_barrier
  ds_read_b128 v[184:187], v176 offset:0
  ds_read_b128 v[188:191], v177 offset:0
  ds_read_b128 v[192:195], v176 offset:40960
  ds_read_b128 v[196:199], v177 offset:40960
  ds_read_b128 v[200:203], v178 offset:0
  ds_read_b128 v[204:207], v179 offset:0
  ds_read_b128 v[208:211], v178 offset:40960
  ds_read_b128 v[212:215], v179 offset:40960
  ds_read_b128 v[216:219], v176 offset:8192
  ds_read_b128 v[220:223], v177 offset:8192
  ds_read_b128 v[224:227], v176 offset:49152
  ds_read_b128 v[228:231], v177 offset:49152
  ds_read_b128 v[232:235], v178 offset:8192
  ds_read_b128 v[236:239], v179 offset:8192
  ds_read_b128 v[240:243], v178 offset:49152
  ds_read_b128 v[244:247], v179 offset:49152
  s_waitcnt lgkmcnt(8)
  v_pk_add_f32 v[184:185], v[184:185], v[192:193]
  v_pk_add_f32 v[200:201], v[200:201], v[208:209]
  v_pk_add_f32 v[186:187], v[186:187], v[194:195]
  v_pk_add_f32 v[202:203], v[202:203], v[210:211]
  v_pk_add_f32 v[188:189], v[188:189], v[196:197]
  v_pk_add_f32 v[204:205], v[204:205], v[212:213]
  v_pk_add_f32 v[190:191], v[190:191], v[198:199]
  v_pk_add_f32 v[206:207], v[206:207], v[214:215]
  v_pk_add_f32 v[184:185], v[184:185], v[200:201]
  v_pk_add_f32 v[186:187], v[186:187], v[202:203]
  v_pk_add_f32 v[188:189], v[188:189], v[204:205]
  v_pk_add_f32 v[190:191], v[190:191], v[206:207]
  v_cvt_pk_bf16_f32 v32, v184, v185
  v_cvt_pk_bf16_f32 v33, v186, v187
  v_cvt_pk_bf16_f32 v34, v188, v189
  v_cvt_pk_bf16_f32 v35, v190, v191
  s_mov_b32 s58, 0
  buffer_store_dwordx4 v[32:35], v180, s[72:75], s58 offen sc1 nt
  s_cmp_ge_u32 s20, 2
  s_cbranch_scc1 LfF5
  ds_read_b128 v[184:187], v176 offset:16384
  ds_read_b128 v[188:191], v177 offset:16384
  ds_read_b128 v[192:195], v176 offset:57344
  ds_read_b128 v[196:199], v177 offset:57344
  ds_read_b128 v[200:203], v178 offset:16384
  ds_read_b128 v[204:207], v179 offset:16384
  ds_read_b128 v[208:211], v178 offset:57344
  ds_read_b128 v[212:215], v179 offset:57344
  s_waitcnt lgkmcnt(8)
  v_pk_add_f32 v[216:217], v[216:217], v[224:225]
  v_pk_add_f32 v[232:233], v[232:233], v[240:241]
  v_pk_add_f32 v[218:219], v[218:219], v[226:227]
  v_pk_add_f32 v[234:235], v[234:235], v[242:243]
  v_pk_add_f32 v[220:221], v[220:221], v[228:229]
  v_pk_add_f32 v[236:237], v[236:237], v[244:245]
  v_pk_add_f32 v[222:223], v[222:223], v[230:231]
  v_pk_add_f32 v[238:239], v[238:239], v[246:247]
  v_pk_add_f32 v[216:217], v[216:217], v[232:233]
  v_pk_add_f32 v[218:219], v[218:219], v[234:235]
  v_pk_add_f32 v[220:221], v[220:221], v[236:237]
  v_pk_add_f32 v[222:223], v[222:223], v[238:239]
  v_cvt_pk_bf16_f32 v36, v216, v217
  v_cvt_pk_bf16_f32 v37, v218, v219
  v_cvt_pk_bf16_f32 v38, v220, v221
  v_cvt_pk_bf16_f32 v39, v222, v223
  s_mov_b32 s58, 40960
  buffer_store_dwordx4 v[36:39], v180, s[72:75], s58 offen sc1 nt
  s_waitcnt lgkmcnt(0)
  v_pk_add_f32 v[184:185], v[184:185], v[192:193]
  v_pk_add_f32 v[200:201], v[200:201], v[208:209]
  v_pk_add_f32 v[186:187], v[186:187], v[194:195]
  v_pk_add_f32 v[202:203], v[202:203], v[210:211]
  v_pk_add_f32 v[188:189], v[188:189], v[196:197]
  v_pk_add_f32 v[204:205], v[204:205], v[212:213]
  v_pk_add_f32 v[190:191], v[190:191], v[198:199]
  v_pk_add_f32 v[206:207], v[206:207], v[214:215]
  v_pk_add_f32 v[184:185], v[184:185], v[200:201]
  v_pk_add_f32 v[186:187], v[186:187], v[202:203]
  v_pk_add_f32 v[188:189], v[188:189], v[204:205]
  v_pk_add_f32 v[190:191], v[190:191], v[206:207]
  v_cvt_pk_bf16_f32 v40, v184, v185
  v_cvt_pk_bf16_f32 v41, v186, v187
  v_cvt_pk_bf16_f32 v42, v188, v189
  v_cvt_pk_bf16_f32 v43, v190, v191
  s_mov_b32 s58, 81920
  buffer_store_dwordx4 v[40:43], v180, s[72:75], s58 offen sc1 nt
  s_branch Lfin
LfF5:
  s_waitcnt lgkmcnt(0)
  v_pk_add_f32 v[216:217], v[216:217], v[224:225]
  v_pk_add_f32 v[232:233], v[232:233], v[240:241]
  v_pk_add_f32 v[218:219], v[218:219], v[226:227]
  v_pk_add_f32 v[234:235], v[234:235], v[242:243]
  v_pk_add_f32 v[220:221], v[220:221], v[228:229]
  v_pk_add_f32 v[236:237], v[236:237], v[244:245]
  v_pk_add_f32 v[222:223], v[222:223], v[230:231]
  v_pk_add_f32 v[238:239], v[238:239], v[246:247]
  v_pk_add_f32 v[216:217], v[216:217], v[232:233]
  v_pk_add_f32 v[218:219], v[218:219], v[234:235]
  v_pk_add_f32 v[220:221], v[220:221], v[236:237]
  v_pk_add_f32 v[222:223], v[222:223], v[238:239]
  v_cvt_pk_bf16_f32 v36, v216, v217
  v_cvt_pk_bf16_f32 v37, v218, v219
  v_cvt_pk_bf16_f32 v38, v220, v221
  v_cvt_pk_bf16_f32 v39, v222, v223
  s_mov_b32 s58, 40960
  buffer_store_dwordx4 v[36:39], v180, s[72:75], s58 offen sc1 nt
  s_branch Lfin
LvN6:
  s_waitcnt vmcnt(18)
  v_mfma_f32_16x16x32_bf16 v[32:35], a[80:83], a[0:3], 0
  v_mfma_f32_16x16x32_bf16 v[36:39], a[84:87], a[0:3], 0
  v_mfma_f32_16x16x32_bf16 v[40:43], a[88:91], a[0:3], 0
  v_mfma_f32_16x16x32_bf16 v[44:47], a[92:95], a[0:3], 0
  buffer_load_dwordx4 a[0:3], v4, s[4:7], s24 offen sc1
  v_mfma_f32_16x16x32_bf16 v[48:51], a[80:83], a[4:7], 0
  v_mfma_f32_16x16x32_bf16 v[52:55], a[84:87], a[4:7], 0
  v_mfma_f32_16x16x32_bf16 v[56:59], a[88:91], a[4:7], 0
  v_mfma_f32_16x16x32_bf16 v[60:63], a[92:95], a[4:7], 0
  buffer_load_dwordx4 a[4:7], v5, s[4:7], s24 offen sc1
  v_mfma_f32_16x16x32_bf16 v[64:67], a[80:83], a[8:11], 0
  v_mfma_f32_16x16x32_bf16 v[68:71], a[84:87], a[8:11], 0
  v_mfma_f32_16x16x32_bf16 v[72:75], a[88:91], a[8:11], 0
  v_mfma_f32_16x16x32_bf16 v[76:79], a[92:95], a[8:11], 0
  buffer_load_dwordx4 a[8:11], v6, s[4:7], s24 offen sc1
  v_mfma_f32_16x16x32_bf16 v[80:83], a[80:83], a[12:15], 0
  v_mfma_f32_16x16x32_bf16 v[84:87], a[84:87], a[12:15], 0
  v_mfma_f32_16x16x32_bf16 v[88:91], a[88:91], a[12:15], 0
  v_mfma_f32_16x16x32_bf16 v[92:95], a[92:95], a[12:15], 0
  buffer_load_dwordx4 a[12:15], v7, s[4:7], s24 offen sc1
  v_mfma_f32_16x16x32_bf16 v[108:111], a[80:83], a[16:19], 0
  v_mfma_f32_16x16x32_bf16 v[112:115], a[84:87], a[16:19], 0
  v_mfma_f32_16x16x32_bf16 v[116:119], a[88:91], a[16:19], 0
  v_mfma_f32_16x16x32_bf16 v[120:123], a[92:95], a[16:19], 0
  buffer_load_dwordx4 a[16:19], v8, s[4:7], s24 offen sc1
  v_mfma_f32_16x16x32_bf16 v[124:127], a[80:83], a[20:23], 0
  v_mfma_f32_16x16x32_bf16 v[128:131], a[84:87], a[20:23], 0
  v_mfma_f32_16x16x32_bf16 v[132:135], a[88:91], a[20:23], 0
  v_mfma_f32_16x16x32_bf16 v[136:139], a[92:95], a[20:23], 0
  buffer_load_dwordx4 a[20:23], v9, s[4:7], s24 offen sc1
  s_waitcnt vmcnt(18)
  v_mfma_f32_16x16x32_bf16 v[32:35], a[96:99], a[24:27], v[32:35]
  s_add_u32 s24, s24, 1024
  v_mfma_f32_16x16x32_bf16 v[36:39], a[100:103], a[24:27], v[36:39]
  v_mfma_f32_16x16x32_bf16 v[40:43], a[104:107], a[24:27], v[40:43]
  s_cmp_eq_u32 s24, s19
  s_cselect_b32 s24, s18, s24
  s_cselect_b32 s6, s68, s14
  v_mfma_f32_16x16x32_bf16 v[44:47], a[108:111], a[24:27], v[44:47]
  buffer_load_dwordx4 a[24:27], v4, s[4:7], s24 offen sc1
  v_mfma_f32_16x16x32_bf16 v[48:51], a[96:99], a[28:31], v[48:51]
  v_mfma_f32_16x16x32_bf16 v[52:55], a[100:103], a[28:31], v[52:55]
  v_mfma_f32_16x16x32_bf16 v[56:59], a[104:107], a[28:31], v[56:59]
  v_mfma_f32_16x16x32_bf16 v[60:63], a[108:111], a[28:31], v[60:63]
  buffer_load_dwordx4 a[28:31], v5, s[4:7], s24 offen sc1
  v_mfma_f32_16x16x32_bf16 v[64:67], a[96:99], a[32:35], v[64:67]
  v_mfma_f32_16x16x32_bf16 v[68:71], a[100:103], a[32:35], v[68:71]
  v_mfma_f32_16x16x32_bf16 v[72:75], a[104:107], a[32:35], v[72:75]
  v_mfma_f32_16x16x32_bf16 v[76:79], a[108:111], a[32:35], v[76:79]
  buffer_load_dwordx4 a[32:35], v6, s[4:7], s24 offen sc1
  v_mfma_f32_16x16x32_bf16 v[80:83], a[96:99], a[36:39], v[80:83]
  v_mfma_f32_16x16x32_bf16 v[84:87], a[100:103], a[36:39], v[84:87]
  v_mfma_f32_16x16x32_bf16 v[88:91], a[104:107], a[36:39], v[88:91]
  v_mfma_f32_16x16x32_bf16 v[92:95], a[108:111], a[36:39], v[92:95]
  buffer_load_dwordx4 a[36:39], v7, s[4:7], s24 offen sc1
  v_mfma_f32_16x16x32_bf16 v[108:111], a[96:99], a[40:43], v[108:111]
  v_mfma_f32_16x16x32_bf16 v[112:115], a[100:103], a[40:43], v[112:115]
  v_mfma_f32_16x16x32_bf16 v[116:119], a[104:107], a[40:43], v[116:119]
  v_mfma_f32_16x16x32_bf16 v[120:123], a[108:111], a[40:43], v[120:123]
  buffer_load_dwordx4 a[40:43], v8, s[4:7], s24 offen sc1
  v_mfma_f32_16x16x32_bf16 v[124:127], a[96:99], a[44:47], v[124:127]
  v_mfma_f32_16x16x32_bf16 v[128:131], a[100:103], a[44:47], v[128:131]
  v_mfma_f32_16x16x32_bf16 v[132:135], a[104:107], a[44:47], v[132:135]
  v_mfma_f32_16x16x32_bf16 v[136:139], a[108:111], a[44:47], v[136:139]
  buffer_load_dwordx4 a[44:47], v9, s[4:7], s24 offen sc1
  s_waitcnt vmcnt(18)
  v_mfma_f32_16x16x32_bf16 v[32:35], a[112:115], a[48:51], v[32:35]
  v_xor_b32 v24, v2, v3
  s_add_u32 s24, s24, 1024
  v_mfma_f32_16x16x32_bf16 v[36:39], a[116:119], a[48:51], v[36:39]
  v_lshlrev_b32 v24, 4, v24
  v_mfma_f32_16x16x32_bf16 v[40:43], a[120:123], a[48:51], v[40:43]
  s_cmp_eq_u32 s24, s19
  s_cselect_b32 s24, s18, s24
  s_cselect_b32 s6, s68, s14
  v_mfma_f32_16x16x32_bf16 v[44:47], a[124:127], a[48:51], v[44:47]
  buffer_load_dwordx4 a[48:51], v4, s[4:7], s24 offen sc1
  v_mfma_f32_16x16x32_bf16 v[48:51], a[112:115], a[52:55], v[48:51]
  v_lshl_add_u32 v24, v3, 8, v24
  v_mfma_f32_16x16x32_bf16 v[52:55], a[116:119], a[52:55], v[52:55]
  v_add_u32 v172, s33, v24
  v_mfma_f32_16x16x32_bf16 v[56:59], a[120:123], a[52:55], v[56:59]
  v_mfma_f32_16x16x32_bf16 v[60:63], a[124:127], a[52:55], v[60:63]
  buffer_load_dwordx4 a[52:55], v5, s[4:7], s24 offen sc1
  v_mfma_f32_16x16x32_bf16 v[64:67], a[112:115], a[56:59], v[64:67]
  v_xor_b32 v173, 64, v172
  v_mfma_f32_16x16x32_bf16 v[68:71], a[116:119], a[56:59], v[68:71]
  v_mfma_f32_16x16x32_bf16 v[72:75], a[120:123], a[56:59], v[72:75]
  v_xor_b32 v174, 128, v172
  v_mfma_f32_16x16x32_bf16 v[76:79], a[124:127], a[56:59], v[76:79]
  buffer_load_dwordx4 a[56:59], v6, s[4:7], s24 offen sc1
  v_mfma_f32_16x16x32_bf16 v[80:83], a[112:115], a[60:63], v[80:83]
  v_xor_b32 v175, 192, v172
  v_mfma_f32_16x16x32_bf16 v[84:87], a[116:119], a[60:63], v[84:87]
  v_mfma_f32_16x16x32_bf16 v[88:91], a[120:123], a[60:63], v[88:91]
  v_bfe_u32 v24, v0, 3, 4
  v_mfma_f32_16x16x32_bf16 v[92:95], a[124:127], a[60:63], v[92:95]
  buffer_load_dwordx4 a[60:63], v7, s[4:7], s24 offen sc1
  v_mfma_f32_16x16x32_bf16 v[108:111], a[112:115], a[64:67], v[108:111]
  v_mfma_f32_16x16x32_bf16 v[112:115], a[116:119], a[64:67], v[112:115]
  v_and_b32 v25, 7, v0
  v_mfma_f32_16x16x32_bf16 v[116:119], a[120:123], a[64:67], v[116:119]
  v_lshlrev_b32 v26, 1, v25
  v_mfma_f32_16x16x32_bf16 v[120:123], a[124:127], a[64:67], v[120:123]
  buffer_load_dwordx4 a[64:67], v8, s[4:7], s24 offen sc1
  v_mfma_f32_16x16x32_bf16 v[124:127], a[112:115], a[68:71], v[124:127]
  v_mfma_f32_16x16x32_bf16 v[128:131], a[116:119], a[68:71], v[128:131]
  v_xor_b32 v26, v26, v24
  v_mfma_f32_16x16x32_bf16 v[132:135], a[120:123], a[68:71], v[132:135]
  v_mfma_f32_16x16x32_bf16 v[136:139], a[124:127], a[68:71], v[136:139]
  buffer_load_dwordx4 a[68:71], v9, s[4:7], s24 offen sc1
  s_waitcnt vmcnt(18)
  v_mfma_f32_16x16x32_bf16 v[32:35], a[128:131], a[72:75], v[32:35]
  v_lshlrev_b32 v26, 4, v26
  s_add_u32 s24, s24, 1024
  v_mfma_f32_16x16x32_bf16 v[36:39], a[132:135], a[72:75], v[36:39]
  v_lshl_add_u32 v26, v24, 8, v26
  v_mfma_f32_16x16x32_bf16 v[40:43], a[136:139], a[72:75], v[40:43]
  s_cmp_eq_u32 s24, s19
  s_cselect_b32 s24, s18, s24
  s_cselect_b32 s6, s68, s14
  v_mfma_f32_16x16x32_bf16 v[44:47], a[140:143], a[72:75], v[44:47]
  buffer_load_dwordx4 a[72:75], v4, s[4:7], s24 offen sc1
  v_mfma_f32_16x16x32_bf16 v[48:51], a[128:131], a[76:79], v[48:51]
  s_lshr_b32 s59, s20, 1
  v_mfma_f32_16x16x32_bf16 v[52:55], a[132:135], a[76:79], v[52:55]
  s_lshl_b32 s58, s59, 12
  v_mfma_f32_16x16x32_bf16 v[56:59], a[136:139], a[76:79], v[56:59]
  v_mfma_f32_16x16x32_bf16 v[60:63], a[140:143], a[76:79], v[60:63]
  buffer_load_dwordx4 a[76:79], v5, s[4:7], s24 offen sc1
  v_mfma_f32_16x16x32_bf16 v[64:67], a[128:131], v[184:187], v[64:67]
  v_add_u32 v176, s58, v26
  v_mfma_f32_16x16x32_bf16 v[68:71], a[132:135], v[184:187], v[68:71]
  v_xor_b32 v177, 16, v176
  v_mfma_f32_16x16x32_bf16 v[72:75], a[136:139], v[184:187], v[72:75]
  v_mfma_f32_16x16x32_bf16 v[76:79], a[140:143], v[184:187], v[76:79]
  buffer_load_dwordx4 v[184:187], v6, s[4:7], s24 offen sc1
  v_mfma_f32_16x16x32_bf16 v[80:83], a[128:131], v[188:191], v[80:83]
  v_add_u32 v178, 81920, v176
  v_mfma_f32_16x16x32_bf16 v[84:87], a[132:135], v[188:191], v[84:87]
  v_add_u32 v179, 81920, v177
  v_mfma_f32_16x16x32_bf16 v[88:91], a[136:139], v[188:191], v[88:91]
  v_mfma_f32_16x16x32_bf16 v[92:95], a[140:143], v[188:191], v[92:95]
  buffer_load_dwordx4 v[188:191], v7, s[4:7], s24 offen sc1
  v_mfma_f32_16x16x32_bf16 v[108:111], a[128:131], v[192:195], v[108:111]
  s_mov_b32 s72, s50
  v_mfma_f32_16x16x32_bf16 v[112:115], a[132:135], v[192:195], v[112:115]
  s_mov_b32 s73, s51
  v_mfma_f32_16x16x32_bf16 v[116:119], a[136:139], v[192:195], v[116:119]
  v_mfma_f32_16x16x32_bf16 v[120:123], a[140:143], v[192:195], v[120:123]
  buffer_load_dwordx4 v[192:195], v8, s[4:7], s24 offen sc1
  v_mfma_f32_16x16x32_bf16 v[124:127], a[128:131], v[196:199], v[124:127]
  s_mov_b32 s74, 2621440
  v_mfma_f32_16x16x32_bf16 v[128:131], a[132:135], v[196:199], v[128:131]
  s_lshl_b32 s23, s23, 7
  v_mfma_f32_16x16x32_bf16 v[132:135], a[136:139], v[196:199], v[132:135]
  v_mfma_f32_16x16x32_bf16 v[136:139], a[140:143], v[196:199], v[136:139]
  buffer_load_dwordx4 v[196:199], v9, s[4:7], s24 offen sc1
  s_waitcnt vmcnt(18)
  v_mfma_f32_16x16x32_bf16 v[32:35], a[144:147], a[0:3], v[32:35]
  v_lshl_add_u32 v25, v25, 4, s23
  s_add_u32 s24, s24, 1024
  v_mfma_f32_16x16x32_bf16 v[36:39], a[148:151], a[0:3], v[36:39]
  v_mul_u32_u24 v24, 2560, v24
  v_mfma_f32_16x16x32_bf16 v[40:43], a[152:155], a[0:3], v[40:43]
  s_cmp_eq_u32 s24, s19
  s_cselect_b32 s24, s18, s24
  s_cselect_b32 s6, s68, s14
  v_mfma_f32_16x16x32_bf16 v[44:47], a[156:159], a[0:3], v[44:47]
  buffer_load_dwordx4 a[0:3], v4, s[4:7], s24 offen sc1
  v_mfma_f32_16x16x32_bf16 v[48:51], a[144:147], a[4:7], v[48:51]
  s_add_u32 s58, s59, s21
  v_mfma_f32_16x16x32_bf16 v[52:55], a[148:151], a[4:7], v[52:55]
  s_and_b32 s59, s58, 1
  v_mfma_f32_16x16x32_bf16 v[56:59], a[152:155], a[4:7], v[56:59]
  v_mfma_f32_16x16x32_bf16 v[60:63], a[156:159], a[4:7], v[60:63]
  buffer_load_dwordx4 a[4:7], v5, s[4:7], s24 offen sc1
  v_mfma_f32_16x16x32_bf16 v[64:67], a[144:147], a[8:11], v[64:67]
  s_lshr_b32 s58, s58, 1
  v_mfma_f32_16x16x32_bf16 v[68:71], a[148:151], a[8:11], v[68:71]
  s_lshl_b32 s58, s58, 5
  v_mfma_f32_16x16x32_bf16 v[72:75], a[152:155], a[8:11], v[72:75]
  v_mfma_f32_16x16x32_bf16 v[76:79], a[156:159], a[8:11], v[76:79]
  buffer_load_dwordx4 a[8:11], v6, s[4:7], s24 offen sc1
  v_mfma_f32_16x16x32_bf16 v[80:83], a[144:147], a[12:15], v[80:83]
  s_add_u32 s58, s58, s59
  v_mfma_f32_16x16x32_bf16 v[84:87], a[148:151], a[12:15], v[84:87]
  s_mul_i32 s58, s58, 1280
  v_mfma_f32_16x16x32_bf16 v[88:91], a[152:155], a[12:15], v[88:91]
  v_mfma_f32_16x16x32_bf16 v[92:95], a[156:159], a[12:15], v[92:95]
  buffer_load_dwordx4 a[12:15], v7, s[4:7], s24 offen sc1
  v_mfma_f32_16x16x32_bf16 v[108:111], a[144:147], a[16:19], v[108:111]
  v_add3_u32 v180, v24, v25, s58
  v_mfma_f32_16x16x32_bf16 v[112:115], a[148:151], a[16:19], v[112:115]
  s_lshl_b32 s63, s21, 6
  v_mfma_f32_16x16x32_bf16 v[116:119], a[152:155], a[16:19], v[116:119]
  v_mfma_f32_16x16x32_bf16 v[120:123], a[156:159], a[16:19], v[120:123]
  buffer_load_dwordx4 a[16:19], v8, s[4:7], s24 offen sc1
  v_mfma_f32_16x16x32_bf16 v[124:127], a[144:147], a[20:23], v[124:127]
  s_add_u32 s63, s63, 10485760
  v_mfma_f32_16x16x32_bf16 v[128:131], a[148:151], a[20:23], v[128:131]
  v_lshlrev_b32 v22, 2, v3
  v_mfma_f32_16x16x32_bf16 v[132:135], a[152:155], a[20:23], v[132:135]
  v_mfma_f32_16x16x32_bf16 v[136:139], a[156:159], a[20:23], v[136:139]
  buffer_load_dwordx4 a[20:23], v9, s[4:7], s24 offen sc1
  s_waitcnt vmcnt(18)
  v_mfma_f32_16x16x32_bf16 v[32:35], a[160:163], a[24:27], v[32:35]
  ds_read_b64_tr_b16 a[80:81], v96 offset:28672
  s_add_u32 s24, s24, 1024
  v_mfma_f32_16x16x32_bf16 v[36:39], a[164:167], a[24:27], v[36:39]
  ds_read_b64_tr_b16 a[82:83], v96 offset:30720
  v_mfma_f32_16x16x32_bf16 v[40:43], a[168:171], a[24:27], v[40:43]
  s_cmp_eq_u32 s24, s19
  s_cselect_b32 s24, s18, s24
  s_cselect_b32 s6, s68, s14
  v_mfma_f32_16x16x32_bf16 v[44:47], a[172:175], a[24:27], v[44:47]
  buffer_load_dwordx4 a[24:27], v4, s[4:7], s24 offen sc1
  v_mfma_f32_16x16x32_bf16 v[48:51], a[160:163], a[28:31], v[48:51]
  ds_read_b64_tr_b16 a[84:85], v97 offset:28672
  v_mfma_f32_16x16x32_bf16 v[52:55], a[164:167], a[28:31], v[52:55]
  ds_read_b64_tr_b16 a[86:87], v97 offset:30720
  v_mfma_f32_16x16x32_bf16 v[56:59], a[168:171], a[28:31], v[56:59]
  v_mfma_f32_16x16x32_bf16 v[60:63], a[172:175], a[28:31], v[60:63]
  buffer_load_dwordx4 a[28:31], v5, s[4:7], s24 offen sc1
  v_mfma_f32_16x16x32_bf16 v[64:67], a[160:163], a[32:35], v[64:67]
  ds_read_b64_tr_b16 a[88:89], v98 offset:28672
  v_mfma_f32_16x16x32_bf16 v[68:71], a[164:167], a[32:35], v[68:71]
  ds_read_b64_tr_b16 a[90:91], v98 offset:30720
  v_mfma_f32_16x16x32_bf16 v[72:75], a[168:171], a[32:35], v[72:75]
  v_mfma_f32_16x16x32_bf16 v[76:79], a[172:175], a[32:35], v[76:79]
  buffer_load_dwordx4 a[32:35], v6, s[4:7], s24 offen sc1
  v_mfma_f32_16x16x32_bf16 v[80:83], a[160:163], a[36:39], v[80:83]
  ds_read_b64_tr_b16 a[92:93], v99 offset:28672
  v_mfma_f32_16x16x32_bf16 v[84:87], a[164:167], a[36:39], v[84:87]
  ds_read_b64_tr_b16 a[94:95], v99 offset:30720
  v_mfma_f32_16x16x32_bf16 v[88:91], a[168:171], a[36:39], v[88:91]
  v_mfma_f32_16x16x32_bf16 v[92:95], a[172:175], a[36:39], v[92:95]
  buffer_load_dwordx4 a[36:39], v7, s[4:7], s24 offen sc1
  v_mfma_f32_16x16x32_bf16 v[108:111], a[160:163], a[40:43], v[108:111]
  v_mfma_f32_16x16x32_bf16 v[112:115], a[164:167], a[40:43], v[112:115]
  v_mfma_f32_16x16x32_bf16 v[116:119], a[168:171], a[40:43], v[116:119]
  v_mfma_f32_16x16x32_bf16 v[120:123], a[172:175], a[40:43], v[120:123]
  buffer_load_dwordx4 a[40:43], v8, s[4:7], s24 offen sc1
  v_mfma_f32_16x16x32_bf16 v[124:127], a[160:163], a[44:47], v[124:127]
  v_mfma_f32_16x16x32_bf16 v[128:131], a[164:167], a[44:47], v[128:131]
  v_mfma_f32_16x16x32_bf16 v[132:135], a[168:171], a[44:47], v[132:135]
  v_mfma_f32_16x16x32_bf16 v[136:139], a[172:175], a[44:47], v[136:139]
  buffer_load_dwordx4 a[44:47], v9, s[4:7], s24 offen sc1
  s_waitcnt vmcnt(18)
  v_mfma_f32_16x16x32_bf16 v[32:35], a[176:179], a[48:51], v[32:35]
  ds_read_b64_tr_b16 a[96:97], v96 offset:32768
  s_add_u32 s24, s24, 1024
  v_mfma_f32_16x16x32_bf16 v[36:39], a[180:183], a[48:51], v[36:39]
  ds_read_b64_tr_b16 a[98:99], v96 offset:34816
  v_mfma_f32_16x16x32_bf16 v[40:43], a[184:187], a[48:51], v[40:43]
  s_cmp_eq_u32 s24, s19
  s_cselect_b32 s24, s18, s24
  s_cselect_b32 s6, s68, s14
  v_mfma_f32_16x16x32_bf16 v[44:47], a[188:191], a[48:51], v[44:47]
  buffer_load_dwordx4 a[48:51], v4, s[4:7], s24 offen sc1
  v_mfma_f32_16x16x32_bf16 v[48:51], a[176:179], a[52:55], v[48:51]
  ds_read_b64_tr_b16 a[100:101], v97 offset:32768
  v_mfma_f32_16x16x32_bf16 v[52:55], a[180:183], a[52:55], v[52:55]
  ds_read_b64_tr_b16 a[102:103], v97 offset:34816
  v_mfma_f32_16x16x32_bf16 v[56:59], a[184:187], a[52:55], v[56:59]
  v_mfma_f32_16x16x32_bf16 v[60:63], a[188:191], a[52:55], v[60:63]
  buffer_load_dwordx4 a[52:55], v5, s[4:7], s24 offen sc1
  v_mfma_f32_16x16x32_bf16 v[64:67], a[176:179], a[56:59], v[64:67]
  ds_read_b64_tr_b16 a[104:105], v98 offset:32768
  v_mfma_f32_16x16x32_bf16 v[68:71], a[180:183], a[56:59], v[68:71]
  ds_read_b64_tr_b16 a[106:107], v98 offset:34816
  v_mfma_f32_16x16x32_bf16 v[72:75], a[184:187], a[56:59], v[72:75]
  v_mfma_f32_16x16x32_bf16 v[76:79], a[188:191], a[56:59], v[76:79]
  buffer_load_dwordx4 a[56:59], v6, s[4:7], s24 offen sc1
  v_mfma_f32_16x16x32_bf16 v[80:83], a[176:179], a[60:63], v[80:83]
  ds_read_b64_tr_b16 a[108:109], v99 offset:32768
  v_mfma_f32_16x16x32_bf16 v[84:87], a[180:183], a[60:63], v[84:87]
  ds_read_b64_tr_b16 a[110:111], v99 offset:34816
  v_mfma_f32_16x16x32_bf16 v[88:91], a[184:187], a[60:63], v[88:91]
  v_mfma_f32_16x16x32_bf16 v[92:95], a[188:191], a[60:63], v[92:95]
  buffer_load_dwordx4 a[60:63], v7, s[4:7], s24 offen sc1
  v_mfma_f32_16x16x32_bf16 v[108:111], a[176:179], a[64:67], v[108:111]
  v_mfma_f32_16x16x32_bf16 v[112:115], a[180:183], a[64:67], v[112:115]
  v_mfma_f32_16x16x32_bf16 v[116:119], a[184:187], a[64:67], v[116:119]
  v_mfma_f32_16x16x32_bf16 v[120:123], a[188:191], a[64:67], v[120:123]
  buffer_load_dwordx4 a[64:67], v8, s[4:7], s24 offen sc1
  v_mfma_f32_16x16x32_bf16 v[124:127], a[176:179], a[68:71], v[124:127]
  v_mfma_f32_16x16x32_bf16 v[128:131], a[180:183], a[68:71], v[128:131]
  v_mfma_f32_16x16x32_bf16 v[132:135], a[184:187], a[68:71], v[132:135]
  v_mfma_f32_16x16x32_bf16 v[136:139], a[188:191], a[68:71], v[136:139]
  buffer_load_dwordx4 a[68:71], v9, s[4:7], s24 offen sc1
  s_waitcnt vmcnt(18)
  v_mfma_f32_16x16x32_bf16 v[32:35], a[192:195], a[72:75], v[32:35]
  ds_read_b64_tr_b16 a[112:113], v96 offset:0
  s_add_u32 s24, s24, 1024
  v_mfma_f32_16x16x32_bf16 v[36:39], a[196:199], a[72:75], v[36:39]
  ds_read_b64_tr_b16 a[114:115], v96 offset:2048
  v_mfma_f32_16x16x32_bf16 v[40:43], a[200:203], a[72:75], v[40:43]
  s_cmp_eq_u32 s24, s19
  s_cselect_b32 s24, s18, s24
  s_cselect_b32 s6, s68, s14
  v_mfma_f32_16x16x32_bf16 v[44:47], a[204:207], a[72:75], v[44:47]
  buffer_load_dwordx4 a[72:75], v4, s[4:7], s24 offen sc1
  v_mfma_f32_16x16x32_bf16 v[48:51], a[192:195], a[76:79], v[48:51]
  ds_read_b64_tr_b16 a[116:117], v97 offset:0
  v_mfma_f32_16x16x32_bf16 v[52:55], a[196:199], a[76:79], v[52:55]
  ds_read_b64_tr_b16 a[118:119], v97 offset:2048
  v_mfma_f32_16x16x32_bf16 v[56:59], a[200:203], a[76:79], v[56:59]
  v_mfma_f32_16x16x32_bf16 v[60:63], a[204:207], a[76:79], v[60:63]
  buffer_load_dwordx4 a[76:79], v5, s[4:7], s24 offen sc1
  v_mfma_f32_16x16x32_bf16 v[64:67], a[192:195], v[184:187], v[64:67]
  ds_read_b64_tr_b16 a[120:121], v98 offset:0
  v_mfma_f32_16x16x32_bf16 v[68:71], a[196:199], v[184:187], v[68:71]
  ds_read_b64_tr_b16 a[122:123], v98 offset:2048
  v_mfma_f32_16x16x32_bf16 v[72:75], a[200:203], v[184:187], v[72:75]
  v_mfma_f32_16x16x32_bf16 v[76:79], a[204:207], v[184:187], v[76:79]
  buffer_load_dwordx4 v[184:187], v6, s[4:7], s24 offen sc1
  v_mfma_f32_16x16x32_bf16 v[80:83], a[192:195], v[188:191], v[80:83]
  ds_read_b64_tr_b16 a[124:125], v99 offset:0
  v_mfma_f32_16x16x32_bf16 v[84:87], a[196:199], v[188:191], v[84:87]
  ds_read_b64_tr_b16 a[126:127], v99 offset:2048
  v_mfma_f32_16x16x32_bf16 v[88:91], a[200:203], v[188:191], v[88:91]
  v_mfma_f32_16x16x32_bf16 v[92:95], a[204:207], v[188:191], v[92:95]
  buffer_load_dwordx4 v[188:191], v7, s[4:7], s24 offen sc1
  v_mfma_f32_16x16x32_bf16 v[108:111], a[192:195], v[192:195], v[108:111]
  v_mfma_f32_16x16x32_bf16 v[112:115], a[196:199], v[192:195], v[112:115]
  v_mfma_f32_16x16x32_bf16 v[116:119], a[200:203], v[192:195], v[116:119]
  v_mfma_f32_16x16x32_bf16 v[120:123], a[204:207], v[192:195], v[120:123]
  buffer_load_dwordx4 v[192:195], v8, s[4:7], s24 offen sc1
  v_mfma_f32_16x16x32_bf16 v[124:127], a[192:195], v[196:199], v[124:127]
  v_mfma_f32_16x16x32_bf16 v[128:131], a[196:199], v[196:199], v[128:131]
  v_mfma_f32_16x16x32_bf16 v[132:135], a[200:203], v[196:199], v[132:135]
  v_mfma_f32_16x16x32_bf16 v[136:139], a[204:207], v[196:199], v[136:139]
  buffer_load_dwordx4 v[196:199], v9, s[4:7], s24 offen sc1
  s_waitcnt vmcnt(18)
  v_mfma_f32_16x16x32_bf16 v[32:35], a[208:211], a[0:3], v[32:35]
  ds_read_b64_tr_b16 a[240:241], v96 offset:36864
  s_add_u32 s24, s24, 1024
  v_mfma_f32_16x16x32_bf16 v[36:39], a[212:215], a[0:3], v[36:39]
  ds_read_b64_tr_b16 a[242:243], v96 offset:38912
  s_mov_b32 exec_lo, 4294901760
  s_mov_b32 exec_hi, 65535
  buffer_load_dword v23, v104, s[12:15], 0 offen sc1
  s_mov_b64 exec, -1
  v_mfma_f32_16x16x32_bf16 v[40:43], a[216:219], a[0:3], v[40:43]
  ds_read_b64_tr_b16 a[244:245], v97 offset:36864
  s_cmp_eq_u32 s24, s19
  s_cselect_b32 s24, s18, s24
  s_cselect_b32 s6, s68, s14
  v_mfma_f32_16x16x32_bf16 v[44:47], a[220:223], a[0:3], v[44:47]
  buffer_load_dwordx4 a[0:3], v4, s[4:7], s24 offen sc1
  v_mfma_f32_16x16x32_bf16 v[48:51], a[208:211], a[4:7], v[48:51]
  ds_read_b64_tr_b16 a[246:247], v97 offset:38912
  v_mfma_f32_16x16x32_bf16 v[52:55], a[212:215], a[4:7], v[52:55]
  ds_read_b64_tr_b16 a[248:249], v98 offset:36864
  v_mfma_f32_16x16x32_bf16 v[56:59], a[216:219], a[4:7], v[56:59]
  ds_read_b64_tr_b16 a[250:251], v98 offset:38912
  v_mfma_f32_16x16x32_bf16 v[60:63], a[220:223], a[4:7], v[60:63]
  buffer_load_dwordx4 a[4:7], v5, s[4:7], s24 offen sc1
  v_mfma_f32_16x16x32_bf16 v[64:67], a[208:211], a[8:11], v[64:67]
  ds_read_b64_tr_b16 a[252:253], v99 offset:36864
  v_mfma_f32_16x16x32_bf16 v[68:71], a[212:215], a[8:11], v[68:71]
  ds_read_b64_tr_b16 a[254:255], v99 offset:38912
  v_mfma_f32_16x16x32_bf16 v[72:75], a[216:219], a[8:11], v[72:75]
  v_mfma_f32_16x16x32_bf16 v[76:79], a[220:223], a[8:11], v[76:79]
  buffer_load_dwordx4 a[8:11], v6, s[4:7], s24 offen sc1
  v_mfma_f32_16x16x32_bf16 v[80:83], a[208:211], a[12:15], v[80:83]
  ds_read_b64_tr_b16 a[128:129], v96 offset:4096
  v_mfma_f32_16x16x32_bf16 v[84:87], a[212:215], a[12:15], v[84:87]
  ds_read_b64_tr_b16 a[130:131], v96 offset:6144
  v_mfma_f32_16x16x32_bf16 v[88:91], a[216:219], a[12:15], v[88:91]
  ds_read_b64_tr_b16 a[132:133], v97 offset:4096
  v_mfma_f32_16x16x32_bf16 v[92:95], a[220:223], a[12:15], v[92:95]
  buffer_load_dwordx4 a[12:15], v7, s[4:7], s24 offen sc1
  v_mfma_f32_16x16x32_bf16 v[108:111], a[208:211], a[16:19], v[108:111]
  ds_read_b64_tr_b16 a[134:135], v97 offset:6144
  v_mfma_f32_16x16x32_bf16 v[112:115], a[212:215], a[16:19], v[112:115]
  ds_read_b64_tr_b16 a[136:137], v98 offset:4096
  v_mfma_f32_16x16x32_bf16 v[116:119], a[216:219], a[16:19], v[116:119]
  ds_read_b64_tr_b16 a[138:139], v98 offset:6144
  v_mfma_f32_16x16x32_bf16 v[120:123], a[220:223], a[16:19], v[120:123]
  buffer_load_dwordx4 a[16:19], v8, s[4:7], s24 offen sc1
  v_mfma_f32_16x16x32_bf16 v[124:127], a[208:211], a[20:23], v[124:127]
  ds_read_b64_tr_b16 a[140:141], v99 offset:4096
  v_mfma_f32_16x16x32_bf16 v[128:131], a[212:215], a[20:23], v[128:131]
  ds_read_b64_tr_b16 a[142:143], v99 offset:6144
  v_mfma_f32_16x16x32_bf16 v[132:135], a[216:219], a[20:23], v[132:135]
  v_mfma_f32_16x16x32_bf16 v[136:139], a[220:223], a[20:23], v[136:139]
  buffer_load_dwordx4 a[20:23], v9, s[4:7], s24 offen sc1
  s_waitcnt vmcnt(19) lgkmcnt(0)
  v_mfma_f32_16x16x32_bf16 v[32:35], a[240:243], a[24:27], v[32:35]
  ds_read_b64_tr_b16 a[224:225], v96 offset:12288
  s_add_u32 s24, s24, 1024
  v_mfma_f32_16x16x32_bf16 v[36:39], a[244:247], a[24:27], v[36:39]
  ds_read_b64_tr_b16 a[226:227], v96 offset:14336
  v_mfma_f32_16x16x32_bf16 v[40:43], a[248:251], a[24:27], v[40:43]
  ds_read_b64_tr_b16 a[228:229], v97 offset:12288
  s_cmp_eq_u32 s24, s19
  s_cselect_b32 s24, s18, s24
  s_cselect_b32 s6, s68, s14
  v_mfma_f32_16x16x32_bf16 v[44:47], a[252:255], a[24:27], v[44:47]
  buffer_load_dwordx4 a[24:27], v4, s[4:7], s24 offen sc1
  v_mfma_f32_16x16x32_bf16 v[48:51], a[240:243], a[28:31], v[48:51]
  ds_read_b64_tr_b16 a[230:231], v97 offset:14336
  v_mfma_f32_16x16x32_bf16 v[52:55], a[244:247], a[28:31], v[52:55]
  ds_read_b64_tr_b16 a[232:233], v98 offset:12288
  v_mfma_f32_16x16x32_bf16 v[56:59], a[248:251], a[28:31], v[56:59]
  ds_read_b64_tr_b16 a[234:235], v98 offset:14336
  v_mfma_f32_16x16x32_bf16 v[60:63], a[252:255], a[28:31], v[60:63]
  buffer_load_dwordx4 a[28:31], v5, s[4:7], s24 offen sc1
  v_mfma_f32_16x16x32_bf16 v[64:67], a[240:243], a[32:35], v[64:67]
  ds_read_b64_tr_b16 a[236:237], v99 offset:12288
  v_mfma_f32_16x16x32_bf16 v[68:71], a[244:247], a[32:35], v[68:71]
  ds_read_b64_tr_b16 a[238:239], v99 offset:14336
  v_mfma_f32_16x16x32_bf16 v[72:75], a[248:251], a[32:35], v[72:75]
  v_mfma_f32_16x16x32_bf16 v[76:79], a[252:255], a[32:35], v[76:79]
  buffer_load_dwordx4 a[32:35], v6, s[4:7], s24 offen sc1
  v_mfma_f32_16x16x32_bf16 v[80:83], a[240:243], a[36:39], v[80:83]
  ds_read_b64_tr_b16 a[144:145], v96 offset:8192
  v_mfma_f32_16x16x32_bf16 v[84:87], a[244:247], a[36:39], v[84:87]
  ds_read_b64_tr_b16 a[146:147], v96 offset:10240
  v_mfma_f32_16x16x32_bf16 v[88:91], a[248:251], a[36:39], v[88:91]
  ds_read_b64_tr_b16 a[148:149], v97 offset:8192
  v_mfma_f32_16x16x32_bf16 v[92:95], a[252:255], a[36:39], v[92:95]
  buffer_load_dwordx4 a[36:39], v7, s[4:7], s24 offen sc1
  v_mfma_f32_16x16x32_bf16 v[108:111], a[240:243], a[40:43], v[108:111]
  ds_read_b64_tr_b16 a[150:151], v97 offset:10240
  v_mfma_f32_16x16x32_bf16 v[112:115], a[244:247], a[40:43], v[112:115]
  ds_read_b64_tr_b16 a[152:153], v98 offset:8192
  v_mfma_f32_16x16x32_bf16 v[116:119], a[248:251], a[40:43], v[116:119]
  ds_read_b64_tr_b16 a[154:155], v98 offset:10240
  v_mfma_f32_16x16x32_bf16 v[120:123], a[252:255], a[40:43], v[120:123]
  buffer_load_dwordx4 a[40:43], v8, s[4:7], s24 offen sc1
  v_mfma_f32_16x16x32_bf16 v[124:127], a[240:243], a[44:47], v[124:127]
  ds_read_b64_tr_b16 a[156:157], v99 offset:8192
  v_mfma_f32_16x16x32_bf16 v[128:131], a[244:247], a[44:47], v[128:131]
  ds_read_b64_tr_b16 a[158:159], v99 offset:10240
  v_mfma_f32_16x16x32_bf16 v[132:135], a[248:251], a[44:47], v[132:135]
  v_mfma_f32_16x16x32_bf16 v[136:139], a[252:255], a[44:47], v[136:139]
  buffer_load_dwordx4 a[44:47], v9, s[4:7], s24 offen sc1
  s_waitcnt vmcnt(12) lgkmcnt(0)
  v_and_b32 v23, 1, v23
  v_cmp_ne_u32 vcc, v23, v105
  s_nop 0
  s_and_b32 vcc_lo, vcc_lo, 4294901760
  s_and_b32 vcc_hi, vcc_hi, 65535
  s_cbranch_vccz LpoN6ok
  s_mov_b32 exec_lo, 4294901760
  s_mov_b32 exec_hi, 65535
  s_mov_b32 s35, 0x20000
LpoN6:
  buffer_load_dword v23, v104, s[12:15], 0 offen sc1
  s_sub_u32 s35, s35, 1
  s_waitcnt vmcnt(0)
  v_and_b32 v23, 1, v23
  v_cmp_ne_u32 vcc, v23, v105
  s_cmp_eq_u32 s35, 0
  s_cbranch_scc1 LpoN6x
  s_cbranch_vccnz LpoN6
LpoN6x:
  s_mov_b64 exec, -1
LpoN6ok:
  v_mfma_f32_16x16x32_bf16 v[32:35], a[224:227], a[48:51], v[32:35]
  ds_read_b64_tr_b16 a[240:241], v96 offset:16384
  v_mfma_f32_16x16x32_bf16 v[36:39], a[228:231], a[48:51], v[36:39]
  ds_read_b64_tr_b16 a[242:243], v96 offset:18432
  buffer_load_dword v10, v22, s[12:15], s63 offen offset:0 sc1
  v_mfma_f32_16x16x32_bf16 v[40:43], a[232:235], a[48:51], v[40:43]
  v_mfma_f32_16x16x32_bf16 v[44:47], a[236:239], a[48:51], v[44:47]
  buffer_load_dwordx4 a[160:163], v4, s[12:15], s27 offen offset:0 sc1
  v_mfma_f32_16x16x32_bf16 v[48:51], a[224:227], a[52:55], v[48:51]
  ds_read_b64_tr_b16 a[244:245], v97 offset:16384
  v_mfma_f32_16x16x32_bf16 v[52:55], a[228:231], a[52:55], v[52:55]
  ds_read_b64_tr_b16 a[246:247], v97 offset:18432
  buffer_load_dword v11, v22, s[12:15], s63 offen offset:64 sc1
  v_mfma_f32_16x16x32_bf16 v[56:59], a[232:235], a[52:55], v[56:59]
  v_mfma_f32_16x16x32_bf16 v[60:63], a[236:239], a[52:55], v[60:63]
  buffer_load_dwordx4 a[164:167], v4, s[12:15], s27 offen offset:1024 sc1
  v_mfma_f32_16x16x32_bf16 v[64:67], a[224:227], a[56:59], v[64:67]
  ds_read_b64_tr_b16 a[248:249], v98 offset:16384
  v_mfma_f32_16x16x32_bf16 v[68:71], a[228:231], a[56:59], v[68:71]
  ds_read_b64_tr_b16 a[250:251], v98 offset:18432
  buffer_load_dword v12, v22, s[12:15], s63 offen offset:128 sc1
  v_mfma_f32_16x16x32_bf16 v[72:75], a[232:235], a[56:59], v[72:75]
  v_mfma_f32_16x16x32_bf16 v[76:79], a[236:239], a[56:59], v[76:79]
  buffer_load_dwordx4 a[168:171], v4, s[12:15], s27 offen offset:2048 sc1
  v_mfma_f32_16x16x32_bf16 v[80:83], a[224:227], a[60:63], v[80:83]
  ds_read_b64_tr_b16 a[252:253], v99 offset:16384
  v_mfma_f32_16x16x32_bf16 v[84:87], a[228:231], a[60:63], v[84:87]
  ds_read_b64_tr_b16 a[254:255], v99 offset:18432
  buffer_load_dword v13, v22, s[12:15], s63 offen offset:192 sc1
  v_mfma_f32_16x16x32_bf16 v[88:91], a[232:235], a[60:63], v[88:91]
  v_mfma_f32_16x16x32_bf16 v[92:95], a[236:239], a[60:63], v[92:95]
  buffer_load_dwordx4 a[172:175], v4, s[12:15], s27 offen offset:3072 sc1
  v_mfma_f32_16x16x32_bf16 v[108:111], a[224:227], a[64:67], v[108:111]
  v_mfma_f32_16x16x32_bf16 v[112:115], a[228:231], a[64:67], v[112:115]
  buffer_load_dword v14, v22, s[12:15], s63 offen offset:256 sc1
  v_mfma_f32_16x16x32_bf16 v[116:119], a[232:235], a[64:67], v[116:119]
  v_mfma_f32_16x16x32_bf16 v[120:123], a[236:239], a[64:67], v[120:123]
  buffer_load_dwordx4 a[176:179], v4, s[12:15], s28 offen offset:0 sc1
  v_mfma_f32_16x16x32_bf16 v[124:127], a[224:227], a[68:71], v[124:127]
  v_mfma_f32_16x16x32_bf16 v[128:131], a[228:231], a[68:71], v[128:131]
  buffer_load_dword v15, v22, s[12:15], s63 offen offset:320 sc1
  v_mfma_f32_16x16x32_bf16 v[132:135], a[232:235], a[68:71], v[132:135]
  v_mfma_f32_16x16x32_bf16 v[136:139], a[236:239], a[68:71], v[136:139]
  buffer_load_dwordx4 a[180:183], v5, s[12:15], s27 offen offset:0 sc1
  s_waitcnt vmcnt(25) lgkmcnt(0)
  v_mfma_f32_16x16x32_bf16 v[32:35], a[240:243], a[72:75], v[32:35]
  ds_read_b64_tr_b16 a[224:225], v96 offset:20480
  v_mfma_f32_16x16x32_bf16 v[36:39], a[244:247], a[72:75], v[36:39]
  ds_read_b64_tr_b16 a[226:227], v96 offset:22528
  v_mfma_f32_16x16x32_bf16 v[40:43], a[248:251], a[72:75], v[40:43]
  v_mfma_f32_16x16x32_bf16 v[44:47], a[252:255], a[72:75], v[44:47]
  buffer_load_dwordx4 a[184:187], v5, s[12:15], s27 offen offset:1024 sc1
  v_mfma_f32_16x16x32_bf16 v[48:51], a[240:243], a[76:79], v[48:51]
  ds_read_b64_tr_b16 a[228:229], v97 offset:20480
  v_mfma_f32_16x16x32_bf16 v[52:55], a[244:247], a[76:79], v[52:55]
  ds_read_b64_tr_b16 a[230:231], v97 offset:22528
  v_mfma_f32_16x16x32_bf16 v[56:59], a[248:251], a[76:79], v[56:59]
  v_mfma_f32_16x16x32_bf16 v[60:63], a[252:255], a[76:79], v[60:63]
  buffer_load_dwordx4 a[188:191], v5, s[12:15], s27 offen offset:2048 sc1
  v_mfma_f32_16x16x32_bf16 v[64:67], a[240:243], v[184:187], v[64:67]
  ds_read_b64_tr_b16 a[232:233], v98 offset:20480
  v_mfma_f32_16x16x32_bf16 v[68:71], a[244:247], v[184:187], v[68:71]
  ds_read_b64_tr_b16 a[234:235], v98 offset:22528
  v_mfma_f32_16x16x32_bf16 v[72:75], a[248:251], v[184:187], v[72:75]
  v_mfma_f32_16x16x32_bf16 v[76:79], a[252:255], v[184:187], v[76:79]
  buffer_load_dwordx4 a[192:195], v5, s[12:15], s27 offen offset:3072 sc1
  v_mfma_f32_16x16x32_bf16 v[80:83], a[240:243], v[188:191], v[80:83]
  ds_read_b64_tr_b16 a[236:237], v99 offset:20480
  v_mfma_f32_16x16x32_bf16 v[84:87], a[244:247], v[188:191], v[84:87]
  ds_read_b64_tr_b16 a[238:239], v99 offset:22528
  v_mfma_f32_16x16x32_bf16 v[88:91], a[248:251], v[188:191], v[88:91]
  v_mfma_f32_16x16x32_bf16 v[92:95], a[252:255], v[188:191], v[92:95]
  buffer_load_dwordx4 a[196:199], v5, s[12:15], s28 offen offset:0 sc1
  v_mfma_f32_16x16x32_bf16 v[108:111], a[240:243], v[192:195], v[108:111]
  v_mfma_f32_16x16x32_bf16 v[112:115], a[244:247], v[192:195], v[112:115]
  v_mfma_f32_16x16x32_bf16 v[116:119], a[248:251], v[192:195], v[116:119]
  v_mfma_f32_16x16x32_bf16 v[120:123], a[252:255], v[192:195], v[120:123]
  buffer_load_dwordx4 a[200:203], v6, s[12:15], s27 offen offset:0 sc1
  v_mfma_f32_16x16x32_bf16 v[124:127], a[240:243], v[196:199], v[124:127]
  v_mfma_f32_16x16x32_bf16 v[128:131], a[244:247], v[196:199], v[128:131]
  v_mfma_f32_16x16x32_bf16 v[132:135], a[248:251], v[196:199], v[132:135]
  v_mfma_f32_16x16x32_bf16 v[136:139], a[252:255], v[196:199], v[136:139]
  buffer_load_dwordx4 a[204:207], v6, s[12:15], s27 offen offset:1024 sc1
  s_waitcnt vmcnt(24) lgkmcnt(0)
  v_mfma_f32_16x16x32_bf16 v[32:35], a[224:227], a[0:3], v[32:35]
  ds_read_b64_tr_b16 a[240:241], v96 offset:24576
  v_mfma_f32_16x16x32_bf16 v[36:39], a[228:231], a[0:3], v[36:39]
  ds_read_b64_tr_b16 a[242:243], v96 offset:26624
  v_mfma_f32_16x16x32_bf16 v[40:43], a[232:235], a[0:3], v[40:43]
  v_mfma_f32_16x16x32_bf16 v[44:47], a[236:239], a[0:3], v[44:47]
  buffer_load_dwordx4 a[208:211], v6, s[12:15], s27 offen offset:2048 sc1
  v_mfma_f32_16x16x32_bf16 v[48:51], a[224:227], a[4:7], v[48:51]
  ds_read_b64_tr_b16 a[244:245], v97 offset:24576
  v_mfma_f32_16x16x32_bf16 v[52:55], a[228:231], a[4:7], v[52:55]
  ds_read_b64_tr_b16 a[246:247], v97 offset:26624
  v_mfma_f32_16x16x32_bf16 v[56:59], a[232:235], a[4:7], v[56:59]
  v_mfma_f32_16x16x32_bf16 v[60:63], a[236:239], a[4:7], v[60:63]
  buffer_load_dwordx4 a[212:215], v6, s[12:15], s27 offen offset:3072 sc1
  v_mfma_f32_16x16x32_bf16 v[64:67], a[224:227], a[8:11], v[64:67]
  ds_read_b64_tr_b16 a[248:249], v98 offset:24576
  v_mfma_f32_16x16x32_bf16 v[68:71], a[228:231], a[8:11], v[68:71]
  ds_read_b64_tr_b16 a[250:251], v98 offset:26624
  v_mfma_f32_16x16x32_bf16 v[72:75], a[232:235], a[8:11], v[72:75]
  v_mfma_f32_16x16x32_bf16 v[76:79], a[236:239], a[8:11], v[76:79]
  buffer_load_dwordx4 a[216:219], v6, s[12:15], s28 offen offset:0 sc1
  v_mfma_f32_16x16x32_bf16 v[80:83], a[224:227], a[12:15], v[80:83]
  ds_read_b64_tr_b16 a[252:253], v99 offset:24576
  v_mfma_f32_16x16x32_bf16 v[84:87], a[228:231], a[12:15], v[84:87]
  ds_read_b64_tr_b16 a[254:255], v99 offset:26624
  v_mfma_f32_16x16x32_bf16 v[88:91], a[232:235], a[12:15], v[88:91]
  v_mfma_f32_16x16x32_bf16 v[92:95], a[236:239], a[12:15], v[92:95]
  buffer_load_dwordx4 a[220:223], v7, s[12:15], s27 offen offset:0 sc1
  v_mfma_f32_16x16x32_bf16 v[108:111], a[224:227], a[16:19], v[108:111]
  v_mfma_f32_16x16x32_bf16 v[112:115], a[228:231], a[16:19], v[112:115]
  v_mfma_f32_16x16x32_bf16 v[116:119], a[232:235], a[16:19], v[116:119]
  v_mfma_f32_16x16x32_bf16 v[120:123], a[236:239], a[16:19], v[120:123]
  buffer_load_dwordx4 a[48:51], v7, s[12:15], s27 offen offset:1024 sc1
  v_mfma_f32_16x16x32_bf16 v[124:127], a[224:227], a[20:23], v[124:127]
  v_mfma_f32_16x16x32_bf16 v[128:131], a[228:231], a[20:23], v[128:131]
  v_mfma_f32_16x16x32_bf16 v[132:135], a[232:235], a[20:23], v[132:135]
  v_mfma_f32_16x16x32_bf16 v[136:139], a[236:239], a[20:23], v[136:139]
  buffer_load_dwordx4 a[52:55], v7, s[12:15], s27 offen offset:2048 sc1
  s_waitcnt vmcnt(13) lgkmcnt(0)
  v_mfma_f32_16x16x32_bf16 v[32:35], a[240:243], a[24:27], v[32:35]
  v_mfma_f32_16x16x32_bf16 v[36:39], a[244:247], a[24:27], v[36:39]
  v_sub_f32 v16, 1.0, v10
  v_mfma_f32_16x16x32_bf16 v[40:43], a[248:251], a[24:27], v[40:43]
  v_mfma_f32_16x16x32_bf16 v[44:47], a[252:255], a[24:27], v[44:47]
  buffer_load_dwordx4 a[56:59], v7, s[12:15], s27 offen offset:3072 sc1
  v_mfma_f32_16x16x32_bf16 v[48:51], a[240:243], a[28:31], v[48:51]
  v_mfma_f32_16x16x32_bf16 v[52:55], a[244:247], a[28:31], v[52:55]
  v_sub_f32 v17, 1.0, v11
  v_mfma_f32_16x16x32_bf16 v[56:59], a[248:251], a[28:31], v[56:59]
  v_mfma_f32_16x16x32_bf16 v[60:63], a[252:255], a[28:31], v[60:63]
  buffer_load_dwordx4 a[60:63], v7, s[12:15], s28 offen offset:0 sc1
  v_mfma_f32_16x16x32_bf16 v[64:67], a[240:243], a[32:35], v[64:67]
  v_mfma_f32_16x16x32_bf16 v[68:71], a[244:247], a[32:35], v[68:71]
  v_sub_f32 v18, 1.0, v12
  v_mfma_f32_16x16x32_bf16 v[72:75], a[248:251], a[32:35], v[72:75]
  v_mfma_f32_16x16x32_bf16 v[76:79], a[252:255], a[32:35], v[76:79]
  buffer_load_dwordx4 a[64:67], v8, s[12:15], s27 offen offset:0 sc1
  v_mfma_f32_16x16x32_bf16 v[80:83], a[240:243], a[36:39], v[80:83]
  v_mfma_f32_16x16x32_bf16 v[84:87], a[244:247], a[36:39], v[84:87]
  v_sub_f32 v19, 1.0, v13
  v_mfma_f32_16x16x32_bf16 v[88:91], a[248:251], a[36:39], v[88:91]
  v_mfma_f32_16x16x32_bf16 v[92:95], a[252:255], a[36:39], v[92:95]
  buffer_load_dwordx4 a[68:71], v8, s[12:15], s27 offen offset:1024 sc1
  v_mfma_f32_16x16x32_bf16 v[108:111], a[240:243], a[40:43], v[108:111]
  v_mfma_f32_16x16x32_bf16 v[112:115], a[244:247], a[40:43], v[112:115]
  v_sub_f32 v20, 1.0, v14
  v_mfma_f32_16x16x32_bf16 v[116:119], a[248:251], a[40:43], v[116:119]
  v_mfma_f32_16x16x32_bf16 v[120:123], a[252:255], a[40:43], v[120:123]
  buffer_load_dwordx4 a[72:75], v8, s[12:15], s27 offen offset:2048 sc1
  v_mfma_f32_16x16x32_bf16 v[124:127], a[240:243], a[44:47], v[124:127]
  v_mfma_f32_16x16x32_bf16 v[128:131], a[244:247], a[44:47], v[128:131]
  v_sub_f32 v21, 1.0, v15
  v_mfma_f32_16x16x32_bf16 v[132:135], a[248:251], a[44:47], v[132:135]
  v_mfma_f32_16x16x32_bf16 v[136:139], a[252:255], a[44:47], v[136:139]
  buffer_load_dwordx4 a[76:79], v8, s[12:15], s27 offen offset:3072 sc1
  s_waitcnt vmcnt(20) lgkmcnt(0)
  v_mfma_f32_16x16x32_bf16 v[140:143], a[80:83], a[160:163], 0
  buffer_load_dwordx4 v[184:187], v8, s[12:15], s28 offen offset:0 sc1
  v_mfma_f32_16x16x32_bf16 v[144:147], a[84:87], a[160:163], 0
  v_mfma_f32_16x16x32_bf16 v[148:151], a[88:91], a[160:163], 0
  buffer_load_dwordx4 v[188:191], v9, s[12:15], s27 offen offset:0 sc1
  v_mfma_f32_16x16x32_bf16 v[152:155], a[92:95], a[160:163], 0
  v_mfma_f32_16x16x32_bf16 v[140:143], a[96:99], a[164:167], v[140:143]
  buffer_load_dwordx4 v[192:195], v9, s[12:15], s27 offen offset:1024 sc1
  v_mul_f32 v32, v16, v32
  v_mfma_f32_16x16x32_bf16 v[144:147], a[100:103], a[164:167], v[144:147]
  v_mul_f32 v33, v16, v33
  v_mfma_f32_16x16x32_bf16 v[148:151], a[104:107], a[164:167], v[148:151]
  buffer_load_dwordx4 v[196:199], v9, s[12:15], s27 offen offset:2048 sc1
  v_mul_f32 v34, v16, v34
  v_mfma_f32_16x16x32_bf16 v[152:155], a[108:111], a[164:167], v[152:155]
  v_mul_f32 v35, v16, v35
  v_mfma_f32_16x16x32_bf16 v[140:143], a[112:115], a[168:171], v[140:143]
  buffer_load_dwordx4 a[0:3], v9, s[12:15], s27 offen offset:3072 sc1
  v_mul_f32 v36, v16, v36
  v_mfma_f32_16x16x32_bf16 v[144:147], a[116:119], a[168:171], v[144:147]
  v_mul_f32 v37, v16, v37
  v_mfma_f32_16x16x32_bf16 v[148:151], a[120:123], a[168:171], v[148:151]
  buffer_load_dwordx4 a[4:7], v9, s[12:15], s28 offen offset:0 sc1
  v_mul_f32 v38, v16, v38
  v_mfma_f32_16x16x32_bf16 v[152:155], a[124:127], a[168:171], v[152:155]
  v_mul_f32 v39, v16, v39
  v_mfma_f32_16x16x32_bf16 v[140:143], a[128:131], a[172:175], v[140:143]
  v_mul_f32 v40, v16, v40
  v_mfma_f32_16x16x32_bf16 v[144:147], a[132:135], a[172:175], v[144:147]
  v_mul_f32 v41, v16, v41
  v_mfma_f32_16x16x32_bf16 v[148:151], a[136:139], a[172:175], v[148:151]
  v_mul_f32 v42, v16, v42
  v_mfma_f32_16x16x32_bf16 v[152:155], a[140:143], a[172:175], v[152:155]
  v_mul_f32 v43, v16, v43
  v_mfma_f32_16x16x32_bf16 v[140:143], a[144:147], a[176:179], v[140:143]
  v_mul_f32 v44, v16, v44
  v_mfma_f32_16x16x32_bf16 v[144:147], a[148:151], a[176:179], v[144:147]
  v_mul_f32 v45, v16, v45
  v_mfma_f32_16x16x32_bf16 v[148:151], a[152:155], a[176:179], v[148:151]
  v_mul_f32 v46, v16, v46
  v_mfma_f32_16x16x32_bf16 v[152:155], a[156:159], a[176:179], v[152:155]
  v_mul_f32 v47, v16, v47
  s_waitcnt vmcnt(20)
  v_mfma_f32_16x16x32_bf16 v[156:159], a[80:83], a[180:183], 0
  v_mul_f32 v48, v17, v48
  v_mul_f32 v49, v17, v49
  v_mfma_f32_16x16x32_bf16 v[160:163], a[84:87], a[180:183], 0
  v_mul_f32 v50, v17, v50
  v_mul_f32 v51, v17, v51
  v_mfma_f32_16x16x32_bf16 v[164:167], a[88:91], a[180:183], 0
  v_mul_f32 v52, v17, v52
  v_mul_f32 v53, v17, v53
  v_mfma_f32_16x16x32_bf16 v[168:171], a[92:95], a[180:183], 0
  v_fmac_f32 v32, v10, v140
  v_fmac_f32 v33, v10, v141
  v_mfma_f32_16x16x32_bf16 v[156:159], a[96:99], a[184:187], v[156:159]
  v_fmac_f32 v34, v10, v142
  v_fmac_f32 v35, v10, v143
  v_mfma_f32_16x16x32_bf16 v[160:163], a[100:103], a[184:187], v[160:163]
  ds_write_b128 v172, v[32:35] offset:0
  v_fmac_f32 v36, v10, v144
  v_mfma_f32_16x16x32_bf16 v[164:167], a[104:107], a[184:187], v[164:167]
  v_fmac_f32 v37, v10, v145
  v_fmac_f32 v38, v10, v146
  v_mfma_f32_16x16x32_bf16 v[168:171], a[108:111], a[184:187], v[168:171]
  v_fmac_f32 v39, v10, v147
  v_mfma_f32_16x16x32_bf16 v[156:159], a[112:115], a[188:191], v[156:159]
  ds_write_b128 v173, v[36:39] offset:0
  v_fmac_f32 v40, v10, v148
  v_mfma_f32_16x16x32_bf16 v[160:163], a[116:119], a[188:191], v[160:163]
  v_fmac_f32 v41, v10, v149
  v_fmac_f32 v42, v10, v150
  v_mfma_f32_16x16x32_bf16 v[164:167], a[120:123], a[188:191], v[164:167]
  v_fmac_f32 v43, v10, v151
  ds_write_b128 v174, v[40:43] offset:0
  v_mfma_f32_16x16x32_bf16 v[168:171], a[124:127], a[188:191], v[168:171]
  v_fmac_f32 v44, v10, v152
  v_mfma_f32_16x16x32_bf16 v[156:159], a[128:131], a[192:195], v[156:159]
  v_fmac_f32 v45, v10, v153
  v_fmac_f32 v46, v10, v154
  v_mfma_f32_16x16x32_bf16 v[160:163], a[132:135], a[192:195], v[160:163]
  v_fmac_f32 v47, v10, v155
  ds_write_b128 v175, v[44:47] offset:0
  v_mfma_f32_16x16x32_bf16 v[164:167], a[136:139], a[192:195], v[164:167]
  v_mul_f32 v54, v17, v54
  v_mul_f32 v55, v17, v55
  v_mfma_f32_16x16x32_bf16 v[168:171], a[140:143], a[192:195], v[168:171]
  v_mul_f32 v56, v17, v56
  v_mfma_f32_16x16x32_bf16 v[156:159], a[144:147], a[196:199], v[156:159]
  v_mul_f32 v57, v17, v57
  v_mul_f32 v58, v17, v58
  v_mfma_f32_16x16x32_bf16 v[160:163], a[148:151], a[196:199], v[160:163]
  v_mul_f32 v59, v17, v59
  v_mul_f32 v60, v17, v60
  v_mfma_f32_16x16x32_bf16 v[164:167], a[152:155], a[196:199], v[164:167]
  v_mul_f32 v61, v17, v61
  v_mul_f32 v62, v17, v62
  v_mfma_f32_16x16x32_bf16 v[168:171], a[156:159], a[196:199], v[168:171]
  v_mul_f32 v63, v17, v63
  s_waitcnt vmcnt(15)
  v_mfma_f32_16x16x32_bf16 v[140:143], a[80:83], a[200:203], 0
  v_mul_f32 v64, v18, v64
  v_mul_f32 v65, v18, v65
  v_mfma_f32_16x16x32_bf16 v[144:147], a[84:87], a[200:203], 0
  v_mul_f32 v66, v18, v66
  v_mul_f32 v67, v18, v67
  v_mfma_f32_16x16x32_bf16 v[148:151], a[88:91], a[200:203], 0
  v_mul_f32 v68, v18, v68
  v_mul_f32 v69, v18, v69
  v_mfma_f32_16x16x32_bf16 v[152:155], a[92:95], a[200:203], 0
  v_fmac_f32 v48, v11, v156
  v_fmac_f32 v49, v11, v157
  v_mfma_f32_16x16x32_bf16 v[140:143], a[96:99], a[204:207], v[140:143]
  v_fmac_f32 v50, v11, v158
  v_fmac_f32 v51, v11, v159
  v_mfma_f32_16x16x32_bf16 v[144:147], a[100:103], a[204:207], v[144:147]
  ds_write_b128 v172, v[48:51] offset:4096
  v_fmac_f32 v52, v11, v160
  v_mfma_f32_16x16x32_bf16 v[148:151], a[104:107], a[204:207], v[148:151]
  v_fmac_f32 v53, v11, v161
  v_fmac_f32 v54, v11, v162
  v_mfma_f32_16x16x32_bf16 v[152:155], a[108:111], a[204:207], v[152:155]
  v_fmac_f32 v55, v11, v163
  v_mfma_f32_16x16x32_bf16 v[140:143], a[112:115], a[208:211], v[140:143]
  ds_write_b128 v173, v[52:55] offset:4096
  v_fmac_f32 v56, v11, v164
  v_mfma_f32_16x16x32_bf16 v[144:147], a[116:119], a[208:211], v[144:147]
  v_fmac_f32 v57, v11, v165
  v_fmac_f32 v58, v11, v166
  v_mfma_f32_16x16x32_bf16 v[148:151], a[120:123], a[208:211], v[148:151]
  v_fmac_f32 v59, v11, v167
  ds_write_b128 v174, v[56:59] offset:4096
  v_mfma_f32_16x16x32_bf16 v[152:155], a[124:127], a[208:211], v[152:155]
  v_fmac_f32 v60, v11, v168
  v_mfma_f32_16x16x32_bf16 v[140:143], a[128:131], a[212:215], v[140:143]
  v_fmac_f32 v61, v11, v169
  v_fmac_f32 v62, v11, v170
  v_mfma_f32_16x16x32_bf16 v[144:147], a[132:135], a[212:215], v[144:147]
  v_fmac_f32 v63, v11, v171
  ds_write_b128 v175, v[60:63] offset:4096
  v_mfma_f32_16x16x32_bf16 v[148:151], a[136:139], a[212:215], v[148:151]
  v_mul_f32 v70, v18, v70
  v_mul_f32 v71, v18, v71
  v_mfma_f32_16x16x32_bf16 v[152:155], a[140:143], a[212:215], v[152:155]
  v_mul_f32 v72, v18, v72
  v_mfma_f32_16x16x32_bf16 v[140:143], a[144:147], a[216:219], v[140:143]
  v_mul_f32 v73, v18, v73
  v_mul_f32 v74, v18, v74
  v_mfma_f32_16x16x32_bf16 v[144:147], a[148:151], a[216:219], v[144:147]
  v_mul_f32 v75, v18, v75
  v_mul_f32 v76, v18, v76
  v_mfma_f32_16x16x32_bf16 v[148:151], a[152:155], a[216:219], v[148:151]
  v_mul_f32 v77, v18, v77
  v_mul_f32 v78, v18, v78
  v_mfma_f32_16x16x32_bf16 v[152:155], a[156:159], a[216:219], v[152:155]
  v_mul_f32 v79, v18, v79
  s_waitcnt vmcnt(10)
  v_mfma_f32_16x16x32_bf16 v[156:159], a[80:83], a[220:223], 0
  v_mul_f32 v80, v19, v80
  v_mul_f32 v81, v19, v81
  v_mfma_f32_16x16x32_bf16 v[160:163], a[84:87], a[220:223], 0
  v_mul_f32 v82, v19, v82
  v_mul_f32 v83, v19, v83
  v_mfma_f32_16x16x32_bf16 v[164:167], a[88:91], a[220:223], 0
  v_mul_f32 v84, v19, v84
  v_mul_f32 v85, v19, v85
  v_mfma_f32_16x16x32_bf16 v[168:171], a[92:95], a[220:223], 0
  v_fmac_f32 v64, v12, v140
  v_fmac_f32 v65, v12, v141
  v_mfma_f32_16x16x32_bf16 v[156:159], a[96:99], a[48:51], v[156:159]
  v_fmac_f32 v66, v12, v142
  v_fmac_f32 v67, v12, v143
  v_mfma_f32_16x16x32_bf16 v[160:163], a[100:103], a[48:51], v[160:163]
  ds_write_b128 v172, v[64:67] offset:8192
  v_fmac_f32 v68, v12, v144
  v_mfma_f32_16x16x32_bf16 v[164:167], a[104:107], a[48:51], v[164:167]
  v_fmac_f32 v69, v12, v145
  v_fmac_f32 v70, v12, v146
  v_mfma_f32_16x16x32_bf16 v[168:171], a[108:111], a[48:51], v[168:171]
  v_fmac_f32 v71, v12, v147
  v_mfma_f32_16x16x32_bf16 v[156:159], a[112:115], a[52:55], v[156:159]
  ds_write_b128 v173, v[68:71] offset:8192
  v_fmac_f32 v72, v12, v148
  v_mfma_f32_16x16x32_bf16 v[160:163], a[116:119], a[52:55], v[160:163]
  v_fmac_f32 v73, v12, v149
  v_fmac_f32 v74, v12, v150
  v_mfma_f32_16x16x32_bf16 v[164:167], a[120:123], a[52:55], v[164:167]
  v_fmac_f32 v75, v12, v151
  ds_write_b128 v174, v[72:75] offset:8192
  v_mfma_f32_16x16x32_bf16 v[168:171], a[124:127], a[52:55], v[168:171]
  v_fmac_f32 v76, v12, v152
  v_mfma_f32_16x16x32_bf16 v[156:159], a[128:131], a[56:59], v[156:159]
  v_fmac_f32 v77, v12, v153
  v_fmac_f32 v78, v12, v154
  v_mfma_f32_16x16x32_bf16 v[160:163], a[132:135], a[56:59], v[160:163]
  v_fmac_f32 v79, v12, v155
  ds_write_b128 v175, v[76:79] offset:8192
  v_mfma_f32_16x16x32_bf16 v[164:167], a[136:139], a[56:59], v[164:167]
  v_mul_f32 v86, v19, v86
  v_mul_f32 v87, v19, v87
  v_mfma_f32_16x16x32_bf16 v[168:171], a[140:143], a[56:59], v[168:171]
  v_mul_f32 v88, v19, v88
  v_mfma_f32_16x16x32_bf16 v[156:159], a[144:147], a[60:63], v[156:159]
  v_mul_f32 v89, v19, v89
  v_mul_f32 v90, v19, v90
  v_mfma_f32_16x16x32_bf16 v[160:163], a[148:151], a[60:63], v[160:163]
  v_mul_f32 v91, v19, v91
  v_mul_f32 v92, v19, v92
  v_mfma_f32_16x16x32_bf16 v[164:167], a[152:155], a[60:63], v[164:167]
  v_mul_f32 v93, v19, v93
  v_mul_f32 v94, v19, v94
  v_mfma_f32_16x16x32_bf16 v[168:171], a[156:159], a[60:63], v[168:171]
  v_mul_f32 v95, v19, v95
  s_waitcnt vmcnt(5)
  v_mfma_f32_16x16x32_bf16 v[140:143], a[80:83], a[64:67], 0
  v_mul_f32 v108, v20, v108
  v_mul_f32 v109, v20, v109
  v_mfma_f32_16x16x32_bf16 v[144:147], a[84:87], a[64:67], 0
  v_mul_f32 v110, v20, v110
  v_mul_f32 v111, v20, v111
  v_mfma_f32_16x16x32_bf16 v[148:151], a[88:91], a[64:67], 0
  v_mul_f32 v112, v20, v112
  v_mul_f32 v113, v20, v113
  v_mfma_f32_16x16x32_bf16 v[152:155], a[92:95], a[64:67], 0
  v_fmac_f32 v80, v13, v156
  v_fmac_f32 v81, v13, v157
  v_mfma_f32_16x16x32_bf16 v[140:143], a[96:99], a[68:71], v[140:143]
  v_fmac_f32 v82, v13, v158
  v_fmac_f32 v83, v13, v159
  v_mfma_f32_16x16x32_bf16 v[144:147], a[100:103], a[68:71], v[144:147]
  ds_write_b128 v172, v[80:83] offset:12288
  v_fmac_f32 v84, v13, v160
  v_mfma_f32_16x16x32_bf16 v[148:151], a[104:107], a[68:71], v[148:151]
  v_fmac_f32 v85, v13, v161
  v_fmac_f32 v86, v13, v162
  v_mfma_f32_16x16x32_bf16 v[152:155], a[108:111], a[68:71], v[152:155]
  v_fmac_f32 v87, v13, v163
  v_mfma_f32_16x16x32_bf16 v[140:143], a[112:115], a[72:75], v[140:143]
  ds_write_b128 v173, v[84:87] offset:12288
  v_fmac_f32 v88, v13, v164
  v_mfma_f32_16x16x32_bf16 v[144:147], a[116:119], a[72:75], v[144:147]
  v_fmac_f32 v89, v13, v165
  v_fmac_f32 v90, v13, v166
  v_mfma_f32_16x16x32_bf16 v[148:151], a[120:123], a[72:75], v[148:151]
  v_fmac_f32 v91, v13, v167
  ds_write_b128 v174, v[88:91] offset:12288
  v_mfma_f32_16x16x32_bf16 v[152:155], a[124:127], a[72:75], v[152:155]
  v_fmac_f32 v92, v13, v168
  v_mfma_f32_16x16x32_bf16 v[140:143], a[128:131], a[76:79], v[140:143]
  v_fmac_f32 v93, v13, v169
  v_fmac_f32 v94, v13, v170
  v_mfma_f32_16x16x32_bf16 v[144:147], a[132:135], a[76:79], v[144:147]
  v_fmac_f32 v95, v13, v171
  ds_write_b128 v175, v[92:95] offset:12288
  v_mfma_f32_16x16x32_bf16 v[148:151], a[136:139], a[76:79], v[148:151]
  v_mul_f32 v114, v20, v114
  v_mul_f32 v115, v20, v115
  v_mfma_f32_16x16x32_bf16 v[152:155], a[140:143], a[76:79], v[152:155]
  v_mul_f32 v116, v20, v116
  v_mfma_f32_16x16x32_bf16 v[140:143], a[144:147], v[184:187], v[140:143]
  v_mul_f32 v117, v20, v117
  v_mul_f32 v118, v20, v118
  v_mfma_f32_16x16x32_bf16 v[144:147], a[148:151], v[184:187], v[144:147]
  v_mul_f32 v119, v20, v119
  v_mul_f32 v120, v20, v120
  v_mfma_f32_16x16x32_bf16 v[148:151], a[152:155], v[184:187], v[148:151]
  v_mul_f32 v121, v20, v121
  v_mul_f32 v122, v20, v122
  v_mfma_f32_16x16x32_bf16 v[152:155], a[156:159], v[184:187], v[152:155]
  v_mul_f32 v123, v20, v123
  s_waitcnt vmcnt(0)
  v_mfma_f32_16x16x32_bf16 v[156:159], a[80:83], v[188:191], 0
  v_mul_f32 v124, v21, v124
  v_mul_f32 v125, v21, v125
  v_mfma_f32_16x16x32_bf16 v[160:163], a[84:87], v[188:191], 0
  v_mul_f32 v126, v21, v126
  v_mul_f32 v127, v21, v127
  v_mfma_f32_16x16x32_bf16 v[164:167], a[88:91], v[188:191], 0
  v_mul_f32 v128, v21, v128
  v_mul_f32 v129, v21, v129
  v_mfma_f32_16x16x32_bf16 v[168:171], a[92:95], v[188:191], 0
  v_fmac_f32 v108, v14, v140
  v_fmac_f32 v109, v14, v141
  v_mfma_f32_16x16x32_bf16 v[156:159], a[96:99], v[192:195], v[156:159]
  v_fmac_f32 v110, v14, v142
  v_fmac_f32 v111, v14, v143
  v_mfma_f32_16x16x32_bf16 v[160:163], a[100:103], v[192:195], v[160:163]
  ds_write_b128 v172, v[108:111] offset:16384
  v_fmac_f32 v112, v14, v144
  v_mfma_f32_16x16x32_bf16 v[164:167], a[104:107], v[192:195], v[164:167]
  v_fmac_f32 v113, v14, v145
  v_fmac_f32 v114, v14, v146
  v_mfma_f32_16x16x32_bf16 v[168:171], a[108:111], v[192:195], v[168:171]
  v_fmac_f32 v115, v14, v147
  v_mfma_f32_16x16x32_bf16 v[156:159], a[112:115], v[196:199], v[156:159]
  ds_write_b128 v173, v[112:115] offset:16384
  v_fmac_f32 v116, v14, v148
  v_mfma_f32_16x16x32_bf16 v[160:163], a[116:119], v[196:199], v[160:163]
  v_fmac_f32 v117, v14, v149
  v_fmac_f32 v118, v14, v150
  v_mfma_f32_16x16x32_bf16 v[164:167], a[120:123], v[196:199], v[164:167]
  v_fmac_f32 v119, v14, v151
  ds_write_b128 v174, v[116:119] offset:16384
  v_mfma_f32_16x16x32_bf16 v[168:171], a[124:127], v[196:199], v[168:171]
  v_fmac_f32 v120, v14, v152
  v_mfma_f32_16x16x32_bf16 v[156:159], a[128:131], a[0:3], v[156:159]
  v_fmac_f32 v121, v14, v153
  v_fmac_f32 v122, v14, v154
  v_mfma_f32_16x16x32_bf16 v[160:163], a[132:135], a[0:3], v[160:163]
  v_fmac_f32 v123, v14, v155
  ds_write_b128 v175, v[120:123] offset:16384
  v_mfma_f32_16x16x32_bf16 v[164:167], a[136:139], a[0:3], v[164:167]
  v_mul_f32 v130, v21, v130
  v_mul_f32 v131, v21, v131
  v_mfma_f32_16x16x32_bf16 v[168:171], a[140:143], a[0:3], v[168:171]
  v_mul_f32 v132, v21, v132
  v_mfma_f32_16x16x32_bf16 v[156:159], a[144:147], a[4:7], v[156:159]
  v_mul_f32 v133, v21, v133
  v_mul_f32 v134, v21, v134
  v_mfma_f32_16x16x32_bf16 v[160:163], a[148:151], a[4:7], v[160:163]
  v_mul_f32 v135, v21, v135
  v_mul_f32 v136, v21, v136
  v_mfma_f32_16x16x32_bf16 v[164:167], a[152:155], a[4:7], v[164:167]
  v_mul_f32 v137, v21, v137
  v_mul_f32 v138, v21, v138
  v_mfma_f32_16x16x32_bf16 v[168:171], a[156:159], a[4:7], v[168:171]
  v_mul_f32 v139, v21, v139
  v_fmac_f32 v124, v15, v156
  v_fmac_f32 v125, v15, v157
  v_fmac_f32 v126, v15, v158
  v_fmac_f32 v127, v15, v159
  ds_write_b128 v172, v[124:127] offset:20480
  v_fmac_f32 v128, v15, v160
  v_fmac_f32 v129, v15, v161
  v_fmac_f32 v130, v15, v162
  v_fmac_f32 v131, v15, v163
  ds_write_b128 v173, v[128:131] offset:20480
  v_fmac_f32 v132, v15, v164
  v_fmac_f32 v133, v15, v165
  v_fmac_f32 v134, v15, v166
  v_fmac_f32 v135, v15, v167
  ds_write_b128 v174, v[132:135] offset:20480
  v_fmac_f32 v136, v15, v168
  v_fmac_f32 v137, v15, v169
  v_fmac_f32 v138, v15, v170
  v_fmac_f32 v139, v15, v171
  ds_write_b128 v175, v[136:139] offset:20480
  s_waitcnt lgkmcnt(0)
  s_barrier
  ds_read_b128 v[184:187], v176 offset:0
  ds_read_b128 v[188:191], v177 offset:0
  ds_read_b128 v[192:195], v176 offset:40960
  ds_read_b128 v[196:199], v177 offset:40960
  ds_read_b128 v[200:203], v178 offset:0
  ds_read_b128 v[204:207], v179 offset:0
  ds_read_b128 v[208:211], v178 offset:40960
  ds_read_b128 v[212:215], v179 offset:40960
  ds_read_b128 v[216:219], v176 offset:8192
  ds_read_b128 v[220:223], v177 offset:8192
  ds_read_b128 v[224:227], v176 offset:49152
  ds_read_b128 v[228:231], v177 offset:49152
  ds_read_b128 v[232:235], v178 offset:8192
  ds_read_b128 v[236:239], v179 offset:8192
  ds_read_b128 v[240:243], v178 offset:49152
  ds_read_b128 v[244:247], v179 offset:49152
  s_waitcnt lgkmcnt(8)
  v_pk_add_f32 v[184:185], v[184:185], v[192:193]
  v_pk_add_f32 v[200:201], v[200:201], v[208:209]
  v_pk_add_f32 v[186:187], v[186:187], v[194:195]
  v_pk_add_f32 v[202:203], v[202:203], v[210:211]
  v_pk_add_f32 v[188:189], v[188:189], v[196:197]
  v_pk_add_f32 v[204:205], v[204:205], v[212:213]
  v_pk_add_f32 v[190:191], v[190:191], v[198:199]
  v_pk_add_f32 v[206:207], v[206:207], v[214:215]
  v_pk_add_f32 v[184:185], v[184:185], v[200:201]
  v_pk_add_f32 v[186:187], v[186:187], v[202:203]
  v_pk_add_f32 v[188:189], v[188:189], v[204:205]
  v_pk_add_f32 v[190:191], v[190:191], v[206:207]
  v_cvt_pk_bf16_f32 v32, v184, v185
  v_cvt_pk_bf16_f32 v33, v186, v187
  v_cvt_pk_bf16_f32 v34, v188, v189
  v_cvt_pk_bf16_f32 v35, v190, v191
  s_mov_b32 s58, 0
  buffer_store_dwordx4 v[32:35], v180, s[72:75], s58 offen sc1 nt
  ds_read_b128 v[184:187], v176 offset:16384
  ds_read_b128 v[188:191], v177 offset:16384
  ds_read_b128 v[192:195], v176 offset:57344
  ds_read_b128 v[196:199], v177 offset:57344
  ds_read_b128 v[200:203], v178 offset:16384
  ds_read_b128 v[204:207], v179 offset:16384
  ds_read_b128 v[208:211], v178 offset:57344
  ds_read_b128 v[212:215], v179 offset:57344
  s_waitcnt lgkmcnt(8)
  v_pk_add_f32 v[216:217], v[216:217], v[224:225]
  v_pk_add_f32 v[232:233], v[232:233], v[240:241]
  v_pk_add_f32 v[218:219], v[218:219], v[226:227]
  v_pk_add_f32 v[234:235], v[234:235], v[242:243]
  v_pk_add_f32 v[220:221], v[220:221], v[228:229]
  v_pk_add_f32 v[236:237], v[236:237], v[244:245]
  v_pk_add_f32 v[222:223], v[222:223], v[230:231]
  v_pk_add_f32 v[238:239], v[238:239], v[246:247]
  v_pk_add_f32 v[216:217], v[216:217], v[232:233]
  v_pk_add_f32 v[218:219], v[218:219], v[234:235]
  v_pk_add_f32 v[220:221], v[220:221], v[236:237]
  v_pk_add_f32 v[222:223], v[222:223], v[238:239]
  v_cvt_pk_bf16_f32 v36, v216, v217
  v_cvt_pk_bf16_f32 v37, v218, v219
  v_cvt_pk_bf16_f32 v38, v220, v221
  v_cvt_pk_bf16_f32 v39, v222, v223
  s_mov_b32 s58, 40960
  buffer_store_dwordx4 v[36:39], v180, s[72:75], s58 offen sc1 nt
  s_waitcnt lgkmcnt(0)
  v_pk_add_f32 v[184:185], v[184:185], v[192:193]
  v_pk_add_f32 v[200:201], v[200:201], v[208:209]
  v_pk_add_f32 v[186:187], v[186:187], v[194:195]
  v_pk_add_f32 v[202:203], v[202:203], v[210:211]
  v_pk_add_f32 v[188:189], v[188:189], v[196:197]
  v_pk_add_f32 v[204:205], v[204:205], v[212:213]
  v_pk_add_f32 v[190:191], v[190:191], v[198:199]
  v_pk_add_f32 v[206:207], v[206:207], v[214:215]
  v_pk_add_f32 v[184:185], v[184:185], v[200:201]
  v_pk_add_f32 v[186:187], v[186:187], v[202:203]
  v_pk_add_f32 v[188:189], v[188:189], v[204:205]
  v_pk_add_f32 v[190:191], v[190:191], v[206:207]
  v_cvt_pk_bf16_f32 v40, v184, v185
  v_cvt_pk_bf16_f32 v41, v186, v187
  v_cvt_pk_bf16_f32 v42, v188, v189
  v_cvt_pk_bf16_f32 v43, v190, v191
  s_mov_b32 s58, 81920
  buffer_store_dwordx4 v[40:43], v180, s[72:75], s58 offen sc1 nt
  s_branch Lfin
Lfin:
Lend:
  s_endpgm
.p2align 6
.type Ltab,@object
.size Ltab, 1024
Ltab:
.long 0x00001200, 0x18888614, 0x29111623, 0x39d98a32, 0x4a622642, 0x62ea9a54, 0x73730e62, 0x7bfb626d
.long 0x08041e05, 0x20ccc219, 0x3195422c, 0x41dd9a37, 0x52a6464a, 0x62ea9e54, 0x7bb74a68, 0x8c7fd67c
.long 0x00000280, 0x1048428f, 0x2910ca9e, 0x39995aad, 0x4a21e2be, 0x5aaa4ece, 0x6b32dedd, 0x7bfb56ed
.long 0x00000680, 0x1048468f, 0x2910d69e, 0x399966ad, 0x4a21c2bf, 0x5aaa62ce, 0x7372cade, 0x83fb8ef0
.long 0x00000a80, 0x10484a8f, 0x2910da9e, 0x399962af, 0x4a21cebf, 0x5aaa4acf, 0x7372d6de, 0x83fb92f0
.long 0x00000e80, 0x1048568f, 0x2910e69e, 0x399982b0, 0x4a2206c0, 0x5aaa56cf, 0x737312e0, 0x83fb82f1
.long 0x00001680, 0x10485a8f, 0x29110ea0, 0x39998eb0, 0x4a220ac0, 0x5aaa5acf, 0x737302e2, 0x83fb86f1
.long 0x00001a80, 0x1048668f, 0x291122a0, 0x399986b1, 0x4a2216c0, 0x5aaa5ecf, 0x737306e2, 0x83fb8af1
.long 0x00001e80, 0x18888e90, 0x291102a2, 0x399996b1, 0x4a221ac0, 0x62ea92d1, 0x73731ae2, 0x83fb9af1
.long 0x00002680, 0x1888a290, 0x291106a2, 0x39999eb1, 0x4a221ec0, 0x62eaa6d1, 0x73731ee2, 0x83fb9ef1
.long 0x08041284, 0x18889293, 0x29111ea2, 0x39d99ab2, 0x526212c2, 0x62ea82d3, 0x737326e2, 0x83fba2f1
.long 0x08040285, 0x18889e93, 0x29110aa3, 0x41dda2b4, 0x526222c3, 0x62ea86d3, 0x73730ae3, 0x83fba6f1
.long 0x08040685, 0x188c8294, 0x29111aa3, 0x41dd82b5, 0x526602c4, 0x62ea8ed3, 0x737316e3, 0x843b96f2
.long 0x08040a85, 0x188c8a94, 0x291126a3, 0x41dd8eb5, 0x52660ec4, 0x62eaa2d3, 0x737322e3, 0x8c3f8ef5
.long 0x08040e85, 0x188c9694, 0x29550ea5, 0x41dd86b6, 0x526606c5, 0x62ee8ad4, 0x73b712e5, 0x8c3f92f5
.long 0x08041685, 0x188c9a94, 0x295522a5, 0x41dd8ab6, 0x52660ac5, 0x62ee96d4, 0x7bb70ee6, 0x8c3f82f6
.long 0x08041a85, 0x188ca694, 0x315502a7, 0x41dd96b6, 0x526616c5, 0x632e92d6, 0x7bb702e7, 0x8c3f86f6
.long 0x08042685, 0x188c8e95, 0x315506a7, 0x41dd9eb6, 0x52661ac5, 0x6b2ec2d8, 0x7bb706e7, 0x8c3f8af6
.long 0x08042286, 0x20ccc698, 0x315516a7, 0x41ddd2b8, 0x52661ec5, 0x6b2ec6d8, 0x7bb71ae7, 0x8c3f9af6
.long 0x08445289, 0x20ccd298, 0x31551ea7, 0x41dde6b8, 0x526626c6, 0x6b2eced8, 0x7bb71ee7, 0x8c3f9ef6
.long 0x08445e89, 0x20ccde98, 0x31554aa8, 0x41dde2b9, 0x526612c7, 0x6b2edad8, 0x7bb726e7, 0x8c3fa2f6
.long 0x1044428a, 0x20ccca99, 0x315552a8, 0x421dc2ba, 0x52a642c9, 0x6b2eded8, 0x7bb756e8, 0x8c3fa6f6
.long 0x1044468a, 0x20ccd699, 0x31555aa8, 0x421dceba, 0x52a64ec9, 0x6b2ee2d8, 0x7bb762e8, 0x8c3f96f7
.long 0x10444a8a, 0x20ccda99, 0x315566a8, 0x421dc6bb, 0x5aa64aca, 0x6b2ecad9, 0x7bb74eeb, 0x8c7fc2fb
.long 0x1044568a, 0x20cce699, 0x315562aa, 0x421dcabb, 0x5aa656ca, 0x6b2ed6d9, 0x7bfb42ec, 0x8c7fc6fb
.long 0x10445a8a, 0x20cce29b, 0x399946ac, 0x421dd6bb, 0x5aa65aca, 0x6b2ed2db, 0x7bfb46ec, 0x8c7fcafb
.long 0x1044668a, 0x20d0c29d, 0x399956ac, 0x421ddabb, 0x5aa65eca, 0x6b32c2dd, 0x7bfb4aec, 0x8c7fdafb
.long 0x1044628b, 0x20d0c69d, 0x39995eac, 0x421ddebb, 0x5aaa52cc, 0x6b32c6dd, 0x7bfb5aec, 0x8c7fdefb
.long 0x1048528e, 0x20d0d29d, 0x39994aad, 0x4a21d2bd, 0x5aaa42ce, 0x6b32cedd, 0x7bfb5eec, 0x8c7fe2fb
.long 0x10485e8e, 0x20d0de9d, 0x399952ad, 0x4a21e6bd, 0x5aaa46ce, 0x6b32dadd, 0x7bfb66ec, 0x8c7fe6fb
.long 0x00002300, 0x188ca315, 0x29111322, 0x39d99332, 0x52a66348, 0x632ea756, 0x7332e35d, 0x8c7fcf7a
.long 0x10444f0a, 0x20cccf1a, 0x31554f2a, 0x39d9a732, 0x5aaa674b, 0x6b32e75c, 0x7bb7536a, 0x8c7fd37a
.section .rodata,"a"
.p2align 6
.amdhsa_kernel gated_mix__sliding_local_dilated__dense_activation_relu__prompt_kernel
  .amdhsa_next_free_vgpr 512
  .amdhsa_next_free_sgpr 102
  .amdhsa_accum_offset 256
  .amdhsa_group_segment_fixed_size 0
  .amdhsa_kernarg_size 80
  .amdhsa_user_sgpr_count 2
  .amdhsa_user_sgpr_kernarg_segment_ptr 1
  .amdhsa_system_sgpr_workgroup_id_x 1
.end_amdhsa_kernel
```
